```python
import torch

def _softmax(x, axis=-1):
    return torch.softmax(x, dim=axis)
def _gelu(x):
    return torch.nn.functional.gelu(x, approximate="tanh")
def _silu(x):
    return torch.nn.functional.silu(x)
def _sigmoid(x):
    return torch.sigmoid(x)
def _layernorm(x, axis=-1, eps=1e-5):
    m = x.mean(dim=axis, keepdim=True)
    v = x.var(dim=axis, keepdim=True, unbiased=False)
    return (x - m) / torch.sqrt(v + eps)
def _scatter_add(tgt, idx, src, axis=0):
    return tgt.clone().index_add_(axis, idx, src)
def _segment_sum(src, seg, n):
    out = torch.zeros((n,) + src.shape[1:], dtype=src.dtype)
    return out.index_add_(0, seg, src)
def _pad(x, pw):
    flat = tuple(v for pair in reversed(pw) for v in pair)
    return torch.nn.functional.pad(x, flat)

kernel_name = 'interleave_layers__ssm_conv_h3__dense_activation_silu__prompt'

def setup_inputs():

    _w = (lambda a: (lambda t: t.to(torch.bfloat16) if t.is_floating_point() else t)(torch.as_tensor(a)))
    def _A_setup():
        B, S, D = 1, 2048, 512
        ks = 4
        return {
            "q": _w((lambda *s: torch.randn(*s, dtype=torch.bfloat16) * 0.05)(B, S, D)),
            "k": _w((lambda *s: torch.randn(*s, dtype=torch.bfloat16) * 0.2)(B, S, D)),
            "v": _w((lambda *s: torch.randn(*s, dtype=torch.bfloat16) * 0.2)(B, S, D)),
            "shift_k": _w((lambda *s: torch.randn(*s, dtype=torch.bfloat16) * 0.2)(D, ks) * 0.5),
            "ssm_k": _w((lambda *s: torch.randn(*s, dtype=torch.bfloat16) * 0.4)(D, S) * (1.0 / S ** 0.5)),
            "ssm_D": _w((lambda *s: torch.randn(*s, dtype=torch.bfloat16) * 0.2)(D)),
        }
    _A_in = _A_setup()

    def _B_setup():
        B, S, D, F = 1, 2048, 512, 1792
        return {
            "x": _w((lambda *s: torch.randn(*s, dtype=torch.bfloat16) * 0.05)(B, S, D)),
            "w1": _w((lambda *s: torch.randn(*s, dtype=torch.bfloat16) * 0.8)(D, F) * (D ** -0.5)),
            "w2": _w((lambda *s: torch.randn(*s, dtype=torch.bfloat16) * 0.1)(F, D) * (F ** -0.5)),
        }
    _B_in = _B_setup()

    return {
        "A_q": _A_in["q"],
        "A_k": _A_in["k"],
        "A_v": _A_in["v"],
        "A_shift_k": _A_in["shift_k"],
        "A_ssm_k": _A_in["ssm_k"],
        "A_ssm_D": _A_in["ssm_D"],
        "B_x": _B_in["x"],
        "B_w1": _B_in["w1"],
        "B_w2": _B_in["w2"],
    }

def reference(A_q, A_k, A_v, A_shift_k, A_ssm_k, A_ssm_D, B_x, B_w1, B_w2):
    def _A_ref(q, k, v, shift_k, ssm_k, ssm_D):
        B, S, D = q.shape
        ks = shift_k.shape[-1]
        k_pad = _pad(k, ((0, 0), (ks - 1, 0), (0, 0)))
        k_shift = torch.zeros_like(k)
        for t in range(ks):
            k_shift = k_shift + k_pad[:, t:t + S, :] * shift_k[:, ks - 1 - t][None, None, :]
        kv = k_shift * v
        L = 2 * S
        kv_pad = _pad(kv, ((0, 0), (0, S), (0, 0)))
        kf_pad = _pad(ssm_k, ((0, 0), (0, S)))
        kv_f = (lambda x, axes=(-2,-1): torch.fft.rfft2(x.float(), dim=axes))(kv_pad[:, None, :, :], axes=(1, 2))
        kf_f = (lambda x, axes=(-2,-1): torch.fft.rfft2(x.float(), dim=axes))(kf_pad[:, None, :], axes=(1, 2))
        kf_f = (lambda x, *d: x.permute(*d))(kf_f, 1, 2, 0)
        y_f = kv_f * kf_f[None, :, :, :]
        y = (lambda x, s, axes=(-2,-1): torch.fft.irfft2(x, s=s, dim=axes).to(torch.bfloat16))(y_f, (1, L), axes=(1, 2))[:, 0, :S, :]
        y = y + kv * ssm_D[None, None, :]
        return q * y

    def _B_ref(x, w1, w2):
        h = torch.einsum("bsd,df->bsf", x, w1)
        h = _silu(h)
        out = torch.einsum("bsf,fd->bsd", h, w2)
        return out

    x = A_q
    x = x + _A_ref(_layernorm(x, axis=-1), A_k, A_v, A_shift_k, A_ssm_k, A_ssm_D)
    x = x + _B_ref(_layernorm(x, axis=-1), B_w1, B_w2)
    x = x + _A_ref(_layernorm(x, axis=-1), A_k, A_v, A_shift_k, A_ssm_k, A_ssm_D)
    x = x + _B_ref(_layernorm(x, axis=-1), B_w1, B_w2)
    return x
```

```asm
; @launch grid=(256,1,1) block=(256,1,1) lds=163840
.amdgcn_target "amdgcn-amd-amdhsa--gfx950"
.text
.globl interleave_layers__ssm_conv_h3__dense_activation_silu__prompt_kernel
.p2align 8
.type interleave_layers__ssm_conv_h3__dense_activation_silu__prompt_kernel,@function
interleave_layers__ssm_conv_h3__dense_activation_silu__prompt_kernel:
    s_cmp_ge_u32 s2, 0x100
    s_cbranch_scc1 L_end
    s_load_dwordx16 s[4:19], s[0:1], 0
    s_load_dwordx8 s[20:27], s[0:1], 64
    s_getpc_b64 s[40:41]
    s_and_b32 s40, s40, 0xffffff00
    s_and_b32 s41, s41, 0xffff
    s_mov_b32 s42, L_cpf_end-interleave_layers__ssm_conv_h3__dense_activation_silu__prompt_kernel
    s_mov_b32 s43, 0x20000
    s_lshr_b32 s72, s2, 3
    s_mul_i32 s72, s72, 1280
    v_lshlrev_b32 v2, 7, v0
    v_cmp_gt_u32 vcc, 10, v0
    s_nop 1
    v_cndmask_b32 v2, -1, v2, vcc
    buffer_load_dword v43, v2, s[40:43], s72 offen
    v_lshrrev_b32 v2, 6, v0
    v_and_b32 v1, 63, v0
    v_readfirstlane_b32 s66, v2
    s_and_b32 s64, s2, 7
    s_lshr_b32 s65, s2, 3
    s_and_b32 s67, s65, 15
    s_lshr_b32 s68, s65, 4
    s_movk_i32 s80, 0x1000
    s_mov_b32 s71, 0x10000
    s_lshl_b32 s76, s64, 5
    s_add_u32 s76, s76, s65
    v_and_b32 v99, 31, v0
    v_lshrrev_b32 v100, 5, v0
    s_lshl_b32 s72, s65, 16
    s_lshl_b32 s73, s64, 7
    s_add_u32 s72, s72, s73
    v_lshlrev_b32 v94, 13, v100
    v_lshl_add_u32 v94, v99, 2, v94
    v_add_u32 v94, s72, v94
    v_subrev_u32 v95, 3072, v94
    v_subrev_u32 v96, 2048, v94
    v_subrev_u32 v97, 1024, v94
    s_lshl_b32 s73, s64, 9
    v_lshl_add_u32 v98, v99, 4, s73
    v_and_b32 v17, 15, v1
    v_lshrrev_b32 v18, 4, v1
    v_lshlrev_b32 v5, 4, v0
    v_mov_b32 v116, -1
    v_mov_b32 v117, -1
    v_mov_b32 v118, -1
    v_mov_b32 v119, -1
    v_and_b32 v22, 7, v99
    v_xor_b32 v22, v22, v100
    v_lshlrev_b32 v22, 4, v22
    v_lshl_add_u32 v22, v99, 8, v22
    v_add_u32 v19, 131072, v22
    v_lshrrev_b32 v22, 3, v0
    v_and_b32 v23, 7, v0
    v_bfe_u32 v2, v0, 4, 3
    v_xor_b32 v2, v2, v23
    v_lshlrev_b32 v2, 4, v2
    v_lshl_add_u32 v2, v22, 7, v2
    v_add_u32 v6, 131072, v2
    s_lshl_b32 s72, s65, 7
    v_lshlrev_b32 v22, 12, v22
    v_lshl_add_u32 v22, v23, 4, v22
    v_add_u32 v20, s72, v22
    s_lshl_b32 s72, s76, 6
    s_add_u32 s72, s72, 16384
    v_lshl_add_u32 v3, v0, 2, s72
    v_cmp_gt_u32 vcc, 16, v0
    s_lshl_b32 s72, s76, 6
    s_add_u32 s72, s72, 262144
    v_lshl_add_u32 v14, v0, 2, s72
    v_cndmask_b32 v3, 2.0, v3, vcc
    v_cmp_gt_u32 vcc, 16, v0
    s_lshl_b32 s72, s64, 11
    s_add_u32 s72, s72, 16384
    v_lshl_add_u32 v4, v99, 6, s72
    v_cndmask_b32 v14, 2.0, v14, vcc
    s_lshl_b32 s72, s65, 13
    s_lshl_b32 s73, s66, 11
    s_add_u32 s72, s72, s73
    v_lshl_add_u32 v112, v1, 7, s72
    v_cmp_gt_u32 vcc, 16, v1
    s_lshl_b32 s72, s66, 7
    s_add_u32 s72, s72, 2097152
    v_cndmask_b32 v112, 2.0, v112, vcc
    v_writelane_b32 v112, s72, 16
    s_lshl_b32 s72, s64, 22
    s_add_u32 s72, s72, 4194304
    s_mov_b32 s75, 131072
    s_mov_b32 s30, 2097152
    s_mov_b32 s31, 0x20000
    s_mov_b32 s34, 2097152
    s_mov_b32 s35, 0x20000
    s_mov_b32 s62, 4194304
    s_mov_b32 s63, 0x20000
    s_waitcnt lgkmcnt(0)
    s_load_dword s69, s[26:27], 0
    s_mov_b32 s28, s6
    s_and_b32 s29, s7, 0xffff
    buffer_load_dword v24, v95, s[28:31], 0 offen
    buffer_load_dword v25, v96, s[28:31], 0 offen
    buffer_load_dword v26, v97, s[28:31], 0 offen
    buffer_load_dword v27, v94, s[28:31], 0 offen offset:0
    buffer_load_dword v28, v94, s[28:31], 0 offen offset:1024
    buffer_load_dword v29, v94, s[28:31], 0 offen offset:2048
    buffer_load_dword v30, v94, s[28:31], 0 offen offset:3072
    buffer_load_dword v31, v94, s[28:31], s80 offen offset:0
    buffer_load_dword v32, v94, s[28:31], s80 offen offset:1024
    buffer_load_dword v33, v94, s[28:31], s80 offen offset:2048
    buffer_load_dword v34, v94, s[28:31], s80 offen offset:3072
    global_load_dwordx4 v[44:47], v98, s[10:11]
    s_mov_b32 s32, s8
    s_and_b32 s33, s9, 0xffff
    buffer_load_dword v35, v94, s[32:35], 0 offen offset:0
    buffer_load_dword v36, v94, s[32:35], 0 offen offset:1024
    buffer_load_dword v37, v94, s[32:35], 0 offen offset:2048
    buffer_load_dword v38, v94, s[32:35], 0 offen offset:3072
    buffer_load_dword v39, v94, s[32:35], s80 offen offset:0
    buffer_load_dword v40, v94, s[32:35], s80 offen offset:1024
    buffer_load_dword v41, v94, s[32:35], s80 offen offset:2048
    buffer_load_dword v42, v94, s[32:35], s80 offen offset:3072
    s_add_u32 s60, s26, s72
    s_addc_u32 s61, s27, 0
    s_and_b32 s61, s61, 0xffff
    s_lshl_b32 s72, s76, 2
    s_load_dword s87, s[14:15], s72
    s_mov_b32 s40, s12
    s_and_b32 s41, s13, 0xffff
    s_mov_b32 s42, 2097152
    s_mov_b32 s43, 0x20000
    s_lshl_b32 s72, s76, 13
    s_add_u32 s73, s72, 4096
    s_lshl_b32 s74, s66, 10
    s_add_u32 m0, s74, 148768
    s_nop 0
    buffer_load_dwordx4 v5, s[40:43], s72 offen lds
    s_add_u32 m0, s74, 152928
    s_nop 0
    buffer_load_dwordx4 v5, s[40:43], s73 offen lds
    s_mov_b32 s52, s26
    s_and_b32 s53, s27, 0xffff
    s_mov_b32 s54, 268435456
    s_mov_b32 s55, 0x20000
    s_mov_b32 s48, s20
    s_and_b32 s49, s21, 0xffff
    s_mov_b32 s50, 1835008
    s_mov_b32 s51, 0x20000
    s_cmp_ge_u32 s67, 14
    s_cselect_b32 s50, 0, s50
    s_lshl_b32 s80, s67, 6
    s_and_b32 s80, s80, 0x380
    s_add_u32 s80, s80, 639
    s_sub_u32 s80, s80, s20
    s_and_b32 s80, s80, 0x380
    v_lshrrev_b32 v22, 3, v1
    v_and_b32 v23, 1, v18
    v_lshlrev_b32 v23, 1, v23
    v_and_b32 v15, 7, v1
    v_xor_b32 v15, v15, v23
    v_lshlrev_b32 v15, 4, v15
    v_lshl_add_u32 v15, v22, 10, v15
    s_mul_i32 s72, s66, 458752
    s_add_u32 s72, s72, s80
    v_add_u32 v15, s72, v15
    s_lshl_b32 s3, s66, 15
    s_mul_i32 s72, s66, 2368
    s_add_u32 s72, s72, 139264
    v_lshl_add_u32 v22, v1, 2, s72
    v_mov_b32 v2, 0
    s_lshr_b32 s72, s66, 1
    s_mul_i32 s72, s72, 4160
    s_and_b32 s73, s66, 1
    s_lshl_b32 s73, s73, 4
    s_add_u32 s72, s72, s73
    s_add_u32 s72, s72, 148496
    v_lshl_add_u32 v23, v1, 2, s72
    v_cmp_gt_u32 vcc, 60, v1
    s_nop 1
    v_cndmask_b32 v22, v23, v22, vcc
    ds_write_b32 v22, v2
    s_and_b32 s72, s66, 1
    s_lshl_b32 s72, s72, 7
    s_add_u32 s72, s72, 1
    v_lshl_add_u32 v22, v18, 5, v17
    v_add_u32 v22, s72, v22
    v_and_b32 v21, 1, v22
    v_lshlrev_b32 v21, 4, v21
    v_and_b32 v22, -2, v22
    s_lshr_b32 s72, s66, 1
    s_mul_i32 s72, s72, 4160
    s_add_u32 s72, s72, 148736
    v_lshl_add_u32 v8, v22, 1, s72
    s_mov_b64 exec, 0
    s_cmp_eq_u32 s66, 0
    s_cbranch_scc1 L_hop_1
    s_cmp_eq_u32 s66, 1
    s_cbranch_scc1 L_hop_2
    s_cmp_eq_u32 s66, 2
    s_cbranch_scc1 L_hop_3
    s_branch L_hop_4
L_hop_back0:
    s_mov_b64 exec, -1
    s_getreg_b32 s72, hwreg(HW_REG_XCC_ID, 0, 4)
    s_waitcnt lgkmcnt(0)
    s_mul_i32 s69, s69, 0x9e3779b1
    s_add_u32 s69, s69, 0x7f4a7c15
    s_and_b32 s69, s69, 0xfffffff0
    s_lshl_b32 s86, s87, 16
    s_and_b32 s87, s87, 0xffff0000
    s_or_b32 s70, s69, s72
    v_mov_b32 v22, s70
    buffer_store_dword v22, v3, s[52:55], 0 offen sc1
    s_add_u32 m0, s3, 0
    s_lshl_b32 s77, s64, 15
    buffer_load_dwordx4 v15, s[48:51], s77 offen lds
    s_add_u32 m0, s3, 1024
    s_add_u32 s77, s77, 8192
    buffer_load_dwordx4 v15, s[48:51], s77 offen lds
    s_add_u32 m0, s3, 2048
    s_add_u32 s77, s77, 8192
    buffer_load_dwordx4 v15, s[48:51], s77 offen lds
    s_add_u32 m0, s3, 3072
    s_add_u32 s77, s77, 8192
    buffer_load_dwordx4 v15, s[48:51], s77 offen lds
    s_waitcnt vmcnt(26)
    v_lshlrev_b32 v56, 16, v24
    v_and_b32 v57, 0xffff0000, v24
    s_waitcnt vmcnt(25)
    v_lshlrev_b32 v58, 16, v25
    v_and_b32 v59, 0xffff0000, v25
    s_waitcnt vmcnt(24)
    v_lshlrev_b32 v60, 16, v26
    v_and_b32 v61, 0xffff0000, v26
    s_waitcnt vmcnt(23)
    v_lshlrev_b32 v62, 16, v27
    v_and_b32 v63, 0xffff0000, v27
    s_waitcnt vmcnt(22)
    v_lshlrev_b32 v64, 16, v28
    v_and_b32 v65, 0xffff0000, v28
    s_waitcnt vmcnt(21)
    v_lshlrev_b32 v66, 16, v29
    v_and_b32 v67, 0xffff0000, v29
    s_waitcnt vmcnt(20)
    v_lshlrev_b32 v68, 16, v30
    v_and_b32 v69, 0xffff0000, v30
    s_waitcnt vmcnt(19)
    v_lshlrev_b32 v70, 16, v31
    v_and_b32 v71, 0xffff0000, v31
    s_waitcnt vmcnt(18)
    v_lshlrev_b32 v72, 16, v32
    v_and_b32 v73, 0xffff0000, v32
    s_waitcnt vmcnt(17)
    v_lshlrev_b32 v74, 16, v33
    v_and_b32 v75, 0xffff0000, v33
    s_waitcnt vmcnt(16)
    v_lshlrev_b32 v76, 16, v34
    v_and_b32 v77, 0xffff0000, v34
    s_waitcnt vmcnt(15)
    v_lshlrev_b32 v48, 16, v44
    v_lshlrev_b32 v49, 16, v46
    v_and_b32 v50, 0xffff0000, v44
    v_and_b32 v51, 0xffff0000, v46
    v_lshlrev_b32 v52, 16, v45
    v_lshlrev_b32 v53, 16, v47
    v_and_b32 v54, 0xffff0000, v45
    v_and_b32 v55, 0xffff0000, v47
    v_pk_mul_f32 v[94:95], v[48:49], v[62:63]
    v_pk_mul_f32 v[96:97], v[48:49], v[64:65]
    v_pk_mul_f32 v[98:99], v[48:49], v[66:67]
    v_pk_mul_f32 v[100:101], v[48:49], v[68:69]
    v_pk_mul_f32 v[102:103], v[48:49], v[70:71]
    v_pk_mul_f32 v[104:105], v[48:49], v[72:73]
    v_pk_mul_f32 v[106:107], v[48:49], v[74:75]
    v_pk_mul_f32 v[108:109], v[48:49], v[76:77]
    v_pk_fma_f32 v[94:95], v[50:51], v[60:61], v[94:95]
    v_pk_fma_f32 v[96:97], v[50:51], v[62:63], v[96:97]
    v_pk_fma_f32 v[98:99], v[50:51], v[64:65], v[98:99]
    v_pk_fma_f32 v[100:101], v[50:51], v[66:67], v[100:101]
    v_pk_fma_f32 v[102:103], v[50:51], v[68:69], v[102:103]
    v_pk_fma_f32 v[104:105], v[50:51], v[70:71], v[104:105]
    v_pk_fma_f32 v[106:107], v[50:51], v[72:73], v[106:107]
    v_pk_fma_f32 v[108:109], v[50:51], v[74:75], v[108:109]
    v_pk_fma_f32 v[94:95], v[52:53], v[58:59], v[94:95]
    v_pk_fma_f32 v[96:97], v[52:53], v[60:61], v[96:97]
    v_pk_fma_f32 v[98:99], v[52:53], v[62:63], v[98:99]
    v_pk_fma_f32 v[100:101], v[52:53], v[64:65], v[100:101]
    v_pk_fma_f32 v[102:103], v[52:53], v[66:67], v[102:103]
    v_pk_fma_f32 v[104:105], v[52:53], v[68:69], v[104:105]
    v_pk_fma_f32 v[106:107], v[52:53], v[70:71], v[106:107]
    v_pk_fma_f32 v[108:109], v[52:53], v[72:73], v[108:109]
    v_pk_fma_f32 v[94:95], v[54:55], v[56:57], v[94:95]
    v_pk_fma_f32 v[96:97], v[54:55], v[58:59], v[96:97]
    v_pk_fma_f32 v[98:99], v[54:55], v[60:61], v[98:99]
    v_pk_fma_f32 v[100:101], v[54:55], v[62:63], v[100:101]
    v_pk_fma_f32 v[102:103], v[54:55], v[64:65], v[102:103]
    v_pk_fma_f32 v[104:105], v[54:55], v[66:67], v[104:105]
    v_pk_fma_f32 v[106:107], v[54:55], v[68:69], v[106:107]
    v_pk_fma_f32 v[108:109], v[54:55], v[70:71], v[108:109]
    buffer_load_dword v113, v112, s[60:63], 0 offen sc1
    s_waitcnt vmcnt(15)
    v_lshlrev_b32 v78, 16, v35
    v_and_b32 v79, 0xffff0000, v35
    v_pk_mul_f32 v[94:95], v[94:95], v[78:79]
    s_waitcnt vmcnt(14)
    v_lshlrev_b32 v80, 16, v36
    v_and_b32 v81, 0xffff0000, v36
    v_pk_mul_f32 v[96:97], v[96:97], v[80:81]
    s_waitcnt vmcnt(13)
    v_lshlrev_b32 v82, 16, v37
    v_and_b32 v83, 0xffff0000, v37
    v_pk_mul_f32 v[98:99], v[98:99], v[82:83]
    s_waitcnt vmcnt(12)
    v_lshlrev_b32 v84, 16, v38
    v_and_b32 v85, 0xffff0000, v38
    v_pk_mul_f32 v[100:101], v[100:101], v[84:85]
    s_waitcnt vmcnt(11)
    v_lshlrev_b32 v86, 16, v39
    v_and_b32 v87, 0xffff0000, v39
    v_pk_mul_f32 v[102:103], v[102:103], v[86:87]
    s_waitcnt vmcnt(10)
    v_lshlrev_b32 v88, 16, v40
    v_and_b32 v89, 0xffff0000, v40
    v_pk_mul_f32 v[104:105], v[104:105], v[88:89]
    s_waitcnt vmcnt(9)
    v_lshlrev_b32 v90, 16, v41
    v_and_b32 v91, 0xffff0000, v41
    v_pk_mul_f32 v[106:107], v[106:107], v[90:91]
    s_waitcnt vmcnt(8)
    v_lshlrev_b32 v92, 16, v42
    v_and_b32 v93, 0xffff0000, v42
    v_pk_mul_f32 v[108:109], v[108:109], v[92:93]
    v_cvt_pk_bf16_f32 v24, v108, v106
    v_cvt_pk_bf16_f32 v25, v104, v102
    v_cvt_pk_bf16_f32 v26, v100, v98
    v_cvt_pk_bf16_f32 v27, v96, v94
    ds_write_b128 v19, v[24:27] offset:0
    v_cvt_pk_bf16_f32 v28, v109, v107
    v_cvt_pk_bf16_f32 v29, v105, v103
    v_cvt_pk_bf16_f32 v30, v101, v99
    v_cvt_pk_bf16_f32 v31, v97, v95
    ds_write_b128 v19, v[28:31] offset:128
    s_waitcnt lgkmcnt(0)
    s_barrier
    ds_read_b128 v[32:35], v6
    ds_read_b128 v[36:39], v6 offset:4096
    buffer_load_dword v22, v4, s[52:55], 0 offen sc1
    s_waitcnt lgkmcnt(1)
    buffer_store_dwordx4 v[32:35], v20, s[60:63], 0 offen
    s_waitcnt lgkmcnt(0)
    buffer_store_dwordx4 v[36:39], v20, s[60:63], s75 offen
    s_add_u32 m0, s3, 4096
    s_add_u32 s77, s77, 8192
    s_and_b32 s77, s77, 0x3ffff
    buffer_load_dwordx4 v15, s[48:51], s77 offen lds
    s_add_u32 m0, s3, 5120
    s_add_u32 s77, s77, 8192
    buffer_load_dwordx4 v15, s[48:51], s77 offen lds
    s_add_u32 m0, s3, 6144
    s_add_u32 s77, s77, 8192
    buffer_load_dwordx4 v15, s[48:51], s77 offen lds
    s_add_u32 m0, s3, 7168
    s_add_u32 s77, s77, 8192
    buffer_load_dwordx4 v15, s[48:51], s77 offen lds
    s_branch L_page1
L_bail_3:
    s_mov_b32 s71, 0
    s_waitcnt vmcnt(0)
    s_branch L_ret_2
L_uwt:
    buffer_store_dwordx4 v[32:35], v20, s[60:63], 0 offen sc1
    buffer_store_dwordx4 v[36:39], v20, s[60:63], s75 offen sc1
    s_waitcnt vmcnt(0)
    buffer_store_dword v22, v3, s[60:63], 0 offen sc1
    s_branch L_uwt_r
L_bail_6:
    s_mov_b32 s71, 0
    s_waitcnt vmcnt(0)
    s_branch L_ret_5
L_bail_9:
    s_mov_b32 s71, 0
    s_waitcnt vmcnt(0)
    s_branch L_ret_8
L_bail_12:
    s_mov_b32 s71, 0
    s_waitcnt vmcnt(0)
    s_branch L_ret_11
L_bail_16:
    s_mov_b32 s71, 0
    s_waitcnt vmcnt(0)
    s_branch L_ret_15
L_bail_22:
    s_mov_b32 s71, 0
    s_waitcnt vmcnt(0)
    s_branch L_ret_21
L_slow_18:
L_spin_20:
    buffer_load_dword v2, v4, s[60:63], 0 offen sc1
    s_sub_u32 s71, s71, 1
    s_cbranch_scc1 L_bail_22
    s_waitcnt vmcnt(0)
    v_subrev_u32 v2, s70, v2
    v_cmp_le_u32 vcc, 16, v2
    s_nop 0
    s_cbranch_vccnz L_spin_20
L_ret_21:
    s_branch L_back_19
L_bail_25:
    s_mov_b32 s71, 0
    s_waitcnt vmcnt(0)
    s_branch L_ret_24
L_bail_30:
    s_mov_b32 s71, 0
    s_waitcnt vmcnt(0)
    s_branch L_ret_29
L_slow_26:
L_spin_28:
    buffer_load_dword v2, v4, s[60:63], 0 offen sc1
    s_sub_u32 s71, s71, 1
    s_cbranch_scc1 L_bail_30
    s_waitcnt vmcnt(0)
    v_subrev_u32 v2, s70, v2
    v_cmp_le_u32 vcc, 16, v2
    s_nop 0
    s_cbranch_vccnz L_spin_28
L_ret_29:
    s_branch L_back_27
L_bail_35:
    s_mov_b32 s71, 0
    s_waitcnt vmcnt(0)
    s_branch L_ret_34
L_slow_31:
L_spin_33:
    buffer_load_dword v2, v4, s[60:63], 0 offen sc1
    s_sub_u32 s71, s71, 1
    s_cbranch_scc1 L_bail_35
    s_waitcnt vmcnt(0)
    v_subrev_u32 v2, s70, v2
    v_cmp_le_u32 vcc, 16, v2
    s_nop 0
    s_cbranch_vccnz L_spin_33
L_ret_34:
    s_branch L_back_32
L_bail_40:
    s_mov_b32 s71, 0
    s_waitcnt vmcnt(0)
    s_branch L_ret_39
L_slow_36:
L_spin_38:
    buffer_load_dword v2, v4, s[60:63], 0 offen sc1
    s_sub_u32 s71, s71, 1
    s_cbranch_scc1 L_bail_40
    s_waitcnt vmcnt(0)
    v_subrev_u32 v2, s70, v2
    v_cmp_le_u32 vcc, 16, v2
    s_nop 0
    s_cbranch_vccnz L_spin_38
L_ret_39:
    s_branch L_back_37
L_bail_43:
    s_mov_b32 s71, 0
    s_waitcnt vmcnt(0)
    s_branch L_ret_42
L_bail_46:
    s_mov_b32 s71, 0
    s_waitcnt vmcnt(0)
    s_branch L_ret_45
L_bail_49:
    s_mov_b32 s71, 0
    s_waitcnt vmcnt(0)
    s_branch L_ret_48
L_bail_56:
    s_mov_b32 s71, 0
    s_waitcnt vmcnt(0)
    s_branch L_ret_55
L_slow_52:
L_spin_54:
    buffer_load_dword v2, v4, s[60:63], 0 offen sc1
    s_sub_u32 s71, s71, 1
    s_cbranch_scc1 L_bail_56
    s_waitcnt vmcnt(0)
    v_subrev_u32 v2, s70, v2
    v_cmp_le_u32 vcc, 16, v2
    s_nop 0
    s_cbranch_vccnz L_spin_54
L_ret_55:
    s_branch L_back_53
L_bail_61:
    s_mov_b32 s71, 0
    s_waitcnt vmcnt(0)
    s_branch L_ret_60
L_slow_57:
L_spin_59:
    buffer_load_dword v2, v4, s[60:63], 0 offen sc1
    s_sub_u32 s71, s71, 1
    s_cbranch_scc1 L_bail_61
    s_waitcnt vmcnt(0)
    v_subrev_u32 v2, s70, v2
    v_cmp_le_u32 vcc, 16, v2
    s_nop 0
    s_cbranch_vccnz L_spin_59
L_ret_60:
    s_branch L_back_58
L_bail_64:
    s_mov_b32 s71, 0
    s_waitcnt vmcnt(0)
    s_branch L_ret_63
L_bail_69:
    s_mov_b32 s71, 0
    s_waitcnt vmcnt(0)
    s_branch L_ret_68
L_slow_65:
L_spin_67:
    buffer_load_dword v2, v4, s[60:63], 0 offen sc1
    s_sub_u32 s71, s71, 1
    s_cbranch_scc1 L_bail_69
    s_waitcnt vmcnt(0)
    v_subrev_u32 v2, s70, v2
    v_cmp_le_u32 vcc, 16, v2
    s_nop 0
    s_cbranch_vccnz L_spin_67
L_ret_68:
    s_branch L_back_66
L_bail_74:
    s_mov_b32 s71, 0
    s_waitcnt vmcnt(0)
    s_branch L_ret_73
L_slow_70:
L_spin_72:
    buffer_load_dword v2, v4, s[60:63], 0 offen sc1
    s_sub_u32 s71, s71, 1
    s_cbranch_scc1 L_bail_74
    s_waitcnt vmcnt(0)
    v_subrev_u32 v2, s70, v2
    v_cmp_le_u32 vcc, 16, v2
    s_nop 0
    s_cbranch_vccnz L_spin_72
L_ret_73:
    s_branch L_back_71
L_bail_79:
    s_mov_b32 s71, 0
    s_waitcnt vmcnt(0)
    s_branch L_ret_78
L_slow_75:
L_spin_77:
    buffer_load_dword v2, v4, s[60:63], 0 offen sc1
    s_sub_u32 s71, s71, 1
    s_cbranch_scc1 L_bail_79
    s_waitcnt vmcnt(0)
    v_subrev_u32 v2, s70, v2
    v_cmp_le_u32 vcc, 16, v2
    s_nop 0
    s_cbranch_vccnz L_spin_77
L_ret_78:
    s_branch L_back_76
L_bail_82:
    s_mov_b32 s71, 0
    s_waitcnt vmcnt(0)
    s_branch L_ret_81
.p2align 12
L_page1:
L_hop_1:
    s_cbranch_execz L_hop_back0
    s_waitcnt vmcnt(13)
    s_barrier
    ds_read2_b32 v[128:129], v8 offset0:0 offset1:1
    ds_read2_b32 v[130:131], v8 offset0:2 offset1:3
    ds_read2_b32 v[132:133], v8 offset0:4 offset1:5
    s_mov_b32 s36, s4
    s_and_b32 s37, s5, 0xffff
    s_mov_b32 s38, 2097152
    s_mov_b32 s39, 0x20000
    s_add_u32 m0, s3, 8192
    s_add_u32 s77, s77, 8192
    s_and_b32 s77, s77, 0x3ffff
    buffer_load_dwordx4 v15, s[48:51], s77 offen lds
    ds_read2_b32 v[134:135], v8 offset0:6 offset1:7
    ds_read2_b32 v[136:137], v8 offset0:8 offset1:9
    ds_read2_b32 v[138:139], v8 offset0:10 offset1:11
    s_mov_b32 s44, s18
    s_and_b32 s45, s19, 0xffff
    s_mov_b32 s46, 1835008
    s_mov_b32 s47, 0x20000
    ds_read2_b32 v[140:141], v8 offset0:12 offset1:13
    ds_read2_b32 v[142:143], v8 offset0:14 offset1:15
    ds_read_b32 v120, v8 offset:64
    s_sub_u32 s72, s64, 6
    s_cselect_b32 s72, s64, s72
    s_add_u32 s72, s72, 8
    s_add_u32 m0, s3, 9216
    s_add_u32 s77, s77, 8192
    buffer_load_dwordx4 v15, s[48:51], s77 offen lds
    s_lshl_b32 s1, s72, 15
    s_add_u32 s72, s64, 1
    s_and_b32 s72, s72, 7
    ds_read2_b32 v[144:145], v8 offset0:128 offset1:129
    ds_read2_b32 v[146:147], v8 offset0:130 offset1:131
    ds_read2_b32 v[148:149], v8 offset0:132 offset1:133
    s_mul_i32 s0, s72, 57344
    s_mov_b32 s24, 14336
    s_mov_b32 s25, 458752
    s_lshl_b32 s72, s64, 15
    ds_read2_b32 v[150:151], v8 offset0:134 offset1:135
    ds_read2_b32 v[152:153], v8 offset0:136 offset1:137
    ds_read2_b32 v[154:155], v8 offset0:138 offset1:139
    s_add_u32 m0, s3, 10240
    s_add_u32 s77, s77, 8192
    buffer_load_dwordx4 v15, s[48:51], s77 offen lds
    s_cmp_ge_u32 s67, 14
    s_cselect_b32 s0, s72, s0
    s_cselect_b32 s24, 8192, s24
    s_cselect_b32 s25, 262144, s25
    s_cselect_b32 s46, 0, s46
    s_cselect_b64 s[44:45], s[48:49], s[44:45]
    s_cselect_b64 s[82:83], -1, 0
    s_cselect_b32 s79, 0, 32
    s_lshl_b32 s72, s64, 18
    s_add_u32 s56, s22, s72
    s_addc_u32 s57, s23, 0
    s_and_b32 s57, s57, 0xffff
    s_mov_b32 s58, 0x40000
    ds_read2_b32 v[156:157], v8 offset0:140 offset1:141
    ds_read2_b32 v[158:159], v8 offset0:142 offset1:143
    ds_read_b32 v121, v8 offset:576
    s_mov_b32 s59, 0x20000
    s_and_b32 s72, s67, 3
    s_lshl_b32 s81, s72, 4
    s_add_u32 s81, s81, s66
    s_add_u32 m0, s3, 11264
    s_add_u32 s77, s77, 8192
    buffer_load_dwordx4 v15, s[48:51], s77 offen lds
    s_and_b32 s72, s67, 12
    v_add_u32 v8, 1024, v8
    ds_read2_b32 v[160:161], v8 offset0:0 offset1:1
    ds_read2_b32 v[162:163], v8 offset0:2 offset1:3
    s_add_u32 s81, s81, s72
    s_lshl_b32 s72, s68, 7
    s_waitcnt vmcnt(10)
    v_xor_b32 v22, s70, v22
    v_cmp_le_u32 vcc, 16, v22
    s_nop 0
    s_cbranch_vccz L_ret_2
L_spin_1:
    buffer_load_dword v22, v4, s[52:55], 0 offen sc1
    s_sub_u32 s71, s71, 1
    s_cbranch_scc1 L_bail_3
    s_waitcnt vmcnt(0)
    v_xor_b32 v22, s70, v22
    v_cmp_le_u32 vcc, 16, v22
    s_nop 0
    s_cbranch_vccnz L_spin_1
L_ret_2:
    v_cmp_ne_u32 s[26:27], 0, v22
    s_lshl_b32 s74, s65, 2
    s_add_u32 s74, s74, s66
    s_lshl_b32 s74, s74, 2
    s_add_u32 s74, s74, 2097152
    v_mov_b32 v3, 2.0
    v_writelane_b32 v3, s74, 0
    s_add_u32 s70, s69, 1
    v_mov_b32 v22, s70
    s_cmp_lg_u64 s[26:27], 0
    s_cbranch_scc1 L_uwt
    s_waitcnt vmcnt(8)
    buffer_store_dword v22, v3, s[60:63], 0 offen
L_uwt_r:
    s_mov_b32 s74, 2097152
    v_lshl_add_u32 v4, v1, 3, s74
    s_add_u32 s81, s81, s72
    s_lshl_b32 s72, s81, 10
    v_lshl_add_u32 v7, v1, 4, s72
    v_lshlrev_b32 v16, 2, v18
    ds_read2_b32 v[164:165], v8 offset0:4 offset1:5
    s_add_u32 m0, s3, 12288
    s_add_u32 s77, s77, 8192
    s_and_b32 s77, s77, 0x3ffff
    buffer_load_dwordx4 v15, s[48:51], s77 offen lds
    ds_read2_b32 v[166:167], v8 offset0:6 offset1:7
    ds_read2_b32 v[168:169], v8 offset0:8 offset1:9
    v_xor_b32 v16, v16, v17
    v_lshlrev_b32 v16, 4, v16
    s_movk_i32 s72, 3584
    v_mad_u32_u24 v16, v18, s72, v16
    s_mul_i32 s72, s66, 458752
    s_lshl_b32 s73, s67, 8
    ds_read2_b32 v[170:171], v8 offset0:10 offset1:11
    ds_read2_b32 v[172:173], v8 offset0:12 offset1:13
    s_add_u32 m0, s3, 13312
    s_add_u32 s77, s77, 8192
    buffer_load_dwordx4 v15, s[48:51], s77 offen lds
    ds_read2_b32 v[174:175], v8 offset0:14 offset1:15
    ds_read_b32 v122, v8 offset:64
    s_add_u32 s72, s72, s73
    v_add_u32 v16, s72, v16
    s_waitcnt lgkmcnt(15)
    v_alignbit_b32 v128, v129, v128, v21
    buffer_load_dwordx2 v[92:93], v4, s[60:63], 0 offen sc1
    v_alignbit_b32 v129, v130, v129, v21
    v_alignbit_b32 v130, v131, v130, v21
    v_alignbit_b32 v131, v132, v131, v21
    ds_read2_b32 v[176:177], v8 offset0:128 offset1:129
    ds_read2_b32 v[178:179], v8 offset0:130 offset1:131
    ds_read2_b32 v[180:181], v8 offset0:132 offset1:133
    v_cndmask_b32 v16, v16, v15, s[82:83]
    v_bfe_u32 v2, v1, 2, 2
    v_lshl_add_u32 v23, v18, 2, v2
    v_lshl_add_u32 v9, v23, 7, s3
    s_add_u32 m0, s3, 14336
    s_add_u32 s77, s77, 8192
    buffer_load_dwordx4 v15, s[48:51], s77 offen lds
    v_lshrrev_b32 v2, 1, v2
    v_lshl_add_u32 v9, v2, 5, v9
    ds_read2_b32 v[182:183], v8 offset0:134 offset1:135
    ds_read2_b32 v[184:185], v8 offset0:136 offset1:137
    ds_read2_b32 v[186:187], v8 offset0:138 offset1:139
    v_and_b32 v2, 3, v1
    v_lshl_add_u32 v9, v2, 3, v9
    v_xor_b32 v10, 32, v9
    v_and_b32 v23, 1, v0
    v_mul_u32_u24 v23, 2368, v23
    v_lshrrev_b32 v2, 1, v0
    ds_read2_b32 v[188:189], v8 offset0:140 offset1:141
    ds_read2_b32 v[190:191], v8 offset0:142 offset1:143
    ds_read_b32 v123, v8 offset:576
    v_lshl_add_u32 v23, v2, 4, v23
    v_add_u32 v13, 139504, v23
    v_alignbit_b32 v144, v145, v144, v21
    v_alignbit_b32 v145, v146, v145, v21
    v_alignbit_b32 v146, v147, v146, v21
    v_alignbit_b32 v147, v148, v147, v21
    s_add_u32 m0, s3, 15360
    s_add_u32 s77, s77, 8192
    buffer_load_dwordx4 v15, s[48:51], s77 offen lds
    v_add_u32 v8, 1024, v8
    ds_read2_b32 v[192:193], v8 offset0:0 offset1:1
    ds_read2_b32 v[194:195], v8 offset0:2 offset1:3
    s_lshr_b32 s72, s66, 1
    s_mul_i32 s72, s72, 4736
    s_and_b32 s73, s66, 1
    s_lshl_b32 s73, s73, 7
    s_sub_u32 s72, s72, s73
    s_add_u32 s72, s72, 139488
    ds_read2_b32 v[196:197], v8 offset0:4 offset1:5
    ds_read2_b32 v[198:199], v8 offset0:6 offset1:7
    ds_read2_b32 v[200:201], v8 offset0:8 offset1:9
    v_bfe_u32 v23, v1, 1, 2
    v_and_b32 v2, 1, v1
    v_lshl_add_u32 v23, v2, 2, v23
    v_and_or_b32 v23, v1, 8, v23
    v_lshlrev_b32 v2, 1, v18
    v_sub_u32 v2, v23, v2
    ds_read2_b32 v[202:203], v8 offset0:10 offset1:11
    ds_read2_b32 v[204:205], v8 offset0:12 offset1:13
    s_add_u32 m0, s3, 16384
    s_add_u32 s77, s77, 8192
    s_and_b32 s77, s77, 0x3ffff
    buffer_load_dwordx4 v15, s[48:51], s77 offen lds
    ds_read2_b32 v[206:207], v8 offset0:14 offset1:15
    ds_read_b32 v124, v8 offset:64
    v_lshl_add_u32 v11, v2, 4, s72
    s_lshl_b32 s72, s66, 9
    s_waitcnt lgkmcnt(15)
    v_alignbit_b32 v160, v161, v160, v21
    v_alignbit_b32 v161, v162, v161, v21
    v_alignbit_b32 v162, v163, v162, v21
    v_alignbit_b32 v163, v164, v163, v21
    ds_read2_b32 v[208:209], v8 offset0:128 offset1:129
    ds_read2_b32 v[210:211], v8 offset0:130 offset1:131
    ds_read2_b32 v[212:213], v8 offset0:132 offset1:133
    s_add_u32 s72, s72, 139512
    v_lshl_add_u32 v12, v23, 4, s72
    v_lshrrev_b32 v2, 1, v18
    v_mul_u32_u24 v2, 2368, v2
    v_add_u32 v12, v12, v2
    v_and_b32 v2, 1, v18
    ds_read2_b32 v[214:215], v8 offset0:134 offset1:135
    ds_read2_b32 v[216:217], v8 offset0:136 offset1:137
    ds_read2_b32 v[218:219], v8 offset0:138 offset1:139
    s_add_u32 m0, s3, 17408
    s_add_u32 s77, s77, 8192
    buffer_load_dwordx4 v15, s[48:51], s77 offen lds
    v_lshlrev_b32 v2, 3, v2
    v_sub_u32 v12, v12, v2
    s_lshl_b32 s72, s66, 13
    s_add_u32 s72, s72, 131072
    v_lshl_add_u32 v110, v1, 4, s72
    s_lshl_b32 s72, s66, 11
    ds_read2_b32 v[220:221], v8 offset0:140 offset1:141
    ds_read2_b32 v[222:223], v8 offset0:142 offset1:143
    ds_read_b32 v125, v8 offset:576
    s_add_u32 s72, s72, 131072
    s_lshl_b32 s74, s65, 13
    s_add_u32 s75, s74, 4096
    s_waitcnt vmcnt(4)
    v_subrev_u32 v92, s70, v92
    v_subrev_u32 v93, s70, v93
    v_max_u32 v92, v92, v93
    v_cmp_le_u32 vcc, 16, v92
    s_nop 0
    s_cbranch_vccz L_ret_5
L_spin_4:
    buffer_load_dwordx2 v[92:93], v4, s[60:63], 0 offen sc1
    s_sub_u32 s71, s71, 1
    s_cbranch_scc1 L_bail_6
    s_waitcnt vmcnt(0)
    v_subrev_u32 v92, s70, v92
    v_subrev_u32 v93, s70, v93
    v_max_u32 v92, v92, v93
    v_cmp_le_u32 vcc, 16, v92
    s_nop 0
    s_cbranch_vccnz L_spin_4
L_ret_5:
    buffer_load_dwordx4 v[88:91], v5, s[60:63], s74 offen sc1
    buffer_load_dwordx4 v[92:95], v5, s[60:63], s75 offen sc1
    s_lshl_b32 s84, s76, 13
    s_add_u32 s84, s84, 2097152
    s_add_u32 s85, s84, 4096
    buffer_store_dwordx4 v[116:119], v5, s[52:55], s84 offen sc1
    buffer_store_dwordx4 v[116:119], v5, s[52:55], s85 offen sc1
    v_lshl_add_u32 v111, v1, 4, s72
    v_alignbit_b32 v176, v177, v176, v21
    v_alignbit_b32 v177, v178, v177, v21
    s_add_u32 m0, s3, 18432
    s_add_u32 s77, s77, 8192
    buffer_load_dwordx4 v15, s[48:51], s77 offen lds
    v_alignbit_b32 v178, v179, v178, v21
    v_alignbit_b32 v179, v180, v179, v21
    v_add_u32 v8, 1024, v8
    ds_read2_b32 v[224:225], v8 offset0:0 offset1:1
    ds_read2_b32 v[226:227], v8 offset0:2 offset1:3
    s_waitcnt lgkmcnt(15)
    v_alignbit_b32 v192, v193, v192, v21
    s_add_u32 m0, s3, 19456
    s_add_u32 s77, s77, 8192
    buffer_load_dwordx4 v15, s[48:51], s77 offen lds
    ds_read2_b32 v[228:229], v8 offset0:4 offset1:5
    ds_read2_b32 v[230:231], v8 offset0:6 offset1:7
    ds_read2_b32 v[232:233], v8 offset0:8 offset1:9
    v_alignbit_b32 v193, v194, v193, v21
    ds_read2_b32 v[234:235], v8 offset0:10 offset1:11
    ds_read2_b32 v[236:237], v8 offset0:12 offset1:13
    s_add_u32 m0, s3, 20480
    s_add_u32 s77, s77, 8192
    s_and_b32 s77, s77, 0x3ffff
    buffer_load_dwordx4 v15, s[48:51], s77 offen lds
    ds_read2_b32 v[238:239], v8 offset0:14 offset1:15
    ds_read_b32 v126, v8 offset:64
    v_alignbit_b32 v194, v195, v194, v21
    v_alignbit_b32 v195, v196, v195, v21
    ds_read2_b32 v[240:241], v8 offset0:128 offset1:129
    s_add_u32 m0, s3, 21504
    s_add_u32 s77, s77, 8192
    buffer_load_dwordx4 v15, s[48:51], s77 offen lds
    ds_read2_b32 v[242:243], v8 offset0:130 offset1:131
    ds_read2_b32 v[244:245], v8 offset0:132 offset1:133
    s_waitcnt lgkmcnt(15)
    v_alignbit_b32 v208, v209, v208, v21
    ds_read2_b32 v[246:247], v8 offset0:134 offset1:135
    ds_read2_b32 v[248:249], v8 offset0:136 offset1:137
    ds_read2_b32 v[250:251], v8 offset0:138 offset1:139
    s_add_u32 m0, s3, 22528
    s_add_u32 s77, s77, 8192
    buffer_load_dwordx4 v15, s[48:51], s77 offen lds
    v_alignbit_b32 v209, v210, v209, v21
    ds_read2_b32 v[252:253], v8 offset0:140 offset1:141
    ds_read2_b32 v[254:255], v8 offset0:142 offset1:143
    ds_read_b32 v127, v8 offset:576
    v_alignbit_b32 v210, v211, v210, v21
    v_alignbit_b32 v211, v212, v211, v21
    s_add_u32 m0, s3, 23552
    s_add_u32 s77, s77, 8192
    buffer_load_dwordx4 v15, s[48:51], s77 offen lds
    s_waitcnt lgkmcnt(15)
    v_alignbit_b32 v224, v225, v224, v21
    v_alignbit_b32 v225, v226, v225, v21
    v_alignbit_b32 v226, v227, v226, v21
    v_alignbit_b32 v227, v228, v227, v21
    s_waitcnt lgkmcnt(8)
    v_alignbit_b32 v240, v241, v240, v21
    s_waitcnt lgkmcnt(7)
    v_alignbit_b32 v241, v242, v241, v21
    s_add_u32 m0, s3, 24576
    s_add_u32 s77, s77, 8192
    s_and_b32 s77, s77, 0x3ffff
    buffer_load_dwordx4 v15, s[48:51], s77 offen lds
    v_alignbit_b32 v242, v243, v242, v21
    s_waitcnt lgkmcnt(6)
    v_alignbit_b32 v243, v244, v243, v21
    s_mov_b64 exec, 0
    s_cmp_eq_u32 s66, 0
    s_cbranch_scc1 L_hop_5
    s_cmp_eq_u32 s66, 1
    s_cbranch_scc1 L_hop_6
    s_cmp_eq_u32 s66, 2
    s_cbranch_scc1 L_hop_7
    s_branch L_hop_8
L_hop_back1:
    s_mov_b64 exec, -1
    s_waitcnt vmcnt(10)
    ds_write_b128 v13, v[88:91]
    s_waitcnt vmcnt(9)
    ds_write_b128 v13, v[92:95] offset:4736
    s_add_u32 s70, s69, 1
    v_mov_b32 v2, s70
    s_waitcnt lgkmcnt(0)
    s_barrier
    ds_read_b128 v[56:59], v11 offset:2384
    ds_read_b128 v[60:63], v11 offset:2640
    ds_read_b128 v[64:67], v11 offset:2896
    ds_read_b128 v[68:71], v11 offset:3152
    ds_read_b128 v[72:75], v11 offset:3408
    ds_read_b128 v[76:79], v11 offset:3664
    ds_read_b128 v[80:83], v11 offset:3920
    ds_read_b128 v[84:87], v11 offset:4176
    s_waitcnt lgkmcnt(7)
    v_mfma_f32_16x16x32_bf16 v[24:27], v[128:131], v[56:59], 0
    ds_read_b64_tr_b16 a[128:129], v9 offset:0
    ds_read_b64_tr_b16 a[130:131], v9 offset:2048
    v_mfma_f32_16x16x32_bf16 v[28:31], v[144:147], v[56:59], 0
    ds_read_b64_tr_b16 a[132:133], v10 offset:0
    ds_read_b64_tr_b16 a[134:135], v10 offset:2048
    v_mfma_f32_16x16x32_bf16 v[32:35], v[160:163], v[56:59], 0
    ds_read_b64_tr_b16 a[136:137], v9 offset:64
    ds_read_b64_tr_b16 a[138:139], v9 offset:2112
    v_mfma_f32_16x16x32_bf16 v[36:39], v[176:179], v[56:59], 0
    ds_read_b64_tr_b16 a[140:141], v10 offset:64
    ds_read_b64_tr_b16 a[142:143], v10 offset:2112
    v_alignbit_b32 v132, v133, v132, v21
    v_mfma_f32_16x16x32_bf16 v[40:43], v[192:195], v[56:59], 0
    s_lshl_b32 s72, s64, 18
    buffer_load_dwordx4 v[112:115], v7, s[36:39], s72 offen
    v_mfma_f32_16x16x32_bf16 v[44:47], v[208:211], v[56:59], 0
    ds_read_b64_tr_b16 a[144:145], v9 offset:4096
    ds_read_b64_tr_b16 a[146:147], v9 offset:6144
    v_mfma_f32_16x16x32_bf16 v[48:51], v[224:227], v[56:59], 0
    ds_read_b64_tr_b16 a[148:149], v10 offset:4096
    ds_read_b64_tr_b16 a[150:151], v10 offset:6144
    v_alignbit_b32 v133, v134, v133, v21
    v_mfma_f32_16x16x32_bf16 v[52:55], v[240:243], v[56:59], 0
    s_waitcnt lgkmcnt(12)
    ds_read_b128 v[56:59], v11 offset:16
    ds_read_b64_tr_b16 a[152:153], v9 offset:4160
    v_mfma_f32_16x16x32_bf16 v[28:31], v[128:131], v[60:63], v[28:31]
    s_bitset1_b32 s72, 16
    buffer_load_dwordx4 v[116:119], v7, s[36:39], s72 offen
    v_alignbit_b32 v134, v135, v134, v21
    v_mfma_f32_16x16x32_bf16 v[32:35], v[144:147], v[60:63], v[32:35]
    ds_read_b64_tr_b16 a[154:155], v9 offset:6208
    v_alignbit_b32 v135, v136, v135, v21
    v_mfma_f32_16x16x32_bf16 v[36:39], v[160:163], v[60:63], v[36:39]
    ds_read_b64_tr_b16 a[156:157], v10 offset:4160
    ds_read_b64_tr_b16 a[158:159], v10 offset:6208
    v_mfma_f32_16x16x32_bf16 v[40:43], v[176:179], v[60:63], v[40:43]
    ds_read_b64_tr_b16 a[160:161], v9 offset:8192
    ds_read_b64_tr_b16 a[162:163], v9 offset:10240
    v_alignbit_b32 v148, v149, v148, v21
    v_mfma_f32_16x16x32_bf16 v[44:47], v[192:195], v[60:63], v[44:47]
    ds_read_b64_tr_b16 a[164:165], v10 offset:8192
    ds_read_b64_tr_b16 a[166:167], v10 offset:10240
    v_mfma_f32_16x16x32_bf16 v[48:51], v[208:211], v[60:63], v[48:51]
    ds_read_b64_tr_b16 a[168:169], v9 offset:8256
    ds_read_b64_tr_b16 a[170:171], v9 offset:10304
    v_mfma_f32_16x16x32_bf16 v[52:55], v[224:227], v[60:63], v[52:55]
    ds_read_b128 v[60:63], v11 offset:272
    ds_read_b64_tr_b16 a[172:173], v10 offset:8256
    v_alignbit_b32 v149, v150, v149, v21
    v_mfma_f32_16x16x32_bf16 v[32:35], v[128:131], v[64:67], v[32:35]
    ds_read_b64_tr_b16 a[174:175], v10 offset:10304
    v_alignbit_b32 v150, v151, v150, v21
    v_mfma_f32_16x16x32_bf16 v[36:39], v[144:147], v[64:67], v[36:39]
    s_add_u32 m0, s3, 25600
    v_alignbit_b32 v151, v152, v151, v21
    v_alignbit_b32 v164, v165, v164, v21
    v_alignbit_b32 v165, v166, v165, v21
    v_mfma_f32_16x16x32_bf16 v[40:43], v[160:163], v[64:67], v[40:43]
    s_add_u32 s77, s77, 8192
    v_alignbit_b32 v166, v167, v166, v21
    v_alignbit_b32 v167, v168, v167, v21
    v_mfma_f32_16x16x32_bf16 v[44:47], v[176:179], v[64:67], v[44:47]
    buffer_load_dwordx4 v15, s[48:51], s77 offen lds
    v_mfma_f32_16x16x32_bf16 v[48:51], v[192:195], v[64:67], v[48:51]
    s_add_u32 m0, s3, 26624
    v_alignbit_b32 v180, v181, v180, v21
    v_alignbit_b32 v181, v182, v181, v21
    v_alignbit_b32 v182, v183, v182, v21
    v_mfma_f32_16x16x32_bf16 v[52:55], v[208:211], v[64:67], v[52:55]
    s_add_u32 s77, s77, 8192
    ds_read_b128 v[64:67], v11 offset:528
    v_alignbit_b32 v183, v184, v183, v21
    v_mfma_f32_16x16x32_bf16 v[36:39], v[128:131], v[68:71], v[36:39]
    buffer_load_dwordx4 v15, s[48:51], s77 offen lds
    v_mfma_f32_16x16x32_bf16 v[40:43], v[144:147], v[68:71], v[40:43]
    s_add_u32 m0, s3, 27648
    v_alignbit_b32 v196, v197, v196, v21
    v_alignbit_b32 v197, v198, v197, v21
    v_alignbit_b32 v198, v199, v198, v21
    v_mfma_f32_16x16x32_bf16 v[44:47], v[160:163], v[68:71], v[44:47]
    s_add_u32 s77, s77, 8192
    v_alignbit_b32 v199, v200, v199, v21
    v_alignbit_b32 v212, v213, v212, v21
    v_mfma_f32_16x16x32_bf16 v[48:51], v[176:179], v[68:71], v[48:51]
    buffer_load_dwordx4 v15, s[48:51], s77 offen lds
    v_alignbit_b32 v213, v214, v213, v21
    v_mfma_f32_16x16x32_bf16 v[52:55], v[192:195], v[68:71], v[52:55]
    s_add_u32 m0, s3, 28672
    ds_read_b128 v[68:71], v11 offset:784
    v_alignbit_b32 v214, v215, v214, v21
    v_mfma_f32_16x16x32_bf16 v[40:43], v[128:131], v[72:75], v[40:43]
    s_add_u32 s77, s77, 8192
    v_alignbit_b32 v215, v216, v215, v21
    v_alignbit_b32 v228, v229, v228, v21
    v_mfma_f32_16x16x32_bf16 v[44:47], v[144:147], v[72:75], v[44:47]
    s_and_b32 s77, s77, 0x3ffff
    v_alignbit_b32 v229, v230, v229, v21
    v_alignbit_b32 v230, v231, v230, v21
    v_alignbit_b32 v231, v232, v231, v21
    v_mfma_f32_16x16x32_bf16 v[48:51], v[160:163], v[72:75], v[48:51]
    buffer_load_dwordx4 v15, s[48:51], s77 offen lds
    v_mfma_f32_16x16x32_bf16 v[52:55], v[176:179], v[72:75], v[52:55]
    ds_read_b128 v[72:75], v11 offset:1040
    ds_read_b64_tr_b16 a[176:177], v9 offset:12288
    v_mfma_f32_16x16x32_bf16 v[44:47], v[128:131], v[76:79], v[44:47]
    ds_read_b64_tr_b16 a[178:179], v9 offset:14336
    v_alignbit_b32 v244, v245, v244, v21
    v_alignbit_b32 v245, v246, v245, v21
    v_mfma_f32_16x16x32_bf16 v[48:51], v[144:147], v[76:79], v[48:51]
    ds_read_b64_tr_b16 a[180:181], v10 offset:12288
    ds_read_b64_tr_b16 a[182:183], v10 offset:14336
    v_mfma_f32_16x16x32_bf16 v[52:55], v[160:163], v[76:79], v[52:55]
    ds_read_b128 v[76:79], v11 offset:1296
    ds_read_b64_tr_b16 a[184:185], v9 offset:12352
    v_alignbit_b32 v246, v247, v246, v21
    v_mfma_f32_16x16x32_bf16 v[48:51], v[128:131], v[80:83], v[48:51]
    ds_read_b64_tr_b16 a[186:187], v9 offset:14400
    v_alignbit_b32 v247, v248, v247, v21
    v_mfma_f32_16x16x32_bf16 v[52:55], v[144:147], v[80:83], v[52:55]
    ds_read_b128 v[80:83], v11 offset:1552
    ds_read_b64_tr_b16 a[188:189], v10 offset:12352
    v_mfma_f32_16x16x32_bf16 v[52:55], v[128:131], v[84:87], v[52:55]
    s_waitcnt lgkmcnt(11)
    ds_read_b128 v[84:87], v11 offset:1808
    ds_read_b64_tr_b16 a[190:191], v10 offset:14400
    v_mfma_f32_16x16x32_bf16 v[24:27], v[132:135], v[56:59], v[24:27]
    s_add_u32 m0, s3, 29696
    v_mfma_f32_16x16x32_bf16 v[28:31], v[148:151], v[56:59], v[28:31]
    s_add_u32 s77, s77, 8192
    v_alignbit_b32 v136, v137, v136, v21
    v_alignbit_b32 v137, v138, v137, v21
    v_mfma_f32_16x16x32_bf16 v[32:35], v[164:167], v[56:59], v[32:35]
    buffer_load_dwordx4 v15, s[48:51], s77 offen lds
    v_mfma_f32_16x16x32_bf16 v[36:39], v[180:183], v[56:59], v[36:39]
    s_add_u32 m0, s3, 30720
    v_alignbit_b32 v138, v139, v138, v21
    v_alignbit_b32 v139, v140, v139, v21
    v_mfma_f32_16x16x32_bf16 v[40:43], v[196:199], v[56:59], v[40:43]
    s_add_u32 s77, s77, 8192
    v_alignbit_b32 v152, v153, v152, v21
    v_alignbit_b32 v153, v154, v153, v21
    v_mfma_f32_16x16x32_bf16 v[44:47], v[212:215], v[56:59], v[44:47]
    buffer_load_dwordx4 v15, s[48:51], s77 offen lds
    v_mfma_f32_16x16x32_bf16 v[48:51], v[228:231], v[56:59], v[48:51]
    s_add_u32 m0, s3, 31744
    v_alignbit_b32 v154, v155, v154, v21
    v_alignbit_b32 v155, v156, v155, v21
    v_mfma_f32_16x16x32_bf16 v[52:55], v[244:247], v[56:59], v[52:55]
    s_add_u32 s77, s77, 8192
    ds_read_b128 v[56:59], v11 offset:2368
    v_alignbit_b32 v168, v169, v168, v21
    v_mfma_f32_16x16x32_bf16 v[28:31], v[132:135], v[60:63], v[28:31]
    buffer_load_dwordx4 v15, s[48:51], s77 offen lds
    v_mfma_f32_16x16x32_bf16 v[32:35], v[148:151], v[60:63], v[32:35]
    v_alignbit_b32 v169, v170, v169, v21
    v_alignbit_b32 v170, v171, v170, v21
    v_mfma_f32_16x16x32_bf16 v[36:39], v[164:167], v[60:63], v[36:39]
    s_add_u32 m0, s3, 0
    v_alignbit_b32 v171, v172, v171, v21
    v_alignbit_b32 v184, v185, v184, v21
    v_mfma_f32_16x16x32_bf16 v[40:43], v[180:183], v[60:63], v[40:43]
    s_mov_b32 s77, s1
    v_alignbit_b32 v185, v186, v185, v21
    v_alignbit_b32 v186, v187, v186, v21
    v_mfma_f32_16x16x32_bf16 v[44:47], v[196:199], v[60:63], v[44:47]
    buffer_load_dwordx4 v15, s[48:51], s77 offen lds
    v_mfma_f32_16x16x32_bf16 v[48:51], v[212:215], v[60:63], v[48:51]
    s_waitcnt vmcnt(15)
    ds_read_b64_tr_b16 a[192:193], v9 offset:16384
    ds_read_b64_tr_b16 a[194:195], v9 offset:18432
    v_mfma_f32_16x16x32_bf16 v[52:55], v[228:231], v[60:63], v[52:55]
    s_waitcnt lgkmcnt(4)
    ds_read_b128 v[60:63], v11 offset:2624
    ds_read_b64_tr_b16 a[196:197], v10 offset:16384
    v_mfma_f32_16x16x32_bf16 v[32:35], v[132:135], v[64:67], v[32:35]
    s_barrier
    v_mfma_f32_16x16x32_bf16 v[36:39], v[148:151], v[64:67], v[36:39]
    buffer_store_dword v2, v14, s[52:55], 0 offen sc1
    v_mfma_f32_16x16x32_bf16 v[40:43], v[164:167], v[64:67], v[40:43]
    ds_read_b64_tr_b16 a[198:199], v10 offset:18432
    v_alignbit_b32 v187, v188, v187, v21
    v_mfma_f32_16x16x32_bf16 v[44:47], v[180:183], v[64:67], v[44:47]
    ds_read_b64_tr_b16 a[200:201], v9 offset:16448
    ds_read_b64_tr_b16 a[202:203], v9 offset:18496
    v_mfma_f32_16x16x32_bf16 v[48:51], v[196:199], v[64:67], v[48:51]
    ds_read_b64_tr_b16 a[204:205], v10 offset:16448
    ds_read_b64_tr_b16 a[206:207], v10 offset:18496
    v_mfma_f32_16x16x32_bf16 v[52:55], v[212:215], v[64:67], v[52:55]
    s_add_u32 m0, s3, 1024
    ds_read_b128 v[64:67], v11 offset:2880
    v_alignbit_b32 v200, v201, v200, v21
    v_mfma_f32_16x16x32_bf16 v[36:39], v[132:135], v[68:71], v[36:39]
    s_add_u32 s77, s77, 8192
    v_alignbit_b32 v201, v202, v201, v21
    v_alignbit_b32 v202, v203, v202, v21
    v_mfma_f32_16x16x32_bf16 v[40:43], v[148:151], v[68:71], v[40:43]
    buffer_load_dwordx4 v15, s[48:51], s77 offen lds
    v_mfma_f32_16x16x32_bf16 v[44:47], v[164:167], v[68:71], v[44:47]
    s_add_u32 m0, s3, 2048
    v_alignbit_b32 v203, v204, v203, v21
    v_alignbit_b32 v216, v217, v216, v21
    v_mfma_f32_16x16x32_bf16 v[48:51], v[180:183], v[68:71], v[48:51]
    s_add_u32 s77, s77, 8192
    v_alignbit_b32 v217, v218, v217, v21
    v_alignbit_b32 v218, v219, v218, v21
    v_mfma_f32_16x16x32_bf16 v[52:55], v[196:199], v[68:71], v[52:55]
    ds_read_b128 v[68:71], v11 offset:3136
    v_alignbit_b32 v219, v220, v219, v21
    v_mfma_f32_16x16x32_bf16 v[40:43], v[132:135], v[72:75], v[40:43]
    buffer_load_dwordx4 v15, s[48:51], s77 offen lds
    v_mfma_f32_16x16x32_bf16 v[44:47], v[148:151], v[72:75], v[44:47]
    s_add_u32 m0, s3, 3072
    v_alignbit_b32 v232, v233, v232, v21
    v_alignbit_b32 v233, v234, v233, v21
    v_mfma_f32_16x16x32_bf16 v[48:51], v[164:167], v[72:75], v[48:51]
    s_add_u32 s77, s77, 8192
    v_alignbit_b32 v234, v235, v234, v21
    v_alignbit_b32 v235, v236, v235, v21
    v_mfma_f32_16x16x32_bf16 v[52:55], v[180:183], v[72:75], v[52:55]
    ds_read_b128 v[72:75], v11 offset:3392
    v_alignbit_b32 v248, v249, v248, v21
    v_mfma_f32_16x16x32_bf16 v[44:47], v[132:135], v[76:79], v[44:47]
    buffer_load_dwordx4 v15, s[48:51], s77 offen lds
    v_mfma_f32_16x16x32_bf16 v[48:51], v[148:151], v[76:79], v[48:51]
    v_alignbit_b32 v249, v250, v249, v21
    v_alignbit_b32 v250, v251, v250, v21
    v_mfma_f32_16x16x32_bf16 v[52:55], v[164:167], v[76:79], v[52:55]
L_hop_2:
    s_cbranch_execz L_hop_back0
    s_add_u32 m0, s3, 4096
    ds_read_b128 v[76:79], v11 offset:3648
    v_alignbit_b32 v251, v252, v251, v21
    v_mfma_f32_16x16x32_bf16 v[48:51], v[132:135], v[80:83], v[48:51]
    s_mov_b32 s77, s0
    v_mfma_f32_16x16x32_bf16 v[52:55], v[148:151], v[80:83], v[52:55]
    ds_read_b128 v[80:83], v11 offset:3904
    v_mfma_f32_16x16x32_bf16 v[52:55], v[132:135], v[84:87], v[52:55]
    s_waitcnt lgkmcnt(4)
    ds_read_b128 v[84:87], v11 offset:4160
    v_mfma_f32_16x16x32_bf16 v[24:27], v[136:139], v[56:59], v[24:27]
    buffer_load_dwordx4 v16, s[44:47], s77 offen lds
    v_mfma_f32_16x16x32_bf16 v[28:31], v[152:155], v[56:59], v[28:31]
    s_waitcnt vmcnt(16)
    ds_read_b64_tr_b16 a[208:209], v9 offset:20480
    ds_read_b64_tr_b16 a[210:211], v9 offset:22528
    v_mfma_f32_16x16x32_bf16 v[32:35], v[168:171], v[56:59], v[32:35]
    ds_read_b64_tr_b16 a[212:213], v10 offset:20480
    ds_read_b64_tr_b16 a[214:215], v10 offset:22528
    v_mfma_f32_16x16x32_bf16 v[36:39], v[184:187], v[56:59], v[36:39]
    ds_read_b64_tr_b16 a[216:217], v9 offset:20544
    ds_read_b64_tr_b16 a[218:219], v9 offset:22592
    v_alignbit_b32 v140, v141, v140, v21
    v_mfma_f32_16x16x32_bf16 v[40:43], v[200:203], v[56:59], v[40:43]
    ds_read_b64 v[96:97], v12 offset:0
    ds_read_b64 v[98:99], v12 offset:4736
    v_mfma_f32_16x16x32_bf16 v[44:47], v[216:219], v[56:59], v[44:47]
    ds_read_b64 v[100:101], v12 offset:256
    ds_read_b64 v[102:103], v12 offset:4992
    v_mfma_f32_16x16x32_bf16 v[48:51], v[232:235], v[56:59], v[48:51]
    ds_read_b64_tr_b16 a[220:221], v10 offset:20544
    ds_read_b64_tr_b16 a[222:223], v10 offset:22592
    v_alignbit_b32 v141, v142, v141, v21
    v_mfma_f32_16x16x32_bf16 v[52:55], v[248:251], v[56:59], v[52:55]
    s_add_u32 m0, s3, 5120
    ds_read_b128 v[56:59], v11 offset:0
    v_alignbit_b32 v142, v143, v142, v21
    v_mfma_f32_16x16x32_bf16 v[28:31], v[136:139], v[60:63], v[28:31]
    s_add_u32 s77, s77, s24
    v_alignbit_b32 v143, v120, v143, v21
    v_alignbit_b32 v156, v157, v156, v21
    v_alignbit_b32 v157, v158, v157, v21
    v_mfma_f32_16x16x32_bf16 v[32:35], v[152:155], v[60:63], v[32:35]
    buffer_load_dwordx4 v16, s[44:47], s77 offen lds
    v_mfma_f32_16x16x32_bf16 v[36:39], v[168:171], v[60:63], v[36:39]
    s_add_u32 m0, s3, 6144
    v_xor_b32 v16, s79, v16
    v_alignbit_b32 v158, v159, v158, v21
    v_mfma_f32_16x16x32_bf16 v[40:43], v[184:187], v[60:63], v[40:43]
    s_add_u32 s77, s77, s24
    v_alignbit_b32 v159, v121, v159, v21
    v_alignbit_b32 v172, v173, v172, v21
    v_alignbit_b32 v173, v174, v173, v21
    v_mfma_f32_16x16x32_bf16 v[44:47], v[200:203], v[60:63], v[44:47]
    buffer_load_dwordx4 v16, s[44:47], s77 offen lds
    v_mfma_f32_16x16x32_bf16 v[48:51], v[216:219], v[60:63], v[48:51]
    s_add_u32 m0, s3, 7168
    v_alignbit_b32 v174, v175, v174, v21
    v_alignbit_b32 v175, v122, v175, v21
    v_mfma_f32_16x16x32_bf16 v[52:55], v[232:235], v[60:63], v[52:55]
    s_waitcnt lgkmcnt(13)
    ds_read_b128 v[60:63], v11 offset:256
    v_alignbit_b32 v188, v189, v188, v21
    v_alignbit_b32 v189, v190, v189, v21
    v_mfma_f32_16x16x32_bf16 v[32:35], v[136:139], v[64:67], v[32:35]
    s_add_u32 s77, s77, s24
    v_alignbit_b32 v190, v191, v190, v21
    v_alignbit_b32 v191, v123, v191, v21
    v_mfma_f32_16x16x32_bf16 v[36:39], v[152:155], v[64:67], v[36:39]
    buffer_load_dwordx4 v16, s[44:47], s77 offen lds
    v_alignbit_b32 v204, v205, v204, v21
    v_mfma_f32_16x16x32_bf16 v[40:43], v[168:171], v[64:67], v[40:43]
    v_xor_b32 v16, s79, v16
    v_alignbit_b32 v205, v206, v205, v21
    v_mfma_f32_16x16x32_bf16 v[44:47], v[184:187], v[64:67], v[44:47]
    s_add_u32 m0, s3, 8192
    v_alignbit_b32 v206, v207, v206, v21
    v_alignbit_b32 v207, v124, v207, v21
    v_mfma_f32_16x16x32_bf16 v[48:51], v[200:203], v[64:67], v[48:51]
    s_add_u32 s77, s77, s24
    v_alignbit_b32 v220, v221, v220, v21
    v_alignbit_b32 v221, v222, v221, v21
    v_alignbit_b32 v222, v223, v222, v21
    v_mfma_f32_16x16x32_bf16 v[52:55], v[216:219], v[64:67], v[52:55]
    s_cmp_eq_u32 s77, s25
    s_cselect_b32 s77, 0, s77
    ds_read_b128 v[64:67], v11 offset:512
    v_mfma_f32_16x16x32_bf16 v[36:39], v[136:139], v[68:71], v[36:39]
    s_mov_b32 s46, 0x1c0000
    v_alignbit_b32 v223, v125, v223, v21
    v_alignbit_b32 v236, v237, v236, v21
    v_mfma_f32_16x16x32_bf16 v[40:43], v[152:155], v[68:71], v[40:43]
    buffer_load_dwordx4 v16, s[44:47], s77 offen lds
    v_alignbit_b32 v237, v238, v237, v21
    v_mfma_f32_16x16x32_bf16 v[44:47], v[168:171], v[68:71], v[44:47]
    s_waitcnt vmcnt(14)
    ds_read_b64_tr_b16 a[224:225], v9 offset:24576
    ds_read_b64_tr_b16 a[226:227], v9 offset:26624
    v_mfma_f32_16x16x32_bf16 v[48:51], v[184:187], v[68:71], v[48:51]
    ds_read_b64_tr_b16 a[228:229], v10 offset:24576
    ds_read_b64_tr_b16 a[230:231], v10 offset:26624
    v_alignbit_b32 v238, v239, v238, v21
    v_mfma_f32_16x16x32_bf16 v[52:55], v[200:203], v[68:71], v[52:55]
    ds_read_b128 v[68:71], v11 offset:768
    ds_read_b64_tr_b16 a[232:233], v9 offset:24640
    v_mfma_f32_16x16x32_bf16 v[40:43], v[136:139], v[72:75], v[40:43]
    ds_read_b64_tr_b16 a[234:235], v9 offset:26688
    v_alignbit_b32 v239, v126, v239, v21
    v_mfma_f32_16x16x32_bf16 v[44:47], v[152:155], v[72:75], v[44:47]
    ds_read_b64_tr_b16 a[236:237], v10 offset:24640
    ds_read_b64_tr_b16 a[238:239], v10 offset:26688
    v_alignbit_b32 v252, v253, v252, v21
    v_mfma_f32_16x16x32_bf16 v[48:51], v[168:171], v[72:75], v[48:51]
    s_add_u32 m0, s3, 9216
    v_lshlrev_b32 v109, 6, v0
    v_add_u32 v109, 262144, v109
    v_mfma_f32_16x16x32_bf16 v[52:55], v[184:187], v[72:75], v[52:55]
    s_add_u32 s77, s77, s24
    ds_read_b128 v[72:75], v11 offset:1024
    v_alignbit_b32 v253, v254, v253, v21
    v_mfma_f32_16x16x32_bf16 v[44:47], v[136:139], v[76:79], v[44:47]
    buffer_load_dwordx4 v16, s[44:47], s77 offen lds
    v_alignbit_b32 v254, v255, v254, v21
    v_mfma_f32_16x16x32_bf16 v[48:51], v[152:155], v[76:79], v[48:51]
    s_add_u32 m0, s3, 10240
    v_xor_b32 v16, s79, v16
    v_alignbit_b32 v255, v127, v255, v21
    v_mfma_f32_16x16x32_bf16 v[52:55], v[168:171], v[76:79], v[52:55]
    s_add_u32 s77, s77, s24
    ds_read_b128 v[76:79], v11 offset:1280
    v_mfma_f32_16x16x32_bf16 v[48:51], v[136:139], v[80:83], v[48:51]
    buffer_load_dwordx4 v16, s[44:47], s77 offen lds
    v_mfma_f32_16x16x32_bf16 v[52:55], v[152:155], v[80:83], v[52:55]
    s_add_u32 m0, s3, 11264
    ds_read_b128 v[80:83], v11 offset:1536
    v_mfma_f32_16x16x32_bf16 v[52:55], v[136:139], v[84:87], v[52:55]
    s_waitcnt lgkmcnt(12)
    ds_read_b128 v[84:87], v11 offset:1792
    v_mfma_f32_16x16x32_bf16 v[24:27], v[140:143], v[56:59], v[24:27]
    s_add_u32 s77, s77, s24
    v_and_b32 v88, 0xffff0000, v97
    v_lshlrev_b32 v89, 16, v97
    v_mfma_f32_16x16x32_bf16 v[28:31], v[156:159], v[56:59], v[28:31]
    buffer_load_dwordx4 v16, s[44:47], s77 offen lds
    v_mfma_f32_16x16x32_bf16 v[32:35], v[172:175], v[56:59], v[32:35]
    v_xor_b32 v16, s79, v16
    v_and_b32 v90, 0xffff0000, v96
    v_mfma_f32_16x16x32_bf16 v[36:39], v[188:191], v[56:59], v[36:39]
    s_add_u32 m0, s3, 12288
    v_lshlrev_b32 v91, 16, v96
    v_and_b32 v92, 0xffff0000, v99
    v_mfma_f32_16x16x32_bf16 v[40:43], v[204:207], v[56:59], v[40:43]
    s_add_u32 s77, s77, s24
    v_lshlrev_b32 v93, 16, v99
    v_and_b32 v94, 0xffff0000, v98
    v_mfma_f32_16x16x32_bf16 v[44:47], v[220:223], v[56:59], v[44:47]
    s_cmp_eq_u32 s77, s25
    s_cselect_b32 s77, 0, s77
    v_lshlrev_b32 v95, 16, v98
    v_mfma_f32_16x16x32_bf16 v[48:51], v[236:239], v[56:59], v[48:51]
    buffer_load_dwordx4 v16, s[44:47], s77 offen lds
    v_mfma_f32_16x16x32_bf16 v[52:55], v[252:255], v[56:59], v[52:55]
    s_waitcnt vmcnt(14)
    ds_read_b64_tr_b16 a[240:241], v9 offset:28672
    ds_read_b64_tr_b16 a[242:243], v9 offset:30720
    v_mfma_f32_16x16x32_bf16 v[28:31], v[140:143], v[60:63], v[28:31]
    ds_read_b64_tr_b16 a[244:245], v10 offset:28672
    ds_read_b64_tr_b16 a[246:247], v10 offset:30720
    v_mfma_f32_16x16x32_bf16 v[32:35], v[156:159], v[60:63], v[32:35]
    ds_read_b64_tr_b16 a[248:249], v9 offset:28736
    ds_read_b64_tr_b16 a[250:251], v9 offset:30784
    v_mfma_f32_16x16x32_bf16 v[36:39], v[172:175], v[60:63], v[36:39]
    ds_read_b64_tr_b16 a[252:253], v10 offset:28736
    ds_read_b64_tr_b16 a[254:255], v10 offset:30784
    v_mfma_f32_16x16x32_bf16 v[40:43], v[188:191], v[60:63], v[40:43]
    s_add_u32 m0, s3, 13312
    v_and_b32 v120, 0xffff0000, v101
    v_lshlrev_b32 v121, 16, v101
    v_mfma_f32_16x16x32_bf16 v[44:47], v[204:207], v[60:63], v[44:47]
    s_add_u32 s77, s77, s24
    v_and_b32 v122, 0xffff0000, v100
    v_lshlrev_b32 v123, 16, v100
    v_mfma_f32_16x16x32_bf16 v[48:51], v[220:223], v[60:63], v[48:51]
    buffer_load_dwordx4 v16, s[44:47], s77 offen lds
    v_mfma_f32_16x16x32_bf16 v[52:55], v[236:239], v[60:63], v[52:55]
    s_waitcnt lgkmcnt(8)
    s_barrier
    v_xor_b32 v16, s79, v16
    v_mfma_f32_16x16x32_bf16 v[32:35], v[140:143], v[64:67], v[32:35]
    s_add_u32 m0, s3, 14336
    v_and_b32 v124, 0xffff0000, v103
    v_lshlrev_b32 v125, 16, v103
    v_mfma_f32_16x16x32_bf16 v[36:39], v[156:159], v[64:67], v[36:39]
    s_add_u32 s77, s77, s24
    ds_write_b128 v110, v[24:27] offset:0
    v_mfma_f32_16x16x32_bf16 v[40:43], v[172:175], v[64:67], v[40:43]
    buffer_load_dwordx4 v16, s[44:47], s77 offen lds
    v_mfma_f32_16x16x32_bf16 v[44:47], v[188:191], v[64:67], v[44:47]
    s_add_u32 m0, s3, 15360
    v_and_b32 v126, 0xffff0000, v102
    v_lshlrev_b32 v127, 16, v102
    v_mfma_f32_16x16x32_bf16 v[48:51], v[204:207], v[64:67], v[48:51]
    s_add_u32 s77, s77, s24
    ds_write_b128 v110, v[28:31] offset:1024
    v_mfma_f32_16x16x32_bf16 v[52:55], v[220:223], v[64:67], v[52:55]
    buffer_load_dwordx4 v16, s[44:47], s77 offen lds
    v_mfma_f32_16x16x32_bf16 v[36:39], v[140:143], v[68:71], v[36:39]
    v_xor_b32 v16, s79, v16
    v_lshlrev_b32 v22, 4, v1
    v_mfma_f32_16x16x32_bf16 v[40:43], v[156:159], v[68:71], v[40:43]
    s_add_u32 m0, s3, 16384
    ds_write_b128 v110, v[32:35] offset:2048
    v_mfma_f32_16x16x32_bf16 v[44:47], v[172:175], v[68:71], v[44:47]
    s_add_u32 s77, s77, s24
    v_mfma_f32_16x16x32_bf16 v[48:51], v[188:191], v[68:71], v[48:51]
    s_cmp_eq_u32 s77, s25
    s_cselect_b32 s77, 0, s77
    v_mfma_f32_16x16x32_bf16 v[52:55], v[204:207], v[68:71], v[52:55]
    buffer_load_dwordx4 v16, s[44:47], s77 offen lds
    v_mfma_f32_16x16x32_bf16 v[40:43], v[140:143], v[72:75], v[40:43]
    v_mfma_f32_16x16x32_bf16 v[44:47], v[156:159], v[72:75], v[44:47]
    ds_write_b128 v110, v[36:39] offset:3072
    v_mfma_f32_16x16x32_bf16 v[48:51], v[172:175], v[72:75], v[48:51]
    v_mfma_f32_16x16x32_bf16 v[52:55], v[188:191], v[72:75], v[52:55]
    v_mfma_f32_16x16x32_bf16 v[44:47], v[140:143], v[76:79], v[44:47]
    v_mfma_f32_16x16x32_bf16 v[48:51], v[156:159], v[76:79], v[48:51]
    v_mfma_f32_16x16x32_bf16 v[52:55], v[172:175], v[76:79], v[52:55]
    s_nop 0
    ds_write_b128 v110, v[40:43] offset:4096
    v_mfma_f32_16x16x32_bf16 v[48:51], v[140:143], v[80:83], v[48:51]
    v_mfma_f32_16x16x32_bf16 v[52:55], v[156:159], v[80:83], v[52:55]
    v_mfma_f32_16x16x32_bf16 v[52:55], v[140:143], v[84:87], v[52:55]
    s_lshl_b32 s72, s76, 13
    s_lshl_b32 s73, s66, 11
    s_add_u32 s72, s72, s73
    s_add_u32 s72, s72, 2097152
    ds_write_b128 v110, v[44:47] offset:5120
    s_nop 0
    ds_write_b128 v110, v[48:51] offset:6144
    s_nop 0
    ds_write_b128 v110, v[52:55] offset:7168
    s_add_u32 m0, s3, 17408
    s_add_u32 s77, s77, s24
    buffer_load_dwordx4 v16, s[44:47], s77 offen lds
    v_xor_b32 v16, s79, v16
    s_add_u32 m0, s3, 18432
    s_add_u32 s77, s77, s24
    buffer_load_dwordx4 v16, s[44:47], s77 offen lds
    s_add_u32 m0, s3, 19456
    s_add_u32 s77, s77, s24
    buffer_load_dwordx4 v16, s[44:47], s77 offen lds
    s_waitcnt lgkmcnt(0)
    s_barrier
    ds_read_b128 v[56:59], v111 offset:0
    ds_read_b128 v[60:63], v111 offset:8192
    ds_read_b128 v[64:67], v111 offset:16384
    ds_read_b128 v[68:71], v111 offset:24576
    ds_read_b128 v[72:75], v111 offset:1024
    ds_read_b128 v[76:79], v111 offset:9216
    ds_read_b128 v[80:83], v111 offset:17408
    ds_read_b128 v[84:87], v111 offset:25600
    s_waitcnt lgkmcnt(7)
    v_pk_fma_f32 v[88:89], v[88:89], s[86:87], v[56:57] op_sel:[0,0,0] op_sel_hi:[1,0,1]
    v_pk_fma_f32 v[90:91], v[90:91], s[86:87], v[58:59] op_sel:[0,0,0] op_sel_hi:[1,0,1]
    s_waitcnt lgkmcnt(6)
    v_pk_add_f32 v[88:89], v[88:89], v[60:61]
    v_pk_add_f32 v[90:91], v[90:91], v[62:63]
    s_waitcnt lgkmcnt(5)
    v_pk_fma_f32 v[92:93], v[92:93], s[86:87], v[64:65] op_sel:[0,1,0] op_sel_hi:[1,1,1]
    v_pk_fma_f32 v[94:95], v[94:95], s[86:87], v[66:67] op_sel:[0,1,0] op_sel_hi:[1,1,1]
    s_waitcnt lgkmcnt(4)
    v_pk_add_f32 v[92:93], v[92:93], v[68:69]
    v_pk_add_f32 v[94:95], v[94:95], v[70:71]
    v_cvt_pk_bf16_f32 v128, v88, v92
    v_cvt_pk_bf16_f32 v129, v89, v93
    v_cvt_pk_bf16_f32 v130, v90, v94
    v_cvt_pk_bf16_f32 v131, v91, v95
    v_min_u32 v128, -2, v128
    v_min_u32 v129, -2, v129
    v_min_u32 v130, -2, v130
    v_min_u32 v131, -2, v131
    buffer_store_dwordx4 v[128:131], v22, s[52:55], s72 offen offset:0 sc1
    s_waitcnt lgkmcnt(3)
    v_pk_fma_f32 v[120:121], v[120:121], s[86:87], v[72:73] op_sel:[0,0,0] op_sel_hi:[1,0,1]
    v_pk_fma_f32 v[122:123], v[122:123], s[86:87], v[74:75] op_sel:[0,0,0] op_sel_hi:[1,0,1]
    s_waitcnt lgkmcnt(2)
    v_pk_add_f32 v[120:121], v[120:121], v[76:77]
    v_pk_add_f32 v[122:123], v[122:123], v[78:79]
    s_waitcnt lgkmcnt(1)
    v_pk_fma_f32 v[124:125], v[124:125], s[86:87], v[80:81] op_sel:[0,1,0] op_sel_hi:[1,1,1]
    v_pk_fma_f32 v[126:127], v[126:127], s[86:87], v[82:83] op_sel:[0,1,0] op_sel_hi:[1,1,1]
    s_waitcnt lgkmcnt(0)
    v_pk_add_f32 v[124:125], v[124:125], v[84:85]
    v_pk_add_f32 v[126:127], v[126:127], v[86:87]
    v_cvt_pk_bf16_f32 v132, v120, v124
    v_cvt_pk_bf16_f32 v133, v121, v125
    v_cvt_pk_bf16_f32 v134, v122, v126
    v_cvt_pk_bf16_f32 v135, v123, v127
    v_min_u32 v132, -2, v132
    v_min_u32 v133, -2, v133
    v_min_u32 v134, -2, v134
    v_min_u32 v135, -2, v135
    buffer_store_dwordx4 v[132:135], v22, s[52:55], s72 offen offset:1024 sc1
    buffer_load_dword v108, v109, s[52:55], 0 offen sc1
    v_lshlrev_b32 v24, 16, v112
    v_and_b32 v25, 0xffff0000, v112
    v_lshlrev_b32 v26, 16, v113
    v_and_b32 v27, 0xffff0000, v113
    v_lshlrev_b32 v28, 16, v114
    v_and_b32 v29, 0xffff0000, v114
    v_lshlrev_b32 v30, 16, v115
    v_and_b32 v31, 0xffff0000, v115
    v_lshlrev_b32 v32, 16, v116
    v_and_b32 v33, 0xffff0000, v116
    s_waitcnt vmcnt(19)
    ds_read_b64_tr_b16 v[160:161], v9 offset:0
    ds_read_b64_tr_b16 v[162:163], v9 offset:2048
    v_lshlrev_b32 v34, 16, v117
    v_and_b32 v35, 0xffff0000, v117
    v_lshlrev_b32 v36, 16, v118
    v_and_b32 v37, 0xffff0000, v118
    v_lshlrev_b32 v38, 16, v119
    v_and_b32 v39, 0xffff0000, v119
    v_pk_add_f32 v[72:73], v[24:25], v[26:27]
    v_pk_mul_f32 v[74:75], v[24:25], v[24:25]
    v_pk_add_f32 v[76:77], v[32:33], v[34:35]
    v_pk_mul_f32 v[78:79], v[32:33], v[32:33]
    v_pk_fma_f32 v[74:75], v[26:27], v[26:27], v[74:75]
    v_pk_fma_f32 v[78:79], v[34:35], v[34:35], v[78:79]
    v_pk_add_f32 v[72:73], v[72:73], v[28:29]
    v_pk_fma_f32 v[74:75], v[28:29], v[28:29], v[74:75]
    v_pk_add_f32 v[76:77], v[76:77], v[36:37]
    v_pk_fma_f32 v[78:79], v[36:37], v[36:37], v[78:79]
    v_pk_add_f32 v[72:73], v[72:73], v[30:31]
    v_pk_fma_f32 v[74:75], v[30:31], v[30:31], v[74:75]
    v_pk_add_f32 v[76:77], v[76:77], v[38:39]
    v_pk_fma_f32 v[78:79], v[38:39], v[38:39], v[78:79]
    ds_read_b64_tr_b16 v[164:165], v10 offset:0
    ds_read_b64_tr_b16 v[166:167], v10 offset:2048
    v_add_f32 v72, v72, v73
    v_add_f32 v74, v74, v75
    v_add_f32 v76, v76, v77
    v_add_f32 v78, v78, v79
    v_permlane32_swap_b32 v72, v74
    s_nop 0
    v_permlane32_swap_b32 v76, v78
    v_add_f32 v72, v72, v74
    v_add_f32 v76, v76, v78
    s_nop 1
    v_permlane16_swap_b32 v72, v76
    v_add_f32 v72, v72, v76
    s_nop 1
    v_add_f32_dpp v72, v72, v72 row_ror:8 row_mask:0xf bank_mask:0xf
    s_nop 1
    v_add_f32_dpp v72, v72, v72 row_ror:4 row_mask:0xf bank_mask:0xf
    s_nop 1
    v_add_f32_dpp v72, v72, v72 row_ror:2 row_mask:0xf bank_mask:0xf
    s_nop 1
    v_add_f32_dpp v72, v72, v72 row_ror:1 row_mask:0xf bank_mask:0xf
    v_mul_f32 v73, 0x3b000000, v72
    v_mul_f32 v72, 0x3b000000, v72
    s_nop 1
    v_permlane32_swap_b32 v72, v73
    v_fma_f32 v73, -v72, v72, v73
    v_max_f32 v73, 0, v73
    ds_read_b64_tr_b16 v[168:169], v9 offset:64
    ds_read_b64_tr_b16 v[170:171], v9 offset:2112
    v_add_f32 v73, 0x3727c5ac, v73
    v_rsq_f32 v74, v73
    s_nop 0
    v_mul_f32 v75, -v72, v74
    v_readlane_b32 s82, v74, 0
    v_readlane_b32 s84, v74, 16
    v_readlane_b32 s83, v75, 0
    v_readlane_b32 s85, v75, 16
    s_nop 0
    v_pk_fma_f32 v[40:41], v[24:25], s[82:83], s[82:83] op_sel:[0,0,1] op_sel_hi:[1,0,1]
    v_pk_fma_f32 v[42:43], v[26:27], s[82:83], s[82:83] op_sel:[0,0,1] op_sel_hi:[1,0,1]
    v_pk_fma_f32 v[44:45], v[28:29], s[82:83], s[82:83] op_sel:[0,0,1] op_sel_hi:[1,0,1]
    v_pk_fma_f32 v[46:47], v[30:31], s[82:83], s[82:83] op_sel:[0,0,1] op_sel_hi:[1,0,1]
    v_pk_fma_f32 v[48:49], v[32:33], s[84:85], s[84:85] op_sel:[0,0,1] op_sel_hi:[1,0,1]
    v_pk_fma_f32 v[50:51], v[34:35], s[84:85], s[84:85] op_sel:[0,0,1] op_sel_hi:[1,0,1]
    v_pk_fma_f32 v[52:53], v[36:37], s[84:85], s[84:85] op_sel:[0,0,1] op_sel_hi:[1,0,1]
    v_pk_fma_f32 v[54:55], v[38:39], s[84:85], s[84:85] op_sel:[0,0,1] op_sel_hi:[1,0,1]
    s_lshl_b32 s72, s64, 10
    s_and_b32 s73, s67, 12
    s_lshl_b32 s73, s73, 6
    s_add_u32 s72, s72, s73
    ds_read_b64_tr_b16 v[172:173], v10 offset:64
    ds_read_b64_tr_b16 v[174:175], v10 offset:2112
    s_lshl_b32 s73, s68, 7
    s_add_u32 s72, s72, s73
    s_and_b32 s73, s67, 3
    s_lshl_b32 s73, s73, 5
    s_add_u32 s72, s72, s73
    s_add_u32 s74, s72, 2097152
    v_lshrrev_b32 v104, 1, v0
    v_and_b32 v105, 1, v0
    v_lshlrev_b32 v106, 13, v104
    v_lshl_add_u32 v106, v105, 4, v106
    v_add_u32 v106, s74, v106
    v_add_u32 v107, 1048576, v106
    v_lshlrev_b32 v105, 12, v105
    v_lshl_add_u32 v105, v104, 2, v105
    v_add_u32 v105, 131072, v105
    v_add_u32 v104, 131072, v5
    s_lshl_b32 s72, s68, 8
    s_add_u32 s72, s72, 2097664
    v_lshl_add_u32 v4, v1, 2, s72
    s_lshl_b32 s73, s67, 2
    v_xor_b32 v16, s79, v16
    s_add_u32 m0, s3, 20480
    s_add_u32 s77, s77, s24
    s_cmp_eq_u32 s77, s25
    s_cselect_b32 s77, 0, s77
    buffer_load_dwordx4 v16, s[44:47], s77 offen lds
    s_add_u32 s73, s73, s66
    v_cmp_eq_u32 vcc, s73, v1
    s_lshl_b32 s72, s65, 7
    s_add_u32 s72, s72, 2097664
    v_cndmask_b32 v3, -1, v4, vcc
    v_mov_b32 v20, s72
    v_cmp_eq_u32 vcc, 0, v0
    s_nop 1
    v_cndmask_b32 v20, -1, v20, vcc
    buffer_load_dword v136, v20, s[60:63], 0 offen sc1
    s_mov_b32 s42, 0x3f317218
    s_lshl_b32 s43, s66, 10
    s_lshl_b32 s72, s66, 2
    v_add_u32 v20, s72, v18
    v_xor_b32 v21, v20, v17
    v_lshlrev_b32 v21, 4, v21
    v_lshl_add_u32 v8, v20, 10, v21
    s_lshl_b32 s72, s68, 17
    v_add_u32 v8, s72, v8
    s_lshl_b32 s72, s64, 1
    v_add_u32 v20, s72, v18
    v_lshlrev_b32 v21, 8, v17
    v_add_u32 v22, 0, v20
    v_and_b32 v22, 15, v22
    v_xor_b32 v22, v22, v17
    v_lshl_add_u32 v96, v22, 4, v21
    v_add_u32 v22, 4, v20
    v_and_b32 v22, 15, v22
    v_xor_b32 v22, v22, v17
    v_lshl_add_u32 v97, v22, 4, v21
    v_add_u32 v22, 8, v20
    v_and_b32 v22, 15, v22
    v_xor_b32 v22, v22, v17
    v_lshl_add_u32 v98, v22, 4, v21
    v_add_u32 v22, 12, v20
    v_and_b32 v22, 15, v22
    v_xor_b32 v22, v22, v17
    v_lshl_add_u32 v99, v22, 4, v21
    s_mul_i32 s74, s68, 458752
    s_add_u32 s74, s74, 262144
    s_lshl_b32 s72, s67, 12
    s_add_u32 s72, s72, s43
    s_add_u32 s72, s72, s74
    s_cmp_ge_u32 s67, 14
    s_cselect_b32 s72, 0x40000000, s72
    v_lshl_add_u32 v6, v1, 4, s72
    s_and_b32 s72, s67, 1
    s_mul_i32 s72, s72, 57344
    s_mul_i32 s73, s66, 14336
    s_add_u32 m0, s3, 21504
    s_add_u32 s77, s77, s24
    buffer_load_dwordx4 v16, s[44:47], s77 offen lds
    s_add_u32 s72, s72, s73
    s_add_u32 s72, s72, s74
    v_lshl_add_u32 v13, v1, 4, s72
    v_and_b32 v22, 7, v1
    v_xor_b32 v22, v22, v18
    v_lshlrev_b32 v22, 4, v22
    v_lshl_add_u32 v22, v17, 8, v22
    s_lshl_b32 s72, s66, 12
    s_add_u32 s72, s72, 65536
    v_add_u32 v11, s72, v22
    v_xor_b32 v14, 64, v11
    v_lshrrev_b32 v20, 4, v0
    v_and_b32 v22, 7, v20
    v_xor_b32 v22, v22, v17
    v_lshlrev_b32 v22, 4, v22
    v_lshl_add_u32 v12, v20, 8, v22
    v_add_u32 v12, 65536, v12
    s_lshl_b32 s72, s68, 17
    s_and_b32 s73, s67, 1
    s_lshl_b32 s73, s73, 14
    s_add_u32 s72, s72, s73
    s_add_u32 s72, s72, s80
    v_lshlrev_b32 v20, 10, v20
    v_lshl_add_u32 v20, v17, 3, v20
    v_add_u32 v5, s72, v20
    v_bfe_u32 v20, v1, 2, 2
    v_lshl_add_u32 v21, v18, 3, v20
    v_xor_b32 v22, s66, v20
    v_lshlrev_b32 v22, 6, v22
    v_lshl_add_u32 v110, v21, 8, v22
    v_and_b32 v22, 1, v18
    v_lshl_add_u32 v110, v22, 5, v110
    v_and_b32 v22, 3, v1
    v_lshl_add_u32 v110, v22, 3, v110
    v_xor_b32 v111, 32, v110
    v_add_u32 v100, 0x10000, v110
    v_add_u32 v101, 0x10000, v111
    s_waitcnt vmcnt(3)
    v_subrev_u32 v108, s70, v108
    v_cmp_le_u32 vcc, 16, v108
    s_nop 0
    s_cbranch_vccz L_ret_8
L_spin_7:
    s_sleep 8
    buffer_load_dword v108, v109, s[52:55], 0 offen sc1
    s_sub_u32 s71, s71, 1
    s_cbranch_scc1 L_bail_9
    s_waitcnt vmcnt(0)
    v_subrev_u32 v108, s70, v108
    v_cmp_le_u32 vcc, 16, v108
    s_nop 0
    s_cbranch_vccnz L_spin_7
L_ret_8:
    v_xor_b32 v16, s79, v16
    s_add_u32 m0, s3, 22528
    s_add_u32 s77, s77, s24
    buffer_load_dwordx4 v16, s[44:47], s77 offen lds
    s_add_u32 m0, s3, 23552
    s_add_u32 s77, s77, s24
    buffer_load_dwordx4 v16, s[44:47], s77 offen lds
    s_barrier
    buffer_load_dwordx4 v[88:91], v106, s[52:55], 0 offen sc1
    buffer_load_dwordx4 v[92:95], v107, s[52:55], 0 offen sc1
    s_lshl_b32 s72, s81, 3
    s_add_u32 s72, s72, 2098176
    v_mov_b32 v22, s72
    v_cmp_eq_u32 vcc, 0, v1
    s_mov_b32 s86, 0x10000
    s_nop 0
    v_cndmask_b32 v19, 2.0, v22, vcc
    v_xor_b32 v16, s79, v16
    s_add_u32 m0, s3, 24576
    s_add_u32 s77, s77, s24
    s_cmp_eq_u32 s77, s25
    s_cselect_b32 s77, 0, s77
    buffer_load_dwordx4 v16, s[44:47], s77 offen lds
    s_add_u32 s72, s64, 0
    s_and_b32 s72, s72, 7
    s_lshl_b32 s28, s72, 10
    s_add_u32 s72, s64, 1
    s_and_b32 s72, s72, 7
    s_lshl_b32 s29, s72, 10
    s_add_u32 s72, s64, 2
    s_and_b32 s72, s72, 7
    s_lshl_b32 s30, s72, 10
    s_add_u32 s72, s64, 3
    s_add_u32 m0, s3, 25600
    s_add_u32 s77, s77, s24
    buffer_load_dwordx4 v16, s[44:47], s77 offen lds
    s_and_b32 s72, s72, 7
    s_lshl_b32 s31, s72, 10
    s_add_u32 s72, s64, 4
    s_and_b32 s72, s72, 7
    s_lshl_b32 s32, s72, 10
    s_add_u32 s72, s64, 5
    s_and_b32 s72, s72, 7
    s_lshl_b32 s33, s72, 10
    s_add_u32 s72, s64, 6
    s_and_b32 s72, s72, 7
    v_xor_b32 v16, s79, v16
    s_add_u32 m0, s3, 26624
    s_add_u32 s77, s77, s24
    buffer_load_dwordx4 v16, s[44:47], s77 offen lds
    s_lshl_b32 s34, s72, 10
    s_add_u32 s72, s64, 7
    s_and_b32 s72, s72, 7
    s_lshl_b32 s35, s72, 10
    s_lshr_b32 s36, s1, 5
    s_add_u32 s72, s36, 1024
    s_cmp_eq_u32 s72, 14336
    s_cselect_b32 s37, 8192, s72
    s_add_u32 s72, s37, 1024
    s_cmp_eq_u32 s72, 14336
    s_cselect_b32 s38, 8192, s72
    s_add_u32 s72, s38, 1024
    s_add_u32 m0, s3, 27648
    s_add_u32 s77, s77, s24
    buffer_load_dwordx4 v16, s[44:47], s77 offen lds
    s_cmp_eq_u32 s72, 14336
    s_cselect_b32 s39, 8192, s72
    s_add_u32 s72, s39, 1024
    s_cmp_eq_u32 s72, 14336
    s_cselect_b32 s40, 8192, s72
    s_add_u32 s72, s40, 1024
    s_cmp_eq_u32 s72, 14336
    s_cselect_b32 s41, 8192, s72
    s_waitcnt vmcnt(5)
    v_max3_u32 v2, v88, v89, v90
    s_waitcnt vmcnt(4)
    v_max3_u32 v23, v92, v93, v94
    v_max3_u32 v2, v2, v91, v95
    v_max_u32 v2, v2, v23
    v_cmp_eq_u32 vcc, -1, v2
    s_nop 0
    s_cbranch_vccz L_ret_11
L_spin_10:
    buffer_load_dwordx4 v[88:91], v106, s[52:55], 0 offen sc1
    buffer_load_dwordx4 v[92:95], v107, s[52:55], 0 offen sc1
    s_sub_u32 s71, s71, 1
    s_cbranch_scc1 L_bail_12
    s_waitcnt vmcnt(0)
    v_max3_u32 v2, v88, v89, v90
    v_max3_u32 v23, v92, v93, v94
    v_max3_u32 v2, v2, v91, v95
    v_max_u32 v2, v2, v23
    v_cmp_eq_u32 vcc, -1, v2
    s_nop 0
    s_cbranch_vccnz L_spin_10
L_ret_11:
    ds_write_b32 v105, v88 offset:0
    ds_write_b32 v105, v89 offset:1024
    ds_write_b32 v105, v90 offset:2048
    ds_write_b32 v105, v91 offset:3072
    ds_write_b32 v105, v92 offset:512
    ds_write_b32 v105, v93 offset:1536
    ds_write_b32 v105, v94 offset:2560
    ds_write_b32 v105, v95 offset:3584
    v_xor_b32 v16, s79, v16
    s_add_u32 m0, s3, 28672
    s_add_u32 s77, s77, s24
    s_cmp_eq_u32 s77, s25
    s_cselect_b32 s77, 0, s77
    buffer_load_dwordx4 v16, s[44:47], s77 offen lds
    s_add_u32 m0, s3, 29696
    s_add_u32 s77, s77, s24
    buffer_load_dwordx4 v16, s[44:47], s77 offen lds
    s_waitcnt lgkmcnt(0)
    s_barrier
    ds_read_b128 v[152:155], v104
    ds_read_b128 v[156:159], v104 offset:4096
    s_waitcnt lgkmcnt(1)
    v_lshlrev_b32 v56, 16, v152
    v_and_b32 v57, 0xffff0000, v152
    v_lshlrev_b32 v58, 16, v153
    v_and_b32 v59, 0xffff0000, v153
    v_lshlrev_b32 v60, 16, v154
    v_and_b32 v61, 0xffff0000, v154
    v_lshlrev_b32 v62, 16, v155
    v_xor_b32 v16, s79, v16
    s_add_u32 m0, s3, 30720
L_hop_3:
    s_cbranch_execz L_hop_back0
    s_add_u32 s77, s77, s24
    buffer_load_dwordx4 v16, s[44:47], s77 offen lds
    v_and_b32 v63, 0xffff0000, v155
    s_waitcnt lgkmcnt(0)
    v_lshlrev_b32 v64, 16, v156
    v_and_b32 v65, 0xffff0000, v156
    v_lshlrev_b32 v66, 16, v157
    v_and_b32 v67, 0xffff0000, v157
    v_lshlrev_b32 v68, 16, v158
    v_and_b32 v69, 0xffff0000, v158
    v_lshlrev_b32 v70, 16, v159
    v_and_b32 v71, 0xffff0000, v159
    v_pk_fma_f32 v[24:25], v[40:41], v[56:57], v[24:25]
    v_pk_fma_f32 v[26:27], v[42:43], v[58:59], v[26:27]
    v_pk_fma_f32 v[28:29], v[44:45], v[60:61], v[28:29]
    v_pk_fma_f32 v[30:31], v[46:47], v[62:63], v[30:31]
    s_add_u32 m0, s3, 31744
    s_add_u32 s77, s77, s24
    buffer_load_dwordx4 v16, s[44:47], s77 offen lds
    v_pk_fma_f32 v[32:33], v[48:49], v[64:65], v[32:33]
    v_pk_fma_f32 v[34:35], v[50:51], v[66:67], v[34:35]
    v_pk_fma_f32 v[36:37], v[52:53], v[68:69], v[36:37]
    v_pk_fma_f32 v[38:39], v[54:55], v[70:71], v[38:39]
    v_pk_add_f32 v[72:73], v[24:25], v[26:27]
    v_pk_mul_f32 v[74:75], v[24:25], v[24:25]
    v_pk_add_f32 v[76:77], v[32:33], v[34:35]
    v_pk_mul_f32 v[78:79], v[32:33], v[32:33]
    v_pk_fma_f32 v[74:75], v[26:27], v[26:27], v[74:75]
    v_pk_fma_f32 v[78:79], v[34:35], v[34:35], v[78:79]
    v_pk_add_f32 v[72:73], v[72:73], v[28:29]
    v_pk_fma_f32 v[74:75], v[28:29], v[28:29], v[74:75]
    v_pk_add_f32 v[76:77], v[76:77], v[36:37]
    v_xor_b32 v16, s79, v16
    s_add_u32 m0, s3, 0
    s_add_u32 s77, s77, s24
    s_cmp_eq_u32 s77, s25
    s_cselect_b32 s77, 0, s77
    buffer_load_dwordx4 v16, s[44:47], s77 offen lds
    v_pk_fma_f32 v[78:79], v[36:37], v[36:37], v[78:79]
    v_pk_add_f32 v[72:73], v[72:73], v[30:31]
    v_pk_fma_f32 v[74:75], v[30:31], v[30:31], v[74:75]
    v_pk_add_f32 v[76:77], v[76:77], v[38:39]
    v_pk_fma_f32 v[78:79], v[38:39], v[38:39], v[78:79]
    v_add_f32 v72, v72, v73
    v_add_f32 v74, v74, v75
    v_add_f32 v76, v76, v77
    v_add_f32 v78, v78, v79
    v_permlane32_swap_b32 v72, v74
    s_nop 0
    v_permlane32_swap_b32 v76, v78
    v_add_f32 v72, v72, v74
    v_add_f32 v76, v76, v78
    s_add_u32 m0, s3, 1024
    s_add_u32 s77, s77, s24
    buffer_load_dwordx4 v16, s[44:47], s77 offen lds
    v_permlane16_swap_b32 v72, v76
    v_add_f32 v72, v72, v76
    s_nop 1
    v_add_f32_dpp v72, v72, v72 row_ror:8 row_mask:0xf bank_mask:0xf
    s_nop 1
    v_add_f32_dpp v72, v72, v72 row_ror:4 row_mask:0xf bank_mask:0xf
    s_nop 1
    v_add_f32_dpp v72, v72, v72 row_ror:2 row_mask:0xf bank_mask:0xf
    s_nop 1
    v_add_f32_dpp v72, v72, v72 row_ror:1 row_mask:0xf bank_mask:0xf
    v_mul_f32 v73, 0x3b000000, v72
    v_mul_f32 v72, 0x3b000000, v72
    s_nop 1
    v_permlane32_swap_b32 v72, v73
    v_fma_f32 v73, -v72, v72, v73
    v_max_f32 v73, 0, v73
    v_add_f32 v73, 0x3727c5ac, v73
    v_mul_f32 v73, 0x3ef5fdf0, v73
    v_xor_b32 v16, s79, v16
    s_add_u32 m0, s3, 2048
    s_add_u32 s77, s77, s24
    buffer_load_dwordx4 v16, s[44:47], s77 offen lds
    v_rsq_f32 v74, v73
    s_nop 0
    v_mul_f32 v75, -v72, v74
    v_readlane_b32 s82, v74, 0
    v_readlane_b32 s84, v74, 16
    v_readlane_b32 s83, v75, 0
    v_readlane_b32 s85, v75, 16
    s_cmp_lg_u64 s[26:27], 0
    s_cbranch_scc1 L_global
    v_pk_fma_f32 v[40:41], v[24:25], s[82:83], s[82:83] op_sel:[0,0,1] op_sel_hi:[1,0,1]
    v_pk_fma_f32 v[42:43], v[26:27], s[82:83], s[82:83] op_sel:[0,0,1] op_sel_hi:[1,0,1]
    v_pk_fma_f32 v[44:45], v[28:29], s[82:83], s[82:83] op_sel:[0,0,1] op_sel_hi:[1,0,1]
    v_pk_fma_f32 v[46:47], v[30:31], s[82:83], s[82:83] op_sel:[0,0,1] op_sel_hi:[1,0,1]
    v_cvt_pk_bf16_f32 v80, v40, v41
    v_cvt_pk_bf16_f32 v81, v42, v43
    v_cvt_pk_bf16_f32 v82, v44, v45
    v_cvt_pk_bf16_f32 v83, v46, v47
    buffer_store_dwordx4 v[80:83], v7, s[60:63], 0 offen
    v_pk_fma_f32 v[48:49], v[32:33], s[84:85], s[84:85] op_sel:[0,0,1] op_sel_hi:[1,0,1]
    v_pk_fma_f32 v[50:51], v[34:35], s[84:85], s[84:85] op_sel:[0,0,1] op_sel_hi:[1,0,1]
    v_pk_fma_f32 v[52:53], v[36:37], s[84:85], s[84:85] op_sel:[0,0,1] op_sel_hi:[1,0,1]
    v_pk_fma_f32 v[54:55], v[38:39], s[84:85], s[84:85] op_sel:[0,0,1] op_sel_hi:[1,0,1]
    v_cvt_pk_bf16_f32 v84, v48, v49
    v_cvt_pk_bf16_f32 v85, v50, v51
    v_cvt_pk_bf16_f32 v86, v52, v53
    v_cvt_pk_bf16_f32 v87, v54, v55
    buffer_store_dwordx4 v[84:87], v7, s[60:63], s86 offen
    v_cvt_pk_bf16_f32 v144, v24, v25
    v_cvt_pk_bf16_f32 v145, v26, v27
    v_cvt_pk_bf16_f32 v146, v28, v29
    v_cvt_pk_bf16_f32 v147, v30, v31
    v_cvt_pk_bf16_f32 v148, v32, v33
    v_cvt_pk_bf16_f32 v149, v34, v35
    v_cvt_pk_bf16_f32 v150, v36, v37
    v_cvt_pk_bf16_f32 v151, v38, v39
    s_add_u32 m0, s3, 3072
    s_add_u32 s77, s77, s24
    buffer_load_dwordx4 v16, s[44:47], s77 offen lds
    v_mov_b32 v17, s69
    s_add_u32 s70, s69, 3
    v_mov_b32 v2, s70
    s_waitcnt vmcnt(1)
    buffer_store_dword v2, v3, s[60:63], 0 offen
    s_cmp_ge_u32 s67, 14
    s_cbranch_scc1 L_g1skip_13
    s_barrier
    s_lshl_b32 s3, s66, 13
    s_add_u32 m0, s3, 131072
    s_lshl_b32 s77, s37, 5
    buffer_load_dwordx4 v15, s[48:51], s77 offen lds
    s_add_u32 m0, s3, 132096
    s_add_u32 s77, s77, 8192
    buffer_load_dwordx4 v15, s[48:51], s77 offen lds
    s_add_u32 m0, s3, 133120
    s_add_u32 s77, s77, 8192
    buffer_load_dwordx4 v15, s[48:51], s77 offen lds
    s_add_u32 m0, s3, 134144
    s_add_u32 s77, s77, 8192
    buffer_load_dwordx4 v15, s[48:51], s77 offen lds
    s_waitcnt vmcnt(5)
    s_barrier
    ds_read_b64_tr_b16 a[0:1], v110 offset:0
    ds_read_b64_tr_b16 a[2:3], v110 offset:1024
    ds_read_b64_tr_b16 a[4:5], v111 offset:0
    ds_read_b64_tr_b16 a[6:7], v111 offset:1024
    ds_read_b64_tr_b16 a[8:9], v110 offset:8192
    ds_read_b64_tr_b16 a[10:11], v110 offset:9216
    ds_read_b64_tr_b16 a[12:13], v111 offset:8192
    ds_read_b64_tr_b16 a[14:15], v111 offset:9216
    ds_read_b64_tr_b16 a[16:17], v110 offset:16384
    ds_read_b64_tr_b16 a[18:19], v110 offset:17408
    ds_read_b64_tr_b16 a[20:21], v111 offset:16384
    ds_read_b64_tr_b16 a[22:23], v111 offset:17408
    ds_read_b64_tr_b16 a[24:25], v110 offset:24576
    ds_read_b64_tr_b16 a[26:27], v110 offset:25600
    ds_read_b64_tr_b16 a[28:29], v111 offset:24576
    ds_read_b64_tr_b16 a[30:31], v111 offset:25600
    buffer_load_dword v2, v4, s[60:63], 0 offen sc1
    ds_read_b64_tr_b16 a[32:33], v110 offset:32768
    ds_read_b64_tr_b16 a[34:35], v110 offset:33792
    ds_read_b64_tr_b16 a[36:37], v111 offset:32768
    ds_read_b64_tr_b16 a[38:39], v111 offset:33792
    ds_read_b64_tr_b16 a[40:41], v110 offset:40960
    ds_read_b64_tr_b16 a[42:43], v110 offset:41984
    ds_read_b64_tr_b16 a[44:45], v111 offset:40960
    ds_read_b64_tr_b16 a[46:47], v111 offset:41984
    ds_read_b64_tr_b16 a[48:49], v110 offset:49152
    ds_read_b64_tr_b16 a[50:51], v110 offset:50176
    ds_read_b64_tr_b16 a[52:53], v111 offset:49152
    ds_read_b64_tr_b16 a[54:55], v111 offset:50176
    ds_read_b64_tr_b16 a[56:57], v110 offset:57344
    ds_read_b64_tr_b16 a[58:59], v110 offset:58368
    ds_read_b64_tr_b16 a[60:61], v111 offset:57344
    ds_read_b64_tr_b16 a[62:63], v111 offset:58368
    ds_read_b64_tr_b16 a[64:65], v100 offset:0
    ds_read_b64_tr_b16 a[66:67], v100 offset:1024
    ds_read_b64_tr_b16 a[68:69], v101 offset:0
    ds_read_b64_tr_b16 a[70:71], v101 offset:1024
    ds_read_b64_tr_b16 a[72:73], v100 offset:8192
    ds_read_b64_tr_b16 a[74:75], v100 offset:9216
    ds_read_b64_tr_b16 a[76:77], v101 offset:8192
    ds_read_b64_tr_b16 a[78:79], v101 offset:9216
    ds_read_b64_tr_b16 a[80:81], v100 offset:16384
    ds_read_b64_tr_b16 a[82:83], v100 offset:17408
    ds_read_b64_tr_b16 a[84:85], v101 offset:16384
    ds_read_b64_tr_b16 a[86:87], v101 offset:17408
    ds_read_b64_tr_b16 a[88:89], v100 offset:24576
    ds_read_b64_tr_b16 a[90:91], v100 offset:25600
    ds_read_b64_tr_b16 a[92:93], v101 offset:24576
    ds_read_b64_tr_b16 a[94:95], v101 offset:25600
    ds_read_b64_tr_b16 a[96:97], v100 offset:32768
    ds_read_b64_tr_b16 a[98:99], v100 offset:33792
    ds_read_b64_tr_b16 a[100:101], v101 offset:32768
    ds_read_b64_tr_b16 a[102:103], v101 offset:33792
    ds_read_b64_tr_b16 a[104:105], v100 offset:40960
    ds_read_b64_tr_b16 a[106:107], v100 offset:41984
    ds_read_b64_tr_b16 a[108:109], v101 offset:40960
    ds_read_b64_tr_b16 a[110:111], v101 offset:41984
    ds_read_b64_tr_b16 a[112:113], v100 offset:49152
    ds_read_b64_tr_b16 a[114:115], v100 offset:50176
    ds_read_b64_tr_b16 a[116:117], v101 offset:49152
    ds_read_b64_tr_b16 a[118:119], v101 offset:50176
    ds_read_b64_tr_b16 a[120:121], v100 offset:57344
    ds_read_b64_tr_b16 a[122:123], v100 offset:58368
    ds_read_b64_tr_b16 a[124:125], v101 offset:57344
    ds_read_b64_tr_b16 a[126:127], v101 offset:58368
    s_waitcnt vmcnt(0)
    v_subrev_u32 v2, s70, v2
    v_cmp_le_u32 vcc, 16, v2
    s_nop 0
    s_cbranch_vccz L_ret_15
L_spin_14:
    buffer_load_dword v2, v4, s[60:63], 0 offen sc1
    s_sub_u32 s71, s71, 1
    s_cbranch_scc1 L_bail_16
    s_waitcnt vmcnt(0)
    v_subrev_u32 v2, s70, v2
    v_cmp_le_u32 vcc, 16, v2
    s_nop 0
    s_cbranch_vccnz L_spin_14
L_ret_15:
    s_waitcnt lgkmcnt(15)
    s_barrier
    s_add_u32 m0, s43, 0
    s_mov_b32 s72, 0
    buffer_load_dwordx4 v8, s[60:63], s72 offen offset:0 sc1 lds
    s_add_u32 m0, s43, 7936
    s_nop 0
    buffer_load_dwordx4 v8, s[60:63], s72 offen offset:256 sc1 lds
    s_add_u32 m0, s43, 15872
    s_nop 0
    buffer_load_dwordx4 v8, s[60:63], s72 offen offset:512 sc1 lds
    s_add_u32 m0, s43, 23808
    s_nop 0
    buffer_load_dwordx4 v8, s[60:63], s72 offen offset:768 sc1 lds
    s_add_u32 m0, s43, 4096
    s_mov_b32 s72, 16384
    buffer_load_dwordx4 v8, s[60:63], s72 offen offset:0 sc1 lds
    s_add_u32 m0, s43, 12032
    s_nop 0
    buffer_load_dwordx4 v8, s[60:63], s72 offen offset:256 sc1 lds
    s_add_u32 m0, s43, 19968
    s_nop 0
    buffer_load_dwordx4 v8, s[60:63], s72 offen offset:512 sc1 lds
    s_add_u32 m0, s43, 27904
    s_nop 0
    buffer_load_dwordx4 v8, s[60:63], s72 offen offset:768 sc1 lds
    s_waitcnt lgkmcnt(0)
    s_waitcnt vmcnt(6)
    s_barrier
    ds_read_b128 v[56:59], v96 offset:0
    ds_read_b128 v[60:63], v97 offset:0
    ds_read_b128 v[64:67], v98 offset:0
    ds_read_b128 v[68:71], v99 offset:0
    s_waitcnt lgkmcnt(3)
    v_mfma_f32_16x16x32_bf16 v[28:31], a[4:7], v[56:59], 0
    s_add_u32 m0, s43, 32768
    ds_read_b128 v[72:75], v96 offset:8192
    ds_read_b128 v[76:79], v97 offset:8192
    v_mfma_f32_16x16x32_bf16 v[24:27], a[0:3], v[56:59], 0
    s_mov_b32 s72, 32768
    s_waitcnt lgkmcnt(4)
    v_mfma_f32_16x16x32_bf16 v[24:27], a[8:11], v[60:63], v[24:27]
    buffer_load_dwordx4 v8, s[60:63], s72 offen offset:0 sc1 lds
    v_mfma_f32_16x16x32_bf16 v[28:31], a[12:15], v[60:63], v[28:31]
    s_waitcnt lgkmcnt(2)
    v_mfma_f32_16x16x32_bf16 v[28:31], a[20:23], v[64:67], v[28:31]
    s_add_u32 m0, s43, 40704
    ds_read_b128 v[56:59], v98 offset:8192
    ds_read_b128 v[60:63], v99 offset:8192
    v_mfma_f32_16x16x32_bf16 v[24:27], a[16:19], v[64:67], v[24:27]
    s_mul_i32 s74, s66, 24576
    buffer_load_dwordx4 v8, s[60:63], s72 offen offset:256 sc1 lds
    v_mfma_f32_16x16x32_bf16 v[24:27], a[24:27], v[68:71], v[24:27]
    s_waitcnt vmcnt(6)
    s_barrier
    v_mfma_f32_16x16x32_bf16 v[28:31], a[28:31], v[68:71], v[28:31]
    s_waitcnt lgkmcnt(2)
    v_subrev_u32 v9, s74, v9
    v_subrev_u32 v10, s74, v10
    v_mfma_f32_16x16x32_bf16 v[28:31], a[36:39], v[72:75], v[28:31]
    s_add_u32 m0, s43, 48640
    ds_read_b128 v[64:67], v96 offset:16384
    ds_read_b128 v[68:71], v97 offset:16384
    v_mfma_f32_16x16x32_bf16 v[24:27], a[32:35], v[72:75], v[24:27]
    buffer_load_dwordx4 v8, s[60:63], s72 offen offset:512 sc1 lds
    v_mfma_f32_16x16x32_bf16 v[24:27], a[40:43], v[76:79], v[24:27]
    v_add_u32 v18, 131072, v9
    v_add_u32 v0, 131072, v10
    v_mfma_f32_16x16x32_bf16 v[28:31], a[44:47], v[76:79], v[28:31]
    s_waitcnt lgkmcnt(2)
    v_mfma_f32_16x16x32_bf16 v[28:31], a[52:55], v[56:59], v[28:31]
    s_add_u32 m0, s43, 56576
    ds_read_b128 v[72:75], v98 offset:16384
    ds_read_b128 v[76:79], v99 offset:16384
    v_mfma_f32_16x16x32_bf16 v[24:27], a[48:51], v[56:59], v[24:27]
    buffer_load_dwordx4 v8, s[60:63], s72 offen offset:768 sc1 lds
    v_mfma_f32_16x16x32_bf16 v[24:27], a[56:59], v[60:63], v[24:27]
    v_mfma_f32_16x16x32_bf16 v[28:31], a[60:63], v[60:63], v[28:31]
    s_waitcnt lgkmcnt(2)
    v_mfma_f32_16x16x32_bf16 v[28:31], a[68:71], v[64:67], v[28:31]
    s_add_u32 m0, s43, 36864
    ds_read_b128 v[56:59], v96 offset:24576
    ds_read_b128 v[60:63], v97 offset:24576
    v_mfma_f32_16x16x32_bf16 v[24:27], a[64:67], v[64:67], v[24:27]
    s_mov_b32 s72, 49152
    v_mfma_f32_16x16x32_bf16 v[24:27], a[72:75], v[68:71], v[24:27]
    buffer_load_dwordx4 v8, s[60:63], s72 offen offset:0 sc1 lds
    v_mfma_f32_16x16x32_bf16 v[28:31], a[76:79], v[68:71], v[28:31]
    s_waitcnt lgkmcnt(2)
    v_mfma_f32_16x16x32_bf16 v[28:31], a[84:87], v[72:75], v[28:31]
    s_add_u32 m0, s43, 44800
    ds_read_b128 v[64:67], v98 offset:24576
    ds_read_b128 v[68:71], v99 offset:24576
    v_mfma_f32_16x16x32_bf16 v[24:27], a[80:83], v[72:75], v[24:27]
    buffer_load_dwordx4 v8, s[60:63], s72 offen offset:256 sc1 lds
    v_mfma_f32_16x16x32_bf16 v[24:27], a[88:91], v[76:79], v[24:27]
    s_waitcnt vmcnt(6)
    s_barrier
    v_mfma_f32_16x16x32_bf16 v[28:31], a[92:95], v[76:79], v[28:31]
    s_waitcnt lgkmcnt(2)
    v_mfma_f32_16x16x32_bf16 v[28:31], a[100:103], v[56:59], v[28:31]
    s_add_u32 m0, s43, 52736
    ds_read_b128 v[72:75], v96 offset:4096
    ds_read_b128 v[76:79], v97 offset:4096
    v_mfma_f32_16x16x32_bf16 v[24:27], a[96:99], v[56:59], v[24:27]
    buffer_load_dwordx4 v8, s[60:63], s72 offen offset:512 sc1 lds
    v_mfma_f32_16x16x32_bf16 v[24:27], a[104:107], v[60:63], v[24:27]
    v_mfma_f32_16x16x32_bf16 v[28:31], a[108:111], v[60:63], v[28:31]
    s_waitcnt lgkmcnt(2)
    v_mfma_f32_16x16x32_bf16 v[28:31], a[116:119], v[64:67], v[28:31]
    s_add_u32 m0, s43, 60672
    ds_read_b128 v[56:59], v98 offset:4096
    ds_read_b128 v[60:63], v99 offset:4096
    v_mfma_f32_16x16x32_bf16 v[24:27], a[112:115], v[64:67], v[24:27]
    buffer_load_dwordx4 v8, s[60:63], s72 offen offset:768 sc1 lds
    v_mfma_f32_16x16x32_bf16 v[24:27], a[120:123], v[68:71], v[24:27]
    v_mfma_f32_16x16x32_bf16 v[28:31], a[124:127], v[68:71], v[28:31]
    s_waitcnt lgkmcnt(2)
    v_mfma_f32_16x16x32_bf16 v[36:39], a[4:7], v[72:75], 0
    s_add_u32 m0, s43, 65536
    ds_read_b128 v[64:67], v96 offset:12288
    ds_read_b128 v[68:71], v97 offset:12288
    v_mfma_f32_16x16x32_bf16 v[32:35], a[0:3], v[72:75], 0
    s_mov_b32 s72, 65536
    v_mfma_f32_16x16x32_bf16 v[32:35], a[8:11], v[76:79], v[32:35]
    buffer_load_dwordx4 v8, s[60:63], s72 offen offset:0 sc1 lds
    v_mfma_f32_16x16x32_bf16 v[36:39], a[12:15], v[76:79], v[36:39]
    s_waitcnt lgkmcnt(2)
    v_mfma_f32_16x16x32_bf16 v[36:39], a[20:23], v[56:59], v[36:39]
    s_add_u32 m0, s43, 73472
    ds_read_b128 v[72:75], v98 offset:12288
    ds_read_b128 v[76:79], v99 offset:12288
    v_mfma_f32_16x16x32_bf16 v[32:35], a[16:19], v[56:59], v[32:35]
    buffer_load_dwordx4 v8, s[60:63], s72 offen offset:256 sc1 lds
    v_mfma_f32_16x16x32_bf16 v[32:35], a[24:27], v[60:63], v[32:35]
    v_exp_f32 v80, -v24
    v_mfma_f32_16x16x32_bf16 v[36:39], a[28:31], v[60:63], v[36:39]
    s_waitcnt lgkmcnt(2)
    v_exp_f32 v81, -v25
    v_mfma_f32_16x16x32_bf16 v[36:39], a[36:39], v[64:67], v[36:39]
    s_add_u32 m0, s43, 81408
    ds_read_b128 v[56:59], v96 offset:20480
    ds_read_b128 v[60:63], v97 offset:20480
    v_mfma_f32_16x16x32_bf16 v[32:35], a[32:35], v[64:67], v[32:35]
    buffer_load_dwordx4 v8, s[60:63], s72 offen offset:512 sc1 lds
    v_add_f32 v80, 1.0, v80
    v_mfma_f32_16x16x32_bf16 v[32:35], a[40:43], v[68:71], v[32:35]
    v_rcp_f32 v80, v80
    v_mfma_f32_16x16x32_bf16 v[36:39], a[44:47], v[68:71], v[36:39]
    s_waitcnt lgkmcnt(2)
    v_exp_f32 v82, -v26
    v_mfma_f32_16x16x32_bf16 v[36:39], a[52:55], v[72:75], v[36:39]
    s_add_u32 m0, s43, 89344
    ds_read_b128 v[64:67], v98 offset:20480
    ds_read_b128 v[68:71], v99 offset:20480
    v_mfma_f32_16x16x32_bf16 v[32:35], a[48:51], v[72:75], v[32:35]
    buffer_load_dwordx4 v8, s[60:63], s72 offen offset:768 sc1 lds
    v_mul_f32 v80, v80, v24
    v_mfma_f32_16x16x32_bf16 v[32:35], a[56:59], v[76:79], v[32:35]
    v_exp_f32 v83, -v27
    v_mfma_f32_16x16x32_bf16 v[36:39], a[60:63], v[76:79], v[36:39]
    s_waitcnt lgkmcnt(2)
    v_exp_f32 v84, -v28
    v_mfma_f32_16x16x32_bf16 v[36:39], a[68:71], v[56:59], v[36:39]
    s_add_u32 m0, s43, 69632
    ds_read_b128 v[72:75], v96 offset:28672
    ds_read_b128 v[76:79], v97 offset:28672
    v_mfma_f32_16x16x32_bf16 v[32:35], a[64:67], v[56:59], v[32:35]
    s_mov_b32 s72, 81920
    v_exp_f32 v85, -v29
    v_add_f32 v81, 1.0, v81
    v_mfma_f32_16x16x32_bf16 v[32:35], a[72:75], v[60:63], v[32:35]
    buffer_load_dwordx4 v8, s[60:63], s72 offen offset:0 sc1 lds
    v_mfma_f32_16x16x32_bf16 v[36:39], a[76:79], v[60:63], v[36:39]
    s_waitcnt lgkmcnt(2)
    v_rcp_f32 v81, v81
    v_mfma_f32_16x16x32_bf16 v[36:39], a[84:87], v[64:67], v[36:39]
    s_add_u32 m0, s43, 77568
    ds_read_b128 v[56:59], v98 offset:28672
    ds_read_b128 v[60:63], v99 offset:28672
    v_mfma_f32_16x16x32_bf16 v[32:35], a[80:83], v[64:67], v[32:35]
    buffer_load_dwordx4 v8, s[60:63], s72 offen offset:256 sc1 lds
    v_mul_f32 v81, v81, v25
    v_mfma_f32_16x16x32_bf16 v[32:35], a[88:91], v[68:71], v[32:35]
    s_waitcnt vmcnt(10)
    s_barrier
    v_mfma_f32_16x16x32_bf16 v[36:39], a[92:95], v[68:71], v[36:39]
    s_waitcnt lgkmcnt(2)
    v_exp_f32 v86, -v30
    v_mfma_f32_16x16x32_bf16 v[36:39], a[100:103], v[72:75], v[36:39]
    s_add_u32 m0, s43, 85504
    ds_read_b128 v[64:67], v96 offset:32768
    ds_read_b128 v[68:71], v97 offset:32768
    v_mfma_f32_16x16x32_bf16 v[32:35], a[96:99], v[72:75], v[32:35]
    buffer_load_dwordx4 v8, s[60:63], s72 offen offset:512 sc1 lds
    v_cvt_pk_bf16_f32 v88, v80, v81
    v_mfma_f32_16x16x32_bf16 v[32:35], a[104:107], v[76:79], v[32:35]
    v_exp_f32 v87, -v31
    v_mfma_f32_16x16x32_bf16 v[36:39], a[108:111], v[76:79], v[36:39]
    s_waitcnt lgkmcnt(2)
    v_add_f32 v82, 1.0, v82
    v_add_f32 v83, 1.0, v83
    v_mfma_f32_16x16x32_bf16 v[36:39], a[116:119], v[56:59], v[36:39]
    s_add_u32 m0, s43, 93440
    ds_read_b128 v[72:75], v98 offset:32768
    ds_read_b128 v[76:79], v99 offset:32768
    v_mfma_f32_16x16x32_bf16 v[32:35], a[112:115], v[56:59], v[32:35]
    buffer_load_dwordx4 v8, s[60:63], s72 offen offset:768 sc1 lds
    v_add_f32 v84, 1.0, v84
    v_mfma_f32_16x16x32_bf16 v[32:35], a[120:123], v[60:63], v[32:35]
    v_rcp_f32 v82, v82
    v_mfma_f32_16x16x32_bf16 v[36:39], a[124:127], v[60:63], v[36:39]
    s_waitcnt lgkmcnt(2)
    v_rcp_f32 v83, v83
    v_mfma_f32_16x16x32_bf16 v[44:47], a[4:7], v[64:67], 0
    s_add_u32 m0, s43, 98304
    ds_read_b128 v[56:59], v96 offset:40960
    ds_read_b128 v[60:63], v97 offset:40960
    v_mfma_f32_16x16x32_bf16 v[40:43], a[0:3], v[64:67], 0
    s_mov_b32 s72, 98304
    v_rcp_f32 v84, v84
    v_mul_f32 v82, v82, v26
    v_mfma_f32_16x16x32_bf16 v[40:43], a[8:11], v[68:71], v[40:43]
    buffer_load_dwordx4 v8, s[60:63], s72 offen offset:0 sc1 lds
    v_mfma_f32_16x16x32_bf16 v[44:47], a[12:15], v[68:71], v[44:47]
    s_waitcnt lgkmcnt(2)
    v_mul_f32 v83, v83, v27
    v_mul_f32 v84, v84, v28
    v_mfma_f32_16x16x32_bf16 v[44:47], a[20:23], v[72:75], v[44:47]
    s_add_u32 m0, s43, 106240
    ds_read_b128 v[64:67], v98 offset:40960
    ds_read_b128 v[68:71], v99 offset:40960
    v_mfma_f32_16x16x32_bf16 v[40:43], a[16:19], v[72:75], v[40:43]
    buffer_load_dwordx4 v8, s[60:63], s72 offen offset:256 sc1 lds
    v_cvt_pk_bf16_f32 v89, v82, v83
    v_mfma_f32_16x16x32_bf16 v[40:43], a[24:27], v[76:79], v[40:43]
    v_add_f32 v85, 1.0, v85
    v_add_f32 v86, 1.0, v86
    v_mfma_f32_16x16x32_bf16 v[44:47], a[28:31], v[76:79], v[44:47]
    s_waitcnt lgkmcnt(2)
    v_rcp_f32 v85, v85
    v_mfma_f32_16x16x32_bf16 v[44:47], a[36:39], v[56:59], v[44:47]
    s_add_u32 m0, s43, 114176
    ds_read_b128 v[72:75], v96 offset:49152
    ds_read_b128 v[76:79], v97 offset:49152
    v_mfma_f32_16x16x32_bf16 v[40:43], a[32:35], v[56:59], v[40:43]
    buffer_load_dwordx4 v8, s[60:63], s72 offen offset:512 sc1 lds
    v_mul_f32 v85, v85, v29
    v_mfma_f32_16x16x32_bf16 v[40:43], a[40:43], v[60:63], v[40:43]
    v_rcp_f32 v86, v86
    v_mfma_f32_16x16x32_bf16 v[44:47], a[44:47], v[60:63], v[44:47]
    s_waitcnt lgkmcnt(2)
    v_cvt_pk_bf16_f32 v90, v84, v85
    v_mul_f32 v86, v86, v30
    v_mfma_f32_16x16x32_bf16 v[44:47], a[52:55], v[64:67], v[44:47]
    s_add_u32 m0, s43, 122112
    ds_read_b128 v[56:59], v98 offset:49152
    ds_read_b128 v[60:63], v99 offset:49152
    v_mfma_f32_16x16x32_bf16 v[40:43], a[48:51], v[64:67], v[40:43]
    buffer_load_dwordx4 v8, s[60:63], s72 offen offset:768 sc1 lds
    v_add_f32 v87, 1.0, v87
    v_mfma_f32_16x16x32_bf16 v[40:43], a[56:59], v[68:71], v[40:43]
    v_rcp_f32 v87, v87
    v_mfma_f32_16x16x32_bf16 v[44:47], a[60:63], v[68:71], v[44:47]
    s_waitcnt lgkmcnt(2)
    v_mul_f32 v87, v87, v31
    v_mfma_f32_16x16x32_bf16 v[44:47], a[68:71], v[72:75], v[44:47]
    s_add_u32 m0, s43, 102400
    ds_read_b128 v[64:67], v96 offset:57344
    ds_read_b128 v[68:71], v97 offset:57344
    v_mfma_f32_16x16x32_bf16 v[40:43], a[64:67], v[72:75], v[40:43]
    s_mov_b32 s72, 114688
    v_cvt_pk_bf16_f32 v91, v86, v87
    v_mfma_f32_16x16x32_bf16 v[40:43], a[72:75], v[76:79], v[40:43]
    buffer_load_dwordx4 v8, s[60:63], s72 offen offset:0 sc1 lds
    v_mfma_f32_16x16x32_bf16 v[44:47], a[76:79], v[76:79], v[44:47]
    s_waitcnt lgkmcnt(2)
    s_mov_b32 s75, 0
    buffer_store_dwordx4 v[88:91], v6, s[60:63], s75 offen sc1
    v_mfma_f32_16x16x32_bf16 v[44:47], a[84:87], v[56:59], v[44:47]
    s_add_u32 m0, s43, 110336
    ds_read_b128 v[72:75], v98 offset:57344
    ds_read_b128 v[76:79], v99 offset:57344
    v_mfma_f32_16x16x32_bf16 v[40:43], a[80:83], v[56:59], v[40:43]
    buffer_load_dwordx4 v8, s[60:63], s72 offen offset:256 sc1 lds
    v_mfma_f32_16x16x32_bf16 v[40:43], a[88:91], v[60:63], v[40:43]
    s_waitcnt vmcnt(11)
    s_barrier
    v_mfma_f32_16x16x32_bf16 v[44:47], a[92:95], v[60:63], v[44:47]
    s_waitcnt lgkmcnt(2)
    v_exp_f32 v80, -v32
    v_mfma_f32_16x16x32_bf16 v[44:47], a[100:103], v[64:67], v[44:47]
    s_add_u32 m0, s43, 118272
    ds_read_b128 v[56:59], v96 offset:36864
    ds_read_b128 v[60:63], v97 offset:36864
    v_add_f32 v80, 1.0, v80
    v_mfma_f32_16x16x32_bf16 v[40:43], a[96:99], v[64:67], v[40:43]
    buffer_load_dwordx4 v8, s[60:63], s72 offen offset:512 sc1 lds
    v_mfma_f32_16x16x32_bf16 v[40:43], a[104:107], v[68:71], v[40:43]
    v_rcp_f32 v80, v80
    v_exp_f32 v81, -v33
    v_mfma_f32_16x16x32_bf16 v[44:47], a[108:111], v[68:71], v[44:47]
    s_waitcnt lgkmcnt(2)
    v_exp_f32 v82, -v34
    v_mul_f32 v80, v80, v32
    v_mfma_f32_16x16x32_bf16 v[44:47], a[116:119], v[72:75], v[44:47]
    s_add_u32 m0, s43, 126208
    ds_read_b128 v[64:67], v98 offset:36864
    ds_read_b128 v[68:71], v99 offset:36864
    v_add_f32 v81, 1.0, v81
    v_mfma_f32_16x16x32_bf16 v[40:43], a[112:115], v[72:75], v[40:43]
    buffer_load_dwordx4 v8, s[60:63], s72 offen offset:768 sc1 lds
    v_add_f32 v82, 1.0, v82
    v_mfma_f32_16x16x32_bf16 v[40:43], a[120:123], v[76:79], v[40:43]
    s_add_u32 m0, s3, 135168
    v_rcp_f32 v81, v81
    v_mfma_f32_16x16x32_bf16 v[44:47], a[124:127], v[76:79], v[44:47]
    s_waitcnt lgkmcnt(2)
    v_rcp_f32 v82, v82
    v_mul_f32 v81, v81, v33
    v_mfma_f32_16x16x32_bf16 v[52:55], a[4:7], v[56:59], 0
    s_lshl_b32 s77, s38, 5
    ds_read_b128 v[72:75], v96 offset:45056
    ds_read_b128 v[76:79], v97 offset:45056
    v_cvt_pk_bf16_f32 v92, v80, v81
    v_mfma_f32_16x16x32_bf16 v[48:51], a[0:3], v[56:59], 0
    buffer_load_dwordx4 v15, s[48:51], s77 offen lds
    v_mul_f32 v82, v82, v34
    v_mfma_f32_16x16x32_bf16 v[48:51], a[8:11], v[60:63], v[48:51]
    s_add_u32 m0, s3, 136192
    v_exp_f32 v83, -v35
    v_exp_f32 v84, -v36
    v_mfma_f32_16x16x32_bf16 v[52:55], a[12:15], v[60:63], v[52:55]
    s_waitcnt lgkmcnt(2)
    v_exp_f32 v85, -v37
    v_add_f32 v83, 1.0, v83
    v_mfma_f32_16x16x32_bf16 v[52:55], a[20:23], v[64:67], v[52:55]
    s_add_u32 s77, s77, 8192
    ds_read_b128 v[56:59], v98 offset:45056
    ds_read_b128 v[60:63], v99 offset:45056
    v_add_f32 v84, 1.0, v84
    v_mfma_f32_16x16x32_bf16 v[48:51], a[16:19], v[64:67], v[48:51]
    buffer_load_dwordx4 v15, s[48:51], s77 offen lds
    v_add_f32 v85, 1.0, v85
    v_mfma_f32_16x16x32_bf16 v[48:51], a[24:27], v[68:71], v[48:51]
    s_add_u32 m0, s3, 137216
    v_rcp_f32 v83, v83
    v_mfma_f32_16x16x32_bf16 v[52:55], a[28:31], v[68:71], v[52:55]
    s_waitcnt lgkmcnt(2)
    v_rcp_f32 v84, v84
    v_mul_f32 v83, v83, v35
    v_mfma_f32_16x16x32_bf16 v[52:55], a[36:39], v[72:75], v[52:55]
    s_add_u32 s77, s77, 8192
    ds_read_b128 v[64:67], v96 offset:53248
    ds_read_b128 v[68:71], v97 offset:53248
    v_cvt_pk_bf16_f32 v93, v82, v83
    v_mfma_f32_16x16x32_bf16 v[48:51], a[32:35], v[72:75], v[48:51]
    buffer_load_dwordx4 v15, s[48:51], s77 offen lds
    v_mul_f32 v84, v84, v36
    v_mfma_f32_16x16x32_bf16 v[48:51], a[40:43], v[76:79], v[48:51]
    s_add_u32 m0, s3, 138240
    v_rcp_f32 v85, v85
    v_exp_f32 v86, -v38
    v_mfma_f32_16x16x32_bf16 v[52:55], a[44:47], v[76:79], v[52:55]
    s_waitcnt lgkmcnt(2)
    v_exp_f32 v87, -v39
    v_mul_f32 v85, v85, v37
    v_mfma_f32_16x16x32_bf16 v[52:55], a[52:55], v[56:59], v[52:55]
    s_add_u32 s77, s77, 8192
    ds_read_b128 v[72:75], v98 offset:53248
    ds_read_b128 v[76:79], v99 offset:53248
    v_cvt_pk_bf16_f32 v94, v84, v85
    v_mfma_f32_16x16x32_bf16 v[48:51], a[48:51], v[56:59], v[48:51]
    buffer_load_dwordx4 v15, s[48:51], s77 offen lds
L_hop_4:
    s_cbranch_execz L_hop_back0
    v_add_f32 v86, 1.0, v86
    v_mfma_f32_16x16x32_bf16 v[48:51], a[56:59], v[60:63], v[48:51]
    v_rcp_f32 v86, v86
    v_add_f32 v87, 1.0, v87
    v_mfma_f32_16x16x32_bf16 v[52:55], a[60:63], v[60:63], v[52:55]
    s_waitcnt lgkmcnt(2)
    v_rcp_f32 v87, v87
    v_mul_f32 v86, v86, v38
    v_mfma_f32_16x16x32_bf16 v[52:55], a[68:71], v[64:67], v[52:55]
    s_add_u32 m0, s3, 0
    ds_read_b128 v[56:59], v96 offset:61440
    ds_read_b128 v[60:63], v97 offset:61440
    v_mul_f32 v87, v87, v39
    v_mfma_f32_16x16x32_bf16 v[48:51], a[64:67], v[64:67], v[48:51]
    s_lshl_b32 s77, s39, 5
    v_xor_b32 v96, 0x10000, v96
    v_xor_b32 v97, 0x10000, v97
    v_cvt_pk_bf16_f32 v95, v86, v87
    v_mfma_f32_16x16x32_bf16 v[48:51], a[72:75], v[68:71], v[48:51]
    s_mov_b32 s75, 57344
    buffer_load_dwordx4 v15, s[48:51], s77 offen lds
    buffer_store_dwordx4 v[92:95], v6, s[60:63], s75 offen sc1
    v_mfma_f32_16x16x32_bf16 v[52:55], a[76:79], v[68:71], v[52:55]
    s_waitcnt lgkmcnt(2)
    v_exp_f32 v80, -v40
    v_mfma_f32_16x16x32_bf16 v[52:55], a[84:87], v[72:75], v[52:55]
    ds_read_b128 v[64:67], v98 offset:61440
    ds_read_b128 v[68:71], v99 offset:61440
    v_add_f32 v80, 1.0, v80
    v_mfma_f32_16x16x32_bf16 v[48:51], a[80:83], v[72:75], v[48:51]
    v_xor_b32 v98, 0x10000, v98
    v_xor_b32 v99, 0x10000, v99
    v_mfma_f32_16x16x32_bf16 v[48:51], a[88:91], v[76:79], v[48:51]
    s_add_u32 m0, s3, 1024
    v_rcp_f32 v80, v80
    v_mfma_f32_16x16x32_bf16 v[52:55], a[92:95], v[76:79], v[52:55]
    s_waitcnt lgkmcnt(2)
    v_exp_f32 v81, -v41
    v_mul_f32 v80, v80, v40
    v_mfma_f32_16x16x32_bf16 v[52:55], a[100:103], v[56:59], v[52:55]
    s_add_u32 s77, s77, 8192
    ds_read_b128 v[72:75], v96 offset:0
    ds_read_b128 v[76:79], v97 offset:0
    v_mfma_f32_16x16x32_bf16 v[48:51], a[96:99], v[56:59], v[48:51]
    buffer_load_dwordx4 v15, s[48:51], s77 offen lds
    v_add_f32 v81, 1.0, v81
    v_mfma_f32_16x16x32_bf16 v[48:51], a[104:107], v[60:63], v[48:51]
    v_rcp_f32 v81, v81
    v_mfma_f32_16x16x32_bf16 v[52:55], a[108:111], v[60:63], v[52:55]
    s_waitcnt lgkmcnt(2)
    v_exp_f32 v82, -v42
    v_mfma_f32_16x16x32_bf16 v[52:55], a[116:119], v[64:67], v[52:55]
    s_add_u32 m0, s3, 2048
    ds_read_b128 v[56:59], v98 offset:0
    ds_read_b128 v[60:63], v99 offset:0
    v_mul_f32 v81, v81, v41
    v_mfma_f32_16x16x32_bf16 v[48:51], a[112:115], v[64:67], v[48:51]
    s_add_u32 s77, s77, 8192
    v_exp_f32 v83, -v43
    v_mfma_f32_16x16x32_bf16 v[48:51], a[120:123], v[68:71], v[48:51]
    buffer_load_dwordx4 v15, s[48:51], s77 offen lds
    v_mfma_f32_16x16x32_bf16 v[52:55], a[124:127], v[68:71], v[52:55]
    s_waitcnt lgkmcnt(2)
    v_exp_f32 v84, -v44
    v_cvt_pk_bf16_f32 v88, v80, v81
    v_mfma_f32_16x16x32_bf16 v[28:31], a[4:7], v[72:75], 0
    ds_read_b128 v[64:67], v96 offset:8192
    ds_read_b128 v[68:71], v97 offset:8192
    v_mfma_f32_16x16x32_bf16 v[24:27], a[0:3], v[72:75], 0
    v_exp_f32 v85, -v45
    v_add_f32 v82, 1.0, v82
    v_mfma_f32_16x16x32_bf16 v[24:27], a[8:11], v[76:79], v[24:27]
    s_add_u32 m0, s3, 3072
    v_rcp_f32 v82, v82
    v_mfma_f32_16x16x32_bf16 v[28:31], a[12:15], v[76:79], v[28:31]
    s_waitcnt lgkmcnt(2)
    v_exp_f32 v86, -v46
    v_mfma_f32_16x16x32_bf16 v[28:31], a[20:23], v[56:59], v[28:31]
    s_add_u32 s77, s77, 8192
    ds_read_b128 v[72:75], v98 offset:8192
    ds_read_b128 v[76:79], v99 offset:8192
    v_mul_f32 v82, v82, v42
    v_mfma_f32_16x16x32_bf16 v[24:27], a[16:19], v[56:59], v[24:27]
    buffer_load_dwordx4 v15, s[48:51], s77 offen lds
    v_mfma_f32_16x16x32_bf16 v[24:27], a[24:27], v[60:63], v[24:27]
    v_exp_f32 v87, -v47
    v_mfma_f32_16x16x32_bf16 v[28:31], a[28:31], v[60:63], v[28:31]
    s_waitcnt lgkmcnt(2)
    v_add_f32 v83, 1.0, v83
    v_add_f32 v84, 1.0, v84
    v_add_f32 v85, 1.0, v85
    v_mfma_f32_16x16x32_bf16 v[28:31], a[36:39], v[64:67], v[28:31]
    s_add_u32 m0, s3, 4096
    ds_read_b128 v[56:59], v96 offset:16384
    ds_read_b128 v[60:63], v97 offset:16384
    v_mfma_f32_16x16x32_bf16 v[24:27], a[32:35], v[64:67], v[24:27]
    s_lshl_b32 s77, s40, 5
    v_rcp_f32 v83, v83
    v_add_f32 v86, 1.0, v86
    v_mfma_f32_16x16x32_bf16 v[24:27], a[40:43], v[68:71], v[24:27]
    buffer_load_dwordx4 v15, s[48:51], s77 offen lds
    v_mfma_f32_16x16x32_bf16 v[28:31], a[44:47], v[68:71], v[28:31]
    s_waitcnt lgkmcnt(2)
    v_rcp_f32 v84, v84
    v_mfma_f32_16x16x32_bf16 v[28:31], a[52:55], v[72:75], v[28:31]
    ds_read_b128 v[64:67], v98 offset:16384
    ds_read_b128 v[68:71], v99 offset:16384
    v_mul_f32 v83, v83, v43
    v_mfma_f32_16x16x32_bf16 v[24:27], a[48:51], v[72:75], v[24:27]
    v_rcp_f32 v85, v85
    v_mfma_f32_16x16x32_bf16 v[24:27], a[56:59], v[76:79], v[24:27]
    s_add_u32 m0, s3, 5120
    v_rcp_f32 v86, v86
    v_mfma_f32_16x16x32_bf16 v[28:31], a[60:63], v[76:79], v[28:31]
    s_waitcnt lgkmcnt(2)
    v_cvt_pk_bf16_f32 v89, v82, v83
    v_mul_f32 v84, v84, v44
    v_mul_f32 v85, v85, v45
    v_mfma_f32_16x16x32_bf16 v[28:31], a[68:71], v[56:59], v[28:31]
    s_add_u32 s77, s77, 8192
    ds_read_b128 v[72:75], v96 offset:24576
    ds_read_b128 v[76:79], v97 offset:24576
    v_mfma_f32_16x16x32_bf16 v[24:27], a[64:67], v[56:59], v[24:27]
    buffer_load_dwordx4 v15, s[48:51], s77 offen lds
    v_cvt_pk_bf16_f32 v90, v84, v85
    v_mfma_f32_16x16x32_bf16 v[24:27], a[72:75], v[60:63], v[24:27]
    v_mul_f32 v86, v86, v46
    v_add_f32 v87, 1.0, v87
    v_mfma_f32_16x16x32_bf16 v[28:31], a[76:79], v[60:63], v[28:31]
    s_waitcnt lgkmcnt(2)
    v_rcp_f32 v87, v87
    v_mfma_f32_16x16x32_bf16 v[28:31], a[84:87], v[64:67], v[28:31]
    s_add_u32 m0, s3, 6144
    ds_read_b128 v[56:59], v98 offset:24576
    ds_read_b128 v[60:63], v99 offset:24576
    v_mul_f32 v87, v87, v47
    v_mfma_f32_16x16x32_bf16 v[24:27], a[80:83], v[64:67], v[24:27]
    s_add_u32 s77, s77, 8192
    v_cvt_pk_bf16_f32 v91, v86, v87
    v_mfma_f32_16x16x32_bf16 v[24:27], a[88:91], v[68:71], v[24:27]
    s_waitcnt vmcnt(11)
    s_barrier
    v_mfma_f32_16x16x32_bf16 v[28:31], a[92:95], v[68:71], v[28:31]
    s_waitcnt lgkmcnt(2)
    buffer_load_dwordx4 v15, s[48:51], s77 offen lds
    v_mfma_f32_16x16x32_bf16 v[28:31], a[100:103], v[72:75], v[28:31]
    ds_read_b128 v[64:67], v96 offset:4096
    ds_read_b128 v[68:71], v97 offset:4096
    v_mfma_f32_16x16x32_bf16 v[24:27], a[96:99], v[72:75], v[24:27]
    s_mov_b32 s75, 114688
    buffer_store_dwordx4 v[88:91], v6, s[60:63], s75 offen sc1
    v_or_b32 v16, 4, v17
    v_mfma_f32_16x16x32_bf16 v[24:27], a[104:107], v[76:79], v[24:27]
    s_add_u32 m0, s3, 7168
    v_exp_f32 v80, -v48
    v_mfma_f32_16x16x32_bf16 v[28:31], a[108:111], v[76:79], v[28:31]
    s_waitcnt lgkmcnt(2)
    v_exp_f32 v81, -v49
    v_add_f32 v80, 1.0, v80
    v_mfma_f32_16x16x32_bf16 v[28:31], a[116:119], v[56:59], v[28:31]
    s_add_u32 s77, s77, 8192
    ds_read_b128 v[72:75], v98 offset:4096
    ds_read_b128 v[76:79], v99 offset:4096
    v_mfma_f32_16x16x32_bf16 v[24:27], a[112:115], v[56:59], v[24:27]
    buffer_load_dwordx4 v15, s[48:51], s77 offen lds
    v_mfma_f32_16x16x32_bf16 v[24:27], a[120:123], v[60:63], v[24:27]
    v_rcp_f32 v80, v80
    v_add_f32 v81, 1.0, v81
    v_mfma_f32_16x16x32_bf16 v[28:31], a[124:127], v[60:63], v[28:31]
    s_waitcnt lgkmcnt(2)
    v_rcp_f32 v81, v81
    v_mfma_f32_16x16x32_bf16 v[36:39], a[4:7], v[64:67], 0
    s_add_u32 m0, s3, 32768
    ds_read_b128 v[56:59], v96 offset:12288
    ds_read_b128 v[60:63], v97 offset:12288
    v_mul_f32 v80, v80, v48
    v_mfma_f32_16x16x32_bf16 v[32:35], a[0:3], v[64:67], 0
    s_lshl_b32 s77, s41, 5
    v_exp_f32 v82, -v50
    v_mfma_f32_16x16x32_bf16 v[32:35], a[8:11], v[68:71], v[32:35]
    buffer_load_dwordx4 v15, s[48:51], s77 offen lds
    v_mfma_f32_16x16x32_bf16 v[36:39], a[12:15], v[68:71], v[36:39]
    s_waitcnt lgkmcnt(2)
    v_exp_f32 v83, -v51
    v_mul_f32 v81, v81, v49
    v_mfma_f32_16x16x32_bf16 v[36:39], a[20:23], v[72:75], v[36:39]
    ds_read_b128 v[64:67], v98 offset:12288
    ds_read_b128 v[68:71], v99 offset:12288
    v_mfma_f32_16x16x32_bf16 v[32:35], a[16:19], v[72:75], v[32:35]
    v_exp_f32 v84, -v52
    v_mfma_f32_16x16x32_bf16 v[32:35], a[24:27], v[76:79], v[32:35]
    s_add_u32 m0, s3, 33792
    v_exp_f32 v85, -v53
    v_cvt_pk_bf16_f32 v92, v80, v81
    v_mfma_f32_16x16x32_bf16 v[36:39], a[28:31], v[76:79], v[36:39]
    s_waitcnt lgkmcnt(2)
    v_exp_f32 v86, -v54
    v_mfma_f32_16x16x32_bf16 v[36:39], a[36:39], v[56:59], v[36:39]
    s_add_u32 s77, s77, 8192
    ds_read_b128 v[72:75], v96 offset:20480
    ds_read_b128 v[76:79], v97 offset:20480
    v_add_f32 v82, 1.0, v82
    v_mfma_f32_16x16x32_bf16 v[32:35], a[32:35], v[56:59], v[32:35]
    buffer_load_dwordx4 v15, s[48:51], s77 offen lds
    v_mfma_f32_16x16x32_bf16 v[32:35], a[40:43], v[60:63], v[32:35]
    v_rcp_f32 v82, v82
    v_mfma_f32_16x16x32_bf16 v[36:39], a[44:47], v[60:63], v[36:39]
    s_waitcnt lgkmcnt(2)
    v_exp_f32 v87, -v55
    v_mul_f32 v82, v82, v50
    v_mfma_f32_16x16x32_bf16 v[36:39], a[52:55], v[64:67], v[36:39]
    s_add_u32 m0, s3, 34816
    ds_read_b128 v[56:59], v98 offset:20480
    ds_read_b128 v[60:63], v99 offset:20480
    v_mfma_f32_16x16x32_bf16 v[32:35], a[48:51], v[64:67], v[32:35]
    s_add_u32 s77, s77, 8192
    v_add_f32 v83, 1.0, v83
    v_add_f32 v84, 1.0, v84
    v_mfma_f32_16x16x32_bf16 v[32:35], a[56:59], v[68:71], v[32:35]
    buffer_load_dwordx4 v15, s[48:51], s77 offen lds
    v_add_f32 v85, 1.0, v85
    v_mfma_f32_16x16x32_bf16 v[36:39], a[60:63], v[68:71], v[36:39]
    s_waitcnt lgkmcnt(2)
    v_rcp_f32 v83, v83
    v_mfma_f32_16x16x32_bf16 v[36:39], a[68:71], v[72:75], v[36:39]
    ds_read_b128 v[64:67], v96 offset:28672
    ds_read_b128 v[68:71], v97 offset:28672
    v_mul_f32 v83, v83, v51
    v_mfma_f32_16x16x32_bf16 v[32:35], a[64:67], v[72:75], v[32:35]
    s_waitcnt vmcnt(11)
    buffer_store_dword v16, v3, s[60:63], 0 offen
    v_mfma_f32_16x16x32_bf16 v[32:35], a[72:75], v[76:79], v[32:35]
    s_add_u32 m0, s3, 35840
    v_rcp_f32 v84, v84
    v_mfma_f32_16x16x32_bf16 v[36:39], a[76:79], v[76:79], v[36:39]
    s_waitcnt lgkmcnt(2)
    v_rcp_f32 v85, v85
    v_cvt_pk_bf16_f32 v93, v82, v83
    v_mfma_f32_16x16x32_bf16 v[36:39], a[84:87], v[56:59], v[36:39]
    s_add_u32 s77, s77, 8192
    ds_read_b128 v[72:75], v98 offset:28672
    ds_read_b128 v[76:79], v99 offset:28672
    v_mfma_f32_16x16x32_bf16 v[32:35], a[80:83], v[56:59], v[32:35]
    buffer_load_dwordx4 v15, s[48:51], s77 offen lds
    v_mfma_f32_16x16x32_bf16 v[32:35], a[88:91], v[60:63], v[32:35]
    v_mul_f32 v84, v84, v52
    v_mul_f32 v85, v85, v53
    v_add_f32 v86, 1.0, v86
    v_mfma_f32_16x16x32_bf16 v[36:39], a[92:95], v[60:63], v[36:39]
    s_waitcnt lgkmcnt(2)
    v_rcp_f32 v86, v86
    v_mfma_f32_16x16x32_bf16 v[36:39], a[100:103], v[64:67], v[36:39]
    ds_read_b128 v[56:59], v96 offset:32768
    ds_read_b128 v[60:63], v97 offset:32768
    v_cvt_pk_bf16_f32 v94, v84, v85
    v_mfma_f32_16x16x32_bf16 v[32:35], a[96:99], v[64:67], v[32:35]
    v_mul_f32 v86, v86, v54
    v_add_f32 v87, 1.0, v87
    v_mfma_f32_16x16x32_bf16 v[32:35], a[104:107], v[68:71], v[32:35]
    v_rcp_f32 v87, v87
    v_mfma_f32_16x16x32_bf16 v[36:39], a[108:111], v[68:71], v[36:39]
    s_waitcnt lgkmcnt(2)
    v_mul_f32 v87, v87, v55
    v_mfma_f32_16x16x32_bf16 v[36:39], a[116:119], v[72:75], v[36:39]
    ds_read_b128 v[64:67], v98 offset:32768
    ds_read_b128 v[68:71], v99 offset:32768
    v_mfma_f32_16x16x32_bf16 v[32:35], a[112:115], v[72:75], v[32:35]
    v_cvt_pk_bf16_f32 v95, v86, v87
    v_mfma_f32_16x16x32_bf16 v[32:35], a[120:123], v[76:79], v[32:35]
    s_mov_b32 s75, 172032
    buffer_store_dwordx4 v[92:95], v6, s[60:63], s75 offen sc1
    v_mfma_f32_16x16x32_bf16 v[36:39], a[124:127], v[76:79], v[36:39]
    s_waitcnt lgkmcnt(2)
    v_or_b32 v16, 5, v17
    v_mfma_f32_16x16x32_bf16 v[44:47], a[4:7], v[56:59], 0
    ds_read_b128 v[72:75], v96 offset:40960
    ds_read_b128 v[76:79], v97 offset:40960
    v_mfma_f32_16x16x32_bf16 v[40:43], a[0:3], v[56:59], 0
    v_exp_f32 v80, -v24
    v_mfma_f32_16x16x32_bf16 v[40:43], a[8:11], v[60:63], v[40:43]
    v_exp_f32 v81, -v25
    v_mfma_f32_16x16x32_bf16 v[44:47], a[12:15], v[60:63], v[44:47]
    s_waitcnt lgkmcnt(2)
    v_exp_f32 v82, -v26
    v_mfma_f32_16x16x32_bf16 v[44:47], a[20:23], v[64:67], v[44:47]
    ds_read_b128 v[56:59], v98 offset:40960
    ds_read_b128 v[60:63], v99 offset:40960
    v_mfma_f32_16x16x32_bf16 v[40:43], a[16:19], v[64:67], v[40:43]
    v_exp_f32 v83, -v27
    v_add_f32 v80, 1.0, v80
    v_mfma_f32_16x16x32_bf16 v[40:43], a[24:27], v[68:71], v[40:43]
    v_rcp_f32 v80, v80
    v_mfma_f32_16x16x32_bf16 v[44:47], a[28:31], v[68:71], v[44:47]
    s_waitcnt lgkmcnt(2)
    v_exp_f32 v84, -v28
    v_mfma_f32_16x16x32_bf16 v[44:47], a[36:39], v[72:75], v[44:47]
    ds_read_b128 v[64:67], v96 offset:49152
    ds_read_b128 v[68:71], v97 offset:49152
    v_mfma_f32_16x16x32_bf16 v[40:43], a[32:35], v[72:75], v[40:43]
    v_exp_f32 v85, -v29
    v_mul_f32 v80, v80, v24
    v_mfma_f32_16x16x32_bf16 v[40:43], a[40:43], v[76:79], v[40:43]
    v_exp_f32 v86, -v30
    v_mfma_f32_16x16x32_bf16 v[44:47], a[44:47], v[76:79], v[44:47]
    s_waitcnt lgkmcnt(2)
    v_exp_f32 v87, -v31
    v_mfma_f32_16x16x32_bf16 v[44:47], a[52:55], v[56:59], v[44:47]
    ds_read_b128 v[72:75], v98 offset:49152
    ds_read_b128 v[76:79], v99 offset:49152
    v_mfma_f32_16x16x32_bf16 v[40:43], a[48:51], v[56:59], v[40:43]
    v_add_f32 v81, 1.0, v81
    v_add_f32 v82, 1.0, v82
    v_add_f32 v83, 1.0, v83
    v_mfma_f32_16x16x32_bf16 v[40:43], a[56:59], v[60:63], v[40:43]
    v_rcp_f32 v81, v81
    v_mfma_f32_16x16x32_bf16 v[44:47], a[60:63], v[60:63], v[44:47]
    s_waitcnt lgkmcnt(2)
    v_rcp_f32 v82, v82
    v_mfma_f32_16x16x32_bf16 v[44:47], a[68:71], v[64:67], v[44:47]
    ds_read_b128 v[56:59], v96 offset:57344
    ds_read_b128 v[60:63], v97 offset:57344
    v_mfma_f32_16x16x32_bf16 v[40:43], a[64:67], v[64:67], v[40:43]
    v_rcp_f32 v83, v83
    v_mul_f32 v81, v81, v25
    v_mfma_f32_16x16x32_bf16 v[40:43], a[72:75], v[68:71], v[40:43]
    v_cvt_pk_bf16_f32 v88, v80, v81
    v_mul_f32 v82, v82, v26
    v_mfma_f32_16x16x32_bf16 v[44:47], a[76:79], v[68:71], v[44:47]
    s_waitcnt lgkmcnt(2)
    v_mul_f32 v83, v83, v27
    v_add_f32 v84, 1.0, v84
    v_mfma_f32_16x16x32_bf16 v[44:47], a[84:87], v[72:75], v[44:47]
    ds_read_b128 v[64:67], v98 offset:57344
    ds_read_b128 v[68:71], v99 offset:57344
    v_mfma_f32_16x16x32_bf16 v[40:43], a[80:83], v[72:75], v[40:43]
    v_rcp_f32 v84, v84
    v_cvt_pk_bf16_f32 v89, v82, v83
    v_mfma_f32_16x16x32_bf16 v[40:43], a[88:91], v[76:79], v[40:43]
    v_mul_f32 v84, v84, v28
    v_add_f32 v85, 1.0, v85
    v_mfma_f32_16x16x32_bf16 v[44:47], a[92:95], v[76:79], v[44:47]
    s_waitcnt lgkmcnt(2)
    s_add_u32 s70, s69, 4
    buffer_load_dword v2, v4, s[60:63], 0 offen sc1
    v_mfma_f32_16x16x32_bf16 v[44:47], a[100:103], v[56:59], v[44:47]
    ds_read_b128 v[72:75], v96 offset:36864
    ds_read_b128 v[76:79], v97 offset:36864
    v_mfma_f32_16x16x32_bf16 v[40:43], a[96:99], v[56:59], v[40:43]
    v_rcp_f32 v85, v85
    v_add_f32 v86, 1.0, v86
    v_mfma_f32_16x16x32_bf16 v[40:43], a[104:107], v[60:63], v[40:43]
    v_rcp_f32 v86, v86
    v_mfma_f32_16x16x32_bf16 v[44:47], a[108:111], v[60:63], v[44:47]
    s_waitcnt lgkmcnt(2)
    v_mul_f32 v85, v85, v29
    v_mul_f32 v86, v86, v30
    v_mfma_f32_16x16x32_bf16 v[44:47], a[116:119], v[64:67], v[44:47]
    ds_read_b128 v[56:59], v98 offset:36864
    ds_read_b128 v[60:63], v99 offset:36864
    v_mfma_f32_16x16x32_bf16 v[40:43], a[112:115], v[64:67], v[40:43]
    v_cvt_pk_bf16_f32 v90, v84, v85
    v_add_f32 v87, 1.0, v87
    v_mfma_f32_16x16x32_bf16 v[40:43], a[120:123], v[68:71], v[40:43]
    v_rcp_f32 v87, v87
    v_mfma_f32_16x16x32_bf16 v[44:47], a[124:127], v[68:71], v[44:47]
    s_waitcnt lgkmcnt(2)
    v_mul_f32 v87, v87, v31
    v_mfma_f32_16x16x32_bf16 v[52:55], a[4:7], v[72:75], 0
    ds_read_b128 v[64:67], v96 offset:45056
    ds_read_b128 v[68:71], v97 offset:45056
    v_mfma_f32_16x16x32_bf16 v[48:51], a[0:3], v[72:75], 0
    v_cvt_pk_bf16_f32 v91, v86, v87
    v_mfma_f32_16x16x32_bf16 v[48:51], a[8:11], v[76:79], v[48:51]
    s_mov_b32 s75, 229376
    buffer_store_dwordx4 v[88:91], v6, s[60:63], s75 offen sc1
    v_mfma_f32_16x16x32_bf16 v[52:55], a[12:15], v[76:79], v[52:55]
    s_waitcnt lgkmcnt(2)
    v_exp_f32 v80, -v32
    v_mfma_f32_16x16x32_bf16 v[52:55], a[20:23], v[56:59], v[52:55]
    ds_read_b128 v[72:75], v98 offset:45056
    ds_read_b128 v[76:79], v99 offset:45056
    v_add_f32 v80, 1.0, v80
    v_mfma_f32_16x16x32_bf16 v[48:51], a[16:19], v[56:59], v[48:51]
    s_waitcnt vmcnt(2)
    buffer_store_dword v16, v3, s[60:63], 0 offen
    v_mfma_f32_16x16x32_bf16 v[48:51], a[24:27], v[60:63], v[48:51]
    v_rcp_f32 v80, v80
    v_mfma_f32_16x16x32_bf16 v[52:55], a[28:31], v[60:63], v[52:55]
    s_waitcnt lgkmcnt(2)
    v_exp_f32 v81, -v33
    v_mul_f32 v80, v80, v32
    v_mfma_f32_16x16x32_bf16 v[52:55], a[36:39], v[64:67], v[52:55]
    ds_read_b128 v[56:59], v96 offset:53248
    ds_read_b128 v[60:63], v97 offset:53248
    v_add_f32 v81, 1.0, v81
    v_mfma_f32_16x16x32_bf16 v[48:51], a[32:35], v[64:67], v[48:51]
    s_waitcnt vmcnt(2)
    v_subrev_u32 v2, s70, v2
    v_cmp_le_u32 vcc, 16, v2
    v_rcp_f32 v81, v81
    v_mfma_f32_16x16x32_bf16 v[48:51], a[40:43], v[68:71], v[48:51]
    s_cbranch_vccnz L_slow_18
L_back_19:
    v_mfma_f32_16x16x32_bf16 v[52:55], a[44:47], v[68:71], v[52:55]
    s_waitcnt lgkmcnt(2)
    v_mov_b32 v20, -1
    v_mov_b32 v21, -1
    v_mul_f32 v81, v81, v33
    v_mfma_f32_16x16x32_bf16 v[52:55], a[52:55], v[72:75], v[52:55]
    ds_read_b128 v[64:67], v98 offset:53248
    ds_read_b128 v[68:71], v99 offset:53248
    v_cvt_pk_bf16_f32 v92, v80, v81
    v_mfma_f32_16x16x32_bf16 v[48:51], a[48:51], v[72:75], v[48:51]
    v_mov_b32 v22, -1
    v_mov_b32 v23, -1
    v_exp_f32 v82, -v34
    v_mfma_f32_16x16x32_bf16 v[48:51], a[56:59], v[76:79], v[48:51]
    buffer_store_dwordx4 v[20:23], v7, s[60:63], 0 offen
    v_mfma_f32_16x16x32_bf16 v[52:55], a[60:63], v[76:79], v[52:55]
    s_waitcnt lgkmcnt(2)
    buffer_store_dwordx4 v[20:23], v7, s[60:63], s86 offen
    v_mfma_f32_16x16x32_bf16 v[52:55], a[68:71], v[56:59], v[52:55]
    ds_read_b128 v[72:75], v96 offset:61440
    ds_read_b128 v[76:79], v97 offset:61440
    v_add_f32 v82, 1.0, v82
    v_mfma_f32_16x16x32_bf16 v[48:51], a[64:67], v[56:59], v[48:51]
    v_xor_b32 v96, 0x10000, v96
    v_xor_b32 v97, 0x10000, v97
    v_rcp_f32 v82, v82
    v_mfma_f32_16x16x32_bf16 v[48:51], a[72:75], v[60:63], v[48:51]
    buffer_load_dwordx4 v[100:103], v13, s[60:63], s28 offen sc1
    v_mul_f32 v82, v82, v34
    v_mfma_f32_16x16x32_bf16 v[52:55], a[76:79], v[60:63], v[52:55]
    s_waitcnt lgkmcnt(2)
    v_exp_f32 v83, -v35
    v_mfma_f32_16x16x32_bf16 v[52:55], a[84:87], v[64:67], v[52:55]
    ds_read_b128 v[56:59], v98 offset:61440
    ds_read_b128 v[60:63], v99 offset:61440
    v_add_f32 v83, 1.0, v83
    v_mfma_f32_16x16x32_bf16 v[48:51], a[80:83], v[64:67], v[48:51]
    v_xor_b32 v98, 0x10000, v98
    v_xor_b32 v99, 0x10000, v99
    v_rcp_f32 v83, v83
    v_mfma_f32_16x16x32_bf16 v[48:51], a[88:91], v[68:71], v[48:51]
    buffer_load_dwordx4 v[104:107], v13, s[60:63], s29 offen sc1
    v_mul_f32 v83, v83, v35
    v_mfma_f32_16x16x32_bf16 v[52:55], a[92:95], v[68:71], v[52:55]
    s_waitcnt lgkmcnt(2)
    v_exp_f32 v84, -v36
    v_cvt_pk_bf16_f32 v93, v82, v83
    v_mfma_f32_16x16x32_bf16 v[52:55], a[100:103], v[72:75], v[52:55]
    v_exp_f32 v85, -v37
    v_add_f32 v84, 1.0, v84
    v_mfma_f32_16x16x32_bf16 v[48:51], a[96:99], v[72:75], v[48:51]
    v_rcp_f32 v84, v84
    v_exp_f32 v86, -v38
    v_mfma_f32_16x16x32_bf16 v[48:51], a[104:107], v[76:79], v[48:51]
    buffer_load_dwordx4 v[108:111], v13, s[60:63], s30 offen sc1
    v_mul_f32 v84, v84, v36
    v_mfma_f32_16x16x32_bf16 v[52:55], a[108:111], v[76:79], v[52:55]
    s_waitcnt lgkmcnt(0)
    v_exp_f32 v87, -v39
    v_add_f32 v85, 1.0, v85
    v_mfma_f32_16x16x32_bf16 v[52:55], a[116:119], v[56:59], v[52:55]
    v_rcp_f32 v85, v85
    v_add_f32 v86, 1.0, v86
    v_mfma_f32_16x16x32_bf16 v[48:51], a[112:115], v[56:59], v[48:51]
    v_rcp_f32 v86, v86
    v_mul_f32 v85, v85, v37
    v_add_f32 v87, 1.0, v87
    v_mfma_f32_16x16x32_bf16 v[48:51], a[120:123], v[60:63], v[48:51]
    buffer_load_dwordx4 v[112:115], v13, s[60:63], s31 offen sc1
    v_cvt_pk_bf16_f32 v94, v84, v85
    v_mfma_f32_16x16x32_bf16 v[52:55], a[124:127], v[60:63], v[52:55]
    v_rcp_f32 v87, v87
    v_mul_f32 v86, v86, v38
    v_mul_f32 v87, v87, v39
    buffer_load_dwordx4 v[116:119], v13, s[60:63], s32 offen sc1
    v_cvt_pk_bf16_f32 v95, v86, v87
    s_mov_b32 s75, 286720
    buffer_store_dwordx4 v[92:95], v6, s[60:63], s75 offen sc1
    v_or_b32 v16, 6, v17
    buffer_load_dwordx4 v[120:123], v13, s[60:63], s33 offen sc1
    v_exp_f32 v80, -v40
    v_exp_f32 v81, -v41
    v_exp_f32 v82, -v42
    v_exp_f32 v83, -v43
    v_exp_f32 v84, -v44
    v_exp_f32 v85, -v45
    v_add_f32 v80, 1.0, v80
    v_add_f32 v81, 1.0, v81
    buffer_load_dwordx4 v[124:127], v13, s[60:63], s34 offen sc1
    v_rcp_f32 v80, v80
    v_add_f32 v82, 1.0, v82
    v_add_f32 v83, 1.0, v83
    v_mul_f32 v80, v80, v40
    v_add_f32 v84, 1.0, v84
    v_rcp_f32 v81, v81
    v_rcp_f32 v82, v82
    v_rcp_f32 v83, v83
    v_mul_f32 v81, v81, v41
    v_mul_f32 v82, v82, v42
    buffer_load_dwordx4 v[128:131], v13, s[60:63], s35 offen sc1
    v_rcp_f32 v84, v84
    v_exp_f32 v86, -v46
    v_cvt_pk_bf16_f32 v88, v80, v81
    v_mul_f32 v83, v83, v43
    s_add_u32 s70, s69, 5
    buffer_load_dword v2, v4, s[60:63], 0 offen sc1
    v_exp_f32 v87, -v47
    v_cvt_pk_bf16_f32 v89, v82, v83
    v_mul_f32 v84, v84, v44
    v_add_f32 v85, 1.0, v85
    v_add_f32 v86, 1.0, v86
    buffer_load_dwordx4 v[132:135], v13, s[60:63], s36 offen sc1
    v_rcp_f32 v85, v85
    v_rcp_f32 v86, v86
    v_add_f32 v87, 1.0, v87
    v_mul_f32 v85, v85, v45
    v_rcp_f32 v87, v87
    v_cvt_pk_bf16_f32 v90, v84, v85
    v_mul_f32 v86, v86, v46
    v_mul_f32 v87, v87, v47
    buffer_load_dwordx4 v[136:139], v13, s[60:63], s37 offen sc1
    v_cvt_pk_bf16_f32 v91, v86, v87
    s_mov_b32 s75, 344064
    buffer_store_dwordx4 v[88:91], v6, s[60:63], s75 offen sc1
    ds_read_b64_tr_b16 v[176:177], v18 offset:0
    ds_read_b64_tr_b16 v[178:179], v18 offset:2048
    ds_read_b64_tr_b16 v[180:181], v0 offset:0
    ds_read_b64_tr_b16 v[182:183], v0 offset:2048
    ds_read_b64_tr_b16 v[184:185], v18 offset:64
    ds_read_b64_tr_b16 v[186:187], v18 offset:2112
    ds_read_b64_tr_b16 v[188:189], v0 offset:64
    ds_read_b64_tr_b16 v[190:191], v0 offset:2112
    ds_read_b64_tr_b16 v[192:193], v18 offset:4096
    ds_read_b64_tr_b16 v[194:195], v18 offset:6144
    ds_read_b64_tr_b16 v[196:197], v0 offset:4096
    ds_read_b64_tr_b16 v[198:199], v0 offset:6144
    ds_read_b64_tr_b16 v[200:201], v18 offset:4160
    ds_read_b64_tr_b16 v[202:203], v18 offset:6208
    ds_read_b64_tr_b16 v[204:205], v0 offset:4160
    ds_read_b64_tr_b16 v[206:207], v0 offset:6208
    ds_read_b64_tr_b16 v[208:209], v9 offset:0
    ds_read_b64_tr_b16 v[210:211], v9 offset:2048
    ds_read_b64_tr_b16 v[212:213], v10 offset:0
    ds_read_b64_tr_b16 v[214:215], v10 offset:2048
    ds_read_b64_tr_b16 v[216:217], v9 offset:64
    ds_read_b64_tr_b16 v[218:219], v9 offset:2112
    ds_read_b64_tr_b16 v[220:221], v10 offset:64
    ds_read_b64_tr_b16 v[222:223], v10 offset:2112
    ds_read_b64_tr_b16 v[224:225], v9 offset:4096
    ds_read_b64_tr_b16 v[226:227], v9 offset:6144
    ds_read_b64_tr_b16 v[228:229], v10 offset:4096
    ds_read_b64_tr_b16 v[230:231], v10 offset:6144
    ds_read_b64_tr_b16 v[232:233], v9 offset:4160
    ds_read_b64_tr_b16 v[234:235], v9 offset:6208
    ds_read_b64_tr_b16 v[236:237], v10 offset:4160
    ds_read_b64_tr_b16 v[238:239], v10 offset:6208
    ds_read_b64_tr_b16 v[240:241], v9 offset:32768
    ds_read_b64_tr_b16 v[242:243], v9 offset:34816
    ds_read_b64_tr_b16 v[244:245], v10 offset:32768
    ds_read_b64_tr_b16 v[246:247], v10 offset:34816
    ds_read_b64_tr_b16 v[248:249], v9 offset:32832
    ds_read_b64_tr_b16 v[250:251], v9 offset:34880
    ds_read_b64_tr_b16 v[252:253], v10 offset:32832
    ds_read_b64_tr_b16 v[254:255], v10 offset:34880
    v_exp_f32 v80, -v48
    v_exp_f32 v81, -v49
    v_exp_f32 v82, -v50
    v_exp_f32 v83, -v51
    v_exp_f32 v84, -v52
    v_exp_f32 v85, -v53
    v_add_f32 v80, 1.0, v80
    v_add_f32 v81, 1.0, v81
    v_add_f32 v82, 1.0, v82
    v_add_f32 v83, 1.0, v83
    s_waitcnt vmcnt(12)
    v_rcp_f32 v80, v80
    v_rcp_f32 v81, v81
    v_rcp_f32 v82, v82
    v_mul_f32 v80, v80, v48
    v_mul_f32 v81, v81, v49
L_g2_17:
    v_mfma_f32_16x16x32_bf16 v[76:79], a[140:143], v[100:103], 0
    v_rcp_f32 v83, v83
    v_mfma_f32_16x16x32_bf16 v[72:75], a[136:139], v[100:103], 0
    v_exp_f32 v86, -v54
    v_mfma_f32_16x16x32_bf16 v[68:71], a[132:135], v[100:103], 0
    v_exp_f32 v87, -v55
    v_mfma_f32_16x16x32_bf16 v[64:67], a[128:131], v[100:103], 0
    s_waitcnt vmcnt(11)
    buffer_load_dwordx4 v[100:103], v13, s[60:63], s38 offen sc1
    v_mfma_f32_16x16x32_bf16 v[64:67], a[144:147], v[104:107], v[64:67]
    v_cvt_pk_bf16_f32 v92, v80, v81
    v_mul_f32 v82, v82, v50
    v_mfma_f32_16x16x32_bf16 v[68:71], a[148:151], v[104:107], v[68:71]
    v_mul_f32 v83, v83, v51
    v_add_f32 v84, 1.0, v84
    v_mfma_f32_16x16x32_bf16 v[72:75], a[152:155], v[104:107], v[72:75]
    v_rcp_f32 v84, v84
    v_mfma_f32_16x16x32_bf16 v[76:79], a[156:159], v[104:107], v[76:79]
    s_waitcnt vmcnt(11)
    buffer_load_dwordx4 v[104:107], v13, s[60:63], s39 offen sc1
    v_mfma_f32_16x16x32_bf16 v[76:79], a[172:175], v[108:111], v[76:79]
    v_cvt_pk_bf16_f32 v93, v82, v83
    v_mul_f32 v84, v84, v52
    v_mfma_f32_16x16x32_bf16 v[72:75], a[168:171], v[108:111], v[72:75]
    v_add_f32 v85, 1.0, v85
    v_add_f32 v86, 1.0, v86
    v_mfma_f32_16x16x32_bf16 v[68:71], a[164:167], v[108:111], v[68:71]
    s_waitcnt vmcnt(9)
    buffer_store_dword v16, v3, s[60:63], 0 offen
    v_mfma_f32_16x16x32_bf16 v[64:67], a[160:163], v[108:111], v[64:67]
    buffer_load_dwordx4 v[108:111], v13, s[60:63], s40 offen sc1
L_hop_5:
    s_cbranch_execz L_hop_back1
    v_mfma_f32_16x16x32_bf16 v[64:67], a[176:179], v[112:115], v[64:67]
    v_rcp_f32 v85, v85
    v_mfma_f32_16x16x32_bf16 v[68:71], a[180:183], v[112:115], v[68:71]
    v_rcp_f32 v86, v86
    v_mfma_f32_16x16x32_bf16 v[72:75], a[184:187], v[112:115], v[72:75]
    v_mul_f32 v85, v85, v53
    v_mul_f32 v86, v86, v54
    v_mfma_f32_16x16x32_bf16 v[76:79], a[188:191], v[112:115], v[76:79]
    buffer_load_dwordx4 v[112:115], v13, s[60:63], s41 offen sc1
    v_add_u32 v13, 114688, v13
    v_mfma_f32_16x16x32_bf16 v[76:79], a[204:207], v[116:119], v[76:79]
    v_cvt_pk_bf16_f32 v94, v84, v85
    v_add_f32 v87, 1.0, v87
    v_mfma_f32_16x16x32_bf16 v[72:75], a[200:203], v[116:119], v[72:75]
    v_rcp_f32 v87, v87
    v_mfma_f32_16x16x32_bf16 v[68:71], a[196:199], v[116:119], v[68:71]
    v_mul_f32 v87, v87, v55
    v_mfma_f32_16x16x32_bf16 v[64:67], a[192:195], v[116:119], v[64:67]
    s_waitcnt vmcnt(11)
    v_cvt_pk_bf16_f32 v95, v86, v87
    v_mfma_f32_16x16x32_bf16 v[64:67], a[208:211], v[120:123], v[64:67]
    s_waitcnt vmcnt(8)
    v_subrev_u32 v2, s70, v2
    v_cmp_le_u32 vcc, 16, v2
    v_mfma_f32_16x16x32_bf16 v[68:71], a[212:215], v[120:123], v[68:71]
    s_cbranch_vccnz L_slow_26
L_back_27:
    v_mfma_f32_16x16x32_bf16 v[72:75], a[216:219], v[120:123], v[72:75]
    buffer_load_dwordx4 v[116:119], v13, s[60:63], s28 offen sc1
    v_mfma_f32_16x16x32_bf16 v[76:79], a[220:223], v[120:123], v[76:79]
    s_mov_b32 s75, 401408
    buffer_store_dwordx4 v[92:95], v6, s[60:63], s75 offen sc1
    v_mfma_f32_16x16x32_bf16 v[76:79], a[236:239], v[124:127], v[76:79]
    v_or_b32 v16, 7, v17
    v_mfma_f32_16x16x32_bf16 v[72:75], a[232:235], v[124:127], v[72:75]
    v_mfma_f32_16x16x32_bf16 v[68:71], a[228:231], v[124:127], v[68:71]
    buffer_load_dwordx4 v[120:123], v13, s[60:63], s29 offen sc1
    v_mfma_f32_16x16x32_bf16 v[64:67], a[224:227], v[124:127], v[64:67]
    v_mfma_f32_16x16x32_bf16 v[64:67], a[240:243], v[128:131], v[64:67]
    v_mfma_f32_16x16x32_bf16 v[68:71], a[244:247], v[128:131], v[68:71]
    v_mfma_f32_16x16x32_bf16 v[72:75], a[248:251], v[128:131], v[72:75]
    buffer_load_dwordx4 v[124:127], v13, s[60:63], s30 offen sc1
    v_mfma_f32_16x16x32_bf16 v[76:79], a[252:255], v[128:131], v[76:79]
    s_waitcnt vmcnt(11)
    v_mfma_f32_16x16x32_bf16 v[76:79], v[172:175], v[132:135], v[76:79]
    v_mfma_f32_16x16x32_bf16 v[72:75], v[168:171], v[132:135], v[72:75]
    v_mfma_f32_16x16x32_bf16 v[68:71], v[164:167], v[132:135], v[68:71]
    buffer_load_dwordx4 v[128:131], v13, s[60:63], s31 offen sc1
    v_mfma_f32_16x16x32_bf16 v[64:67], v[160:163], v[132:135], v[64:67]
    s_waitcnt vmcnt(11)
    s_waitcnt lgkmcnt(15)
    v_mfma_f32_16x16x32_bf16 v[64:67], v[176:179], v[136:139], v[64:67]
    v_mfma_f32_16x16x32_bf16 v[68:71], v[180:183], v[136:139], v[68:71]
    v_mfma_f32_16x16x32_bf16 v[72:75], v[184:187], v[136:139], v[72:75]
    buffer_load_dwordx4 v[132:135], v13, s[60:63], s32 offen sc1
    v_mfma_f32_16x16x32_bf16 v[76:79], v[188:191], v[136:139], v[76:79]
    s_waitcnt vmcnt(10)
    s_add_u32 s70, s69, 6
    buffer_load_dword v2, v4, s[60:63], 0 offen sc1
    v_mfma_f32_16x16x32_bf16 v[76:79], v[204:207], v[100:103], v[76:79]
    v_mfma_f32_16x16x32_bf16 v[72:75], v[200:203], v[100:103], v[72:75]
    v_mfma_f32_16x16x32_bf16 v[68:71], v[196:199], v[100:103], v[68:71]
    buffer_load_dwordx4 v[136:139], v13, s[60:63], s33 offen sc1
    v_mfma_f32_16x16x32_bf16 v[64:67], v[192:195], v[100:103], v[64:67]
    s_waitcnt vmcnt(11)
    v_mfma_f32_16x16x32_bf16 v[64:67], v[208:211], v[104:107], v[64:67]
    v_mfma_f32_16x16x32_bf16 v[68:71], v[212:215], v[104:107], v[68:71]
    v_mfma_f32_16x16x32_bf16 v[72:75], v[216:219], v[104:107], v[72:75]
    buffer_load_dwordx4 v[100:103], v13, s[60:63], s34 offen sc1
    v_mfma_f32_16x16x32_bf16 v[76:79], v[220:223], v[104:107], v[76:79]
    s_waitcnt vmcnt(10)
    s_waitcnt lgkmcnt(8)
    v_mfma_f32_16x16x32_bf16 v[76:79], v[236:239], v[108:111], v[76:79]
    v_mfma_f32_16x16x32_bf16 v[72:75], v[232:235], v[108:111], v[72:75]
    v_mfma_f32_16x16x32_bf16 v[68:71], v[228:231], v[108:111], v[68:71]
    buffer_load_dwordx4 v[104:107], v13, s[60:63], s35 offen sc1
    v_mfma_f32_16x16x32_bf16 v[64:67], v[224:227], v[108:111], v[64:67]
    s_waitcnt vmcnt(10)
    s_waitcnt lgkmcnt(6)
    v_mfma_f32_16x16x32_bf16 v[64:67], v[240:243], v[112:115], v[64:67]
    s_waitcnt lgkmcnt(4)
    v_mfma_f32_16x16x32_bf16 v[68:71], v[244:247], v[112:115], v[68:71]
    s_waitcnt lgkmcnt(2)
    v_mfma_f32_16x16x32_bf16 v[72:75], v[248:251], v[112:115], v[72:75]
    buffer_load_dwordx4 v[108:111], v13, s[60:63], s36 offen sc1
    s_waitcnt lgkmcnt(0)
    v_mfma_f32_16x16x32_bf16 v[76:79], v[252:255], v[112:115], v[76:79]
    s_waitcnt vmcnt(10)
    v_mfma_f32_16x16x32_bf16 v[36:39], a[140:143], v[116:119], 0
    v_mfma_f32_16x16x32_bf16 v[32:35], a[136:139], v[116:119], 0
    v_mfma_f32_16x16x32_bf16 v[28:31], a[132:135], v[116:119], 0
    buffer_load_dwordx4 v[112:115], v13, s[60:63], s37 offen sc1
    v_mfma_f32_16x16x32_bf16 v[24:27], a[128:131], v[116:119], 0
    s_waitcnt vmcnt(9)
    v_mfma_f32_16x16x32_bf16 v[24:27], a[144:147], v[120:123], v[24:27]
    v_mfma_f32_16x16x32_bf16 v[28:31], a[148:151], v[120:123], v[28:31]
    buffer_store_dword v16, v3, s[60:63], 0 offen
    v_mfma_f32_16x16x32_bf16 v[32:35], a[152:155], v[120:123], v[32:35]
    buffer_load_dwordx4 v[116:119], v13, s[60:63], s38 offen sc1
    v_mfma_f32_16x16x32_bf16 v[36:39], a[156:159], v[120:123], v[36:39]
    s_waitcnt vmcnt(10)
    ds_write_b128 v11, v[64:67] offset:0
    v_mfma_f32_16x16x32_bf16 v[36:39], a[172:175], v[124:127], v[36:39]
    v_mfma_f32_16x16x32_bf16 v[32:35], a[168:171], v[124:127], v[32:35]
    v_mfma_f32_16x16x32_bf16 v[28:31], a[164:167], v[124:127], v[28:31]
    buffer_load_dwordx4 v[120:123], v13, s[60:63], s39 offen sc1
    v_mfma_f32_16x16x32_bf16 v[24:27], a[160:163], v[124:127], v[24:27]
    s_waitcnt vmcnt(10)
    ds_write_b128 v14, v[68:71] offset:0
    v_mfma_f32_16x16x32_bf16 v[24:27], a[176:179], v[128:131], v[24:27]
    v_mfma_f32_16x16x32_bf16 v[28:31], a[180:183], v[128:131], v[28:31]
    v_mfma_f32_16x16x32_bf16 v[32:35], a[184:187], v[128:131], v[32:35]
    buffer_load_dwordx4 v[124:127], v13, s[60:63], s40 offen sc1
    v_mfma_f32_16x16x32_bf16 v[36:39], a[188:191], v[128:131], v[36:39]
    s_waitcnt vmcnt(10)
    ds_write_b128 v11, v[72:75] offset:128
    v_mfma_f32_16x16x32_bf16 v[36:39], a[204:207], v[132:135], v[36:39]
    v_mfma_f32_16x16x32_bf16 v[32:35], a[200:203], v[132:135], v[32:35]
    v_mfma_f32_16x16x32_bf16 v[28:31], a[196:199], v[132:135], v[28:31]
    buffer_load_dwordx4 v[128:131], v13, s[60:63], s41 offen sc1
    v_add_u32 v13, 114688, v13
    v_mfma_f32_16x16x32_bf16 v[24:27], a[192:195], v[132:135], v[24:27]
    s_waitcnt vmcnt(9)
    ds_write_b128 v14, v[76:79] offset:128
    v_mfma_f32_16x16x32_bf16 v[24:27], a[208:211], v[136:139], v[24:27]
    v_subrev_u32 v2, s70, v2
    v_cmp_le_u32 vcc, 16, v2
    v_mfma_f32_16x16x32_bf16 v[28:31], a[212:215], v[136:139], v[28:31]
    s_cbranch_vccnz L_slow_31
L_back_32:
    v_mfma_f32_16x16x32_bf16 v[32:35], a[216:219], v[136:139], v[32:35]
    buffer_load_dwordx4 v[132:135], v13, s[60:63], s28 offen sc1
    v_mfma_f32_16x16x32_bf16 v[36:39], a[220:223], v[136:139], v[36:39]
    s_waitcnt vmcnt(9)
    v_mfma_f32_16x16x32_bf16 v[36:39], a[236:239], v[100:103], v[36:39]
    s_waitcnt lgkmcnt(0)
    s_barrier
    v_mfma_f32_16x16x32_bf16 v[32:35], a[232:235], v[100:103], v[32:35]
    ds_read_b128 v[64:67], v12 offset:0
    ds_read_b128 v[68:71], v12 offset:4096
    v_mfma_f32_16x16x32_bf16 v[28:31], a[228:231], v[100:103], v[28:31]
    buffer_load_dwordx4 v[136:139], v13, s[60:63], s29 offen sc1
    v_mfma_f32_16x16x32_bf16 v[24:27], a[224:227], v[100:103], v[24:27]
    s_waitcnt vmcnt(9)
    ds_read_b128 v[72:75], v12 offset:8192
    ds_read_b128 v[76:79], v12 offset:12288
    v_mfma_f32_16x16x32_bf16 v[24:27], a[240:243], v[104:107], v[24:27]
    v_mfma_f32_16x16x32_bf16 v[28:31], a[244:247], v[104:107], v[28:31]
    v_mfma_f32_16x16x32_bf16 v[32:35], a[248:251], v[104:107], v[32:35]
    buffer_load_dwordx4 v[100:103], v13, s[60:63], s30 offen sc1
    v_mfma_f32_16x16x32_bf16 v[36:39], a[252:255], v[104:107], v[36:39]
    s_waitcnt vmcnt(9)
    v_mfma_f32_16x16x32_bf16 v[36:39], v[172:175], v[108:111], v[36:39]
    v_mfma_f32_16x16x32_bf16 v[32:35], v[168:171], v[108:111], v[32:35]
    s_waitcnt lgkmcnt(0)
    v_add_f32 v64, v64, v68
    v_add_f32 v65, v65, v69
    v_mfma_f32_16x16x32_bf16 v[28:31], v[164:167], v[108:111], v[28:31]
    buffer_load_dwordx4 v[104:107], v13, s[60:63], s31 offen sc1
    v_mfma_f32_16x16x32_bf16 v[24:27], v[160:163], v[108:111], v[24:27]
    s_waitcnt vmcnt(9)
    v_add_f32 v66, v66, v70
    v_add_f32 v67, v67, v71
    v_mfma_f32_16x16x32_bf16 v[24:27], v[176:179], v[112:115], v[24:27]
    v_add_f32 v64, v64, v72
    v_add_f32 v65, v65, v73
    v_mfma_f32_16x16x32_bf16 v[28:31], v[180:183], v[112:115], v[28:31]
    v_add_f32 v66, v66, v74
    v_add_f32 v67, v67, v75
    v_mfma_f32_16x16x32_bf16 v[32:35], v[184:187], v[112:115], v[32:35]
    buffer_load_dwordx4 v[108:111], v13, s[60:63], s32 offen sc1
    v_mfma_f32_16x16x32_bf16 v[36:39], v[188:191], v[112:115], v[36:39]
    s_waitcnt vmcnt(8)
    s_add_u32 s70, s69, 7
    buffer_load_dword v2, v4, s[60:63], 0 offen sc1
    v_mfma_f32_16x16x32_bf16 v[36:39], v[204:207], v[116:119], v[36:39]
    v_add_f32 v64, v64, v76
    v_add_f32 v65, v65, v77
    v_mfma_f32_16x16x32_bf16 v[32:35], v[200:203], v[116:119], v[32:35]
    v_add_f32 v66, v66, v78
    v_add_f32 v67, v67, v79
    v_mfma_f32_16x16x32_bf16 v[28:31], v[196:199], v[116:119], v[28:31]
    buffer_load_dwordx4 v[112:115], v13, s[60:63], s33 offen sc1
    v_mfma_f32_16x16x32_bf16 v[24:27], v[192:195], v[116:119], v[24:27]
    s_waitcnt vmcnt(9)
    v_cvt_pk_bf16_f32 v68, v64, v65
    v_cvt_pk_bf16_f32 v69, v66, v67
    v_mfma_f32_16x16x32_bf16 v[24:27], v[208:211], v[120:123], v[24:27]
    v_min_u32 v68, -2, v68
    v_min_u32 v69, -2, v69
    v_mfma_f32_16x16x32_bf16 v[28:31], v[212:215], v[120:123], v[28:31]
    s_mov_b32 s72, 0
    buffer_store_dwordx2 v[68:69], v5, s[60:63], s72 offen
    v_mfma_f32_16x16x32_bf16 v[32:35], v[216:219], v[120:123], v[32:35]
    buffer_load_dwordx4 v[116:119], v13, s[60:63], s34 offen sc1
    v_mfma_f32_16x16x32_bf16 v[36:39], v[220:223], v[120:123], v[36:39]
    s_waitcnt vmcnt(10)
    v_mfma_f32_16x16x32_bf16 v[36:39], v[236:239], v[124:127], v[36:39]
    v_mfma_f32_16x16x32_bf16 v[32:35], v[232:235], v[124:127], v[32:35]
    v_mfma_f32_16x16x32_bf16 v[28:31], v[228:231], v[124:127], v[28:31]
    buffer_load_dwordx4 v[120:123], v13, s[60:63], s35 offen sc1
    v_mfma_f32_16x16x32_bf16 v[24:27], v[224:227], v[124:127], v[24:27]
    s_waitcnt vmcnt(10)
    v_mfma_f32_16x16x32_bf16 v[24:27], v[240:243], v[128:131], v[24:27]
    v_mfma_f32_16x16x32_bf16 v[28:31], v[244:247], v[128:131], v[28:31]
    v_mfma_f32_16x16x32_bf16 v[32:35], v[248:251], v[128:131], v[32:35]
    buffer_load_dwordx4 v[124:127], v13, s[60:63], s36 offen sc1
    v_mfma_f32_16x16x32_bf16 v[36:39], v[252:255], v[128:131], v[36:39]
    s_waitcnt vmcnt(10)
    v_mfma_f32_16x16x32_bf16 v[76:79], a[140:143], v[132:135], 0
    v_lshlrev_b32 v40, 16, v144
    v_and_b32 v41, 0xffff0000, v144
    v_mfma_f32_16x16x32_bf16 v[72:75], a[136:139], v[132:135], 0
    v_lshlrev_b32 v42, 16, v145
    v_and_b32 v43, 0xffff0000, v145
    v_mfma_f32_16x16x32_bf16 v[68:71], a[132:135], v[132:135], 0
    buffer_load_dwordx4 v[128:131], v13, s[60:63], s37 offen sc1
    v_mfma_f32_16x16x32_bf16 v[64:67], a[128:131], v[132:135], 0
    s_waitcnt vmcnt(10)
    v_lshlrev_b32 v44, 16, v146
    v_and_b32 v45, 0xffff0000, v146
    v_mfma_f32_16x16x32_bf16 v[64:67], a[144:147], v[136:139], v[64:67]
    v_lshlrev_b32 v46, 16, v147
    v_and_b32 v47, 0xffff0000, v147
    v_mfma_f32_16x16x32_bf16 v[68:71], a[148:151], v[136:139], v[68:71]
    v_lshlrev_b32 v48, 16, v152
    v_and_b32 v49, 0xffff0000, v152
    v_mfma_f32_16x16x32_bf16 v[72:75], a[152:155], v[136:139], v[72:75]
    buffer_load_dwordx4 v[132:135], v13, s[60:63], s38 offen sc1
    v_mfma_f32_16x16x32_bf16 v[76:79], a[156:159], v[136:139], v[76:79]
    s_waitcnt vmcnt(10)
    ds_write_b128 v11, v[24:27] offset:16384
    v_mfma_f32_16x16x32_bf16 v[76:79], a[172:175], v[100:103], v[76:79]
    v_lshlrev_b32 v50, 16, v153
    v_and_b32 v51, 0xffff0000, v153
    v_mfma_f32_16x16x32_bf16 v[72:75], a[168:171], v[100:103], v[72:75]
    v_lshlrev_b32 v52, 16, v154
    v_and_b32 v53, 0xffff0000, v154
    v_mfma_f32_16x16x32_bf16 v[68:71], a[164:167], v[100:103], v[68:71]
    buffer_load_dwordx4 v[136:139], v13, s[60:63], s39 offen sc1
    v_mfma_f32_16x16x32_bf16 v[64:67], a[160:163], v[100:103], v[64:67]
    s_waitcnt vmcnt(10)
    ds_write_b128 v14, v[28:31] offset:16384
    v_mfma_f32_16x16x32_bf16 v[64:67], a[176:179], v[104:107], v[64:67]
    v_lshlrev_b32 v54, 16, v155
    v_and_b32 v55, 0xffff0000, v155
    v_mfma_f32_16x16x32_bf16 v[68:71], a[180:183], v[104:107], v[68:71]
    v_mfma_f32_16x16x32_bf16 v[72:75], a[184:187], v[104:107], v[72:75]
    buffer_load_dwordx4 v[100:103], v13, s[60:63], s40 offen sc1
    v_mfma_f32_16x16x32_bf16 v[76:79], a[188:191], v[104:107], v[76:79]
    s_waitcnt vmcnt(10)
    ds_write_b128 v11, v[32:35] offset:16512
    v_mfma_f32_16x16x32_bf16 v[76:79], a[204:207], v[108:111], v[76:79]
    v_mfma_f32_16x16x32_bf16 v[72:75], a[200:203], v[108:111], v[72:75]
    v_mfma_f32_16x16x32_bf16 v[68:71], a[196:199], v[108:111], v[68:71]
    buffer_load_dwordx4 v[104:107], v13, s[60:63], s41 offen sc1
    v_add_u32 v13, 114688, v13
    v_mfma_f32_16x16x32_bf16 v[64:67], a[192:195], v[108:111], v[64:67]
    s_waitcnt vmcnt(9)
    ds_write_b128 v14, v[36:39] offset:16512
    v_mfma_f32_16x16x32_bf16 v[64:67], a[208:211], v[112:115], v[64:67]
    v_subrev_u32 v2, s70, v2
    v_cmp_le_u32 vcc, 16, v2
    v_mfma_f32_16x16x32_bf16 v[68:71], a[212:215], v[112:115], v[68:71]
    s_cbranch_vccnz L_slow_36
L_back_37:
    v_mfma_f32_16x16x32_bf16 v[72:75], a[216:219], v[112:115], v[72:75]
    buffer_load_dwordx4 v[108:111], v13, s[60:63], s28 offen sc1
    v_mfma_f32_16x16x32_bf16 v[76:79], a[220:223], v[112:115], v[76:79]
    s_waitcnt vmcnt(8)
    v_mfma_f32_16x16x32_bf16 v[76:79], a[236:239], v[116:119], v[76:79]
    s_waitcnt lgkmcnt(0)
    s_barrier
    v_mfma_f32_16x16x32_bf16 v[72:75], a[232:235], v[116:119], v[72:75]
    ds_read_b128 v[24:27], v12 offset:16384
    ds_read_b128 v[28:31], v12 offset:20480
    v_mfma_f32_16x16x32_bf16 v[68:71], a[228:231], v[116:119], v[68:71]
    buffer_load_dwordx4 v[112:115], v13, s[60:63], s29 offen sc1
    v_mfma_f32_16x16x32_bf16 v[64:67], a[224:227], v[116:119], v[64:67]
    s_waitcnt vmcnt(8)
    ds_read_b128 v[32:35], v12 offset:24576
    ds_read_b128 v[36:39], v12 offset:28672
    v_mfma_f32_16x16x32_bf16 v[64:67], a[240:243], v[120:123], v[64:67]
    v_mfma_f32_16x16x32_bf16 v[68:71], a[244:247], v[120:123], v[68:71]
    v_mfma_f32_16x16x32_bf16 v[72:75], a[248:251], v[120:123], v[72:75]
    buffer_load_dwordx4 v[116:119], v13, s[60:63], s30 offen sc1
    v_mfma_f32_16x16x32_bf16 v[76:79], a[252:255], v[120:123], v[76:79]
    s_waitcnt vmcnt(8)
    v_mfma_f32_16x16x32_bf16 v[76:79], v[172:175], v[124:127], v[76:79]
    v_mfma_f32_16x16x32_bf16 v[72:75], v[168:171], v[124:127], v[72:75]
    s_waitcnt lgkmcnt(0)
    v_add_f32 v24, v24, v28
    v_add_f32 v25, v25, v29
    v_mfma_f32_16x16x32_bf16 v[68:71], v[164:167], v[124:127], v[68:71]
    buffer_load_dwordx4 v[120:123], v13, s[60:63], s31 offen sc1
    v_mfma_f32_16x16x32_bf16 v[64:67], v[160:163], v[124:127], v[64:67]
    s_waitcnt vmcnt(8)
    v_add_f32 v26, v26, v30
    v_add_f32 v27, v27, v31
    v_mfma_f32_16x16x32_bf16 v[64:67], v[176:179], v[128:131], v[64:67]
    v_add_f32 v24, v24, v32
    v_add_f32 v25, v25, v33
    v_mfma_f32_16x16x32_bf16 v[68:71], v[180:183], v[128:131], v[68:71]
    v_add_f32 v26, v26, v34
    v_add_f32 v27, v27, v35
    v_mfma_f32_16x16x32_bf16 v[72:75], v[184:187], v[128:131], v[72:75]
    buffer_load_dwordx4 v[124:127], v13, s[60:63], s32 offen sc1
    v_mfma_f32_16x16x32_bf16 v[76:79], v[188:191], v[128:131], v[76:79]
    s_waitcnt vmcnt(8)
    v_add_f32 v24, v24, v36
    v_add_f32 v25, v25, v37
    v_mfma_f32_16x16x32_bf16 v[76:79], v[204:207], v[132:135], v[76:79]
    v_add_f32 v26, v26, v38
    v_add_f32 v27, v27, v39
    v_mfma_f32_16x16x32_bf16 v[72:75], v[200:203], v[132:135], v[72:75]
    v_cvt_pk_bf16_f32 v28, v24, v25
    v_cvt_pk_bf16_f32 v29, v26, v27
    v_mfma_f32_16x16x32_bf16 v[68:71], v[196:199], v[132:135], v[68:71]
    buffer_load_dwordx4 v[128:131], v13, s[60:63], s33 offen sc1
    v_mfma_f32_16x16x32_bf16 v[64:67], v[192:195], v[132:135], v[64:67]
    s_waitcnt vmcnt(8)
    v_min_u32 v28, -2, v28
    v_min_u32 v29, -2, v29
    v_mfma_f32_16x16x32_bf16 v[64:67], v[208:211], v[136:139], v[64:67]
    s_mov_b32 s72, 32768
    buffer_store_dwordx2 v[28:29], v5, s[60:63], s72 offen
    v_mfma_f32_16x16x32_bf16 v[68:71], v[212:215], v[136:139], v[68:71]
    v_mfma_f32_16x16x32_bf16 v[72:75], v[216:219], v[136:139], v[72:75]
    buffer_load_dwordx4 v[132:135], v13, s[60:63], s34 offen sc1
    v_mfma_f32_16x16x32_bf16 v[76:79], v[220:223], v[136:139], v[76:79]
    s_waitcnt vmcnt(9)
    v_mfma_f32_16x16x32_bf16 v[76:79], v[236:239], v[100:103], v[76:79]
    v_mfma_f32_16x16x32_bf16 v[72:75], v[232:235], v[100:103], v[72:75]
    v_mfma_f32_16x16x32_bf16 v[68:71], v[228:231], v[100:103], v[68:71]
    buffer_load_dwordx4 v[136:139], v13, s[60:63], s35 offen sc1
    v_mfma_f32_16x16x32_bf16 v[64:67], v[224:227], v[100:103], v[64:67]
    s_waitcnt vmcnt(9)
    v_mfma_f32_16x16x32_bf16 v[64:67], v[240:243], v[104:107], v[64:67]
    v_mfma_f32_16x16x32_bf16 v[68:71], v[244:247], v[104:107], v[68:71]
    v_mfma_f32_16x16x32_bf16 v[72:75], v[248:251], v[104:107], v[72:75]
    buffer_load_dwordx4 v[100:103], v13, s[60:63], s36 offen sc1
    v_mfma_f32_16x16x32_bf16 v[76:79], v[252:255], v[104:107], v[76:79]
    s_waitcnt vmcnt(9)
    v_mfma_f32_16x16x32_bf16 v[36:39], a[140:143], v[108:111], 0
    v_mfma_f32_16x16x32_bf16 v[32:35], a[136:139], v[108:111], 0
    v_mfma_f32_16x16x32_bf16 v[28:31], a[132:135], v[108:111], 0
    buffer_load_dwordx4 v[104:107], v13, s[60:63], s37 offen sc1
    v_mfma_f32_16x16x32_bf16 v[24:27], a[128:131], v[108:111], 0
    s_waitcnt vmcnt(9)
    v_mfma_f32_16x16x32_bf16 v[24:27], a[144:147], v[112:115], v[24:27]
    v_mfma_f32_16x16x32_bf16 v[28:31], a[148:151], v[112:115], v[28:31]
    v_mfma_f32_16x16x32_bf16 v[32:35], a[152:155], v[112:115], v[32:35]
    buffer_load_dwordx4 v[108:111], v13, s[60:63], s38 offen sc1
    v_mfma_f32_16x16x32_bf16 v[36:39], a[156:159], v[112:115], v[36:39]
    s_waitcnt vmcnt(9)
    ds_write_b128 v11, v[64:67] offset:0
    v_mfma_f32_16x16x32_bf16 v[36:39], a[172:175], v[116:119], v[36:39]
    v_mfma_f32_16x16x32_bf16 v[32:35], a[168:171], v[116:119], v[32:35]
    v_mfma_f32_16x16x32_bf16 v[28:31], a[164:167], v[116:119], v[28:31]
    buffer_load_dwordx4 v[112:115], v13, s[60:63], s39 offen sc1
    v_mfma_f32_16x16x32_bf16 v[24:27], a[160:163], v[116:119], v[24:27]
    s_waitcnt vmcnt(9)
    ds_write_b128 v14, v[68:71] offset:0
    v_mfma_f32_16x16x32_bf16 v[24:27], a[176:179], v[120:123], v[24:27]
    v_mfma_f32_16x16x32_bf16 v[28:31], a[180:183], v[120:123], v[28:31]
    v_mfma_f32_16x16x32_bf16 v[32:35], a[184:187], v[120:123], v[32:35]
    buffer_load_dwordx4 v[116:119], v13, s[60:63], s40 offen sc1
    v_mfma_f32_16x16x32_bf16 v[36:39], a[188:191], v[120:123], v[36:39]
    s_waitcnt vmcnt(9)
    ds_write_b128 v11, v[72:75] offset:128
    v_mfma_f32_16x16x32_bf16 v[36:39], a[204:207], v[124:127], v[36:39]
    v_mfma_f32_16x16x32_bf16 v[32:35], a[200:203], v[124:127], v[32:35]
    v_mfma_f32_16x16x32_bf16 v[28:31], a[196:199], v[124:127], v[28:31]
    buffer_load_dwordx4 v[120:123], v13, s[60:63], s41 offen sc1
    v_add_u32 v13, 573440, v13
    v_mfma_f32_16x16x32_bf16 v[24:27], a[192:195], v[124:127], v[24:27]
    s_waitcnt vmcnt(9)
    ds_write_b128 v14, v[76:79] offset:128
    v_mfma_f32_16x16x32_bf16 v[24:27], a[208:211], v[128:131], v[24:27]
    v_mfma_f32_16x16x32_bf16 v[28:31], a[212:215], v[128:131], v[28:31]
    v_mfma_f32_16x16x32_bf16 v[32:35], a[216:219], v[128:131], v[32:35]
    v_mfma_f32_16x16x32_bf16 v[36:39], a[220:223], v[128:131], v[36:39]
    s_waitcnt vmcnt(7)
    v_mfma_f32_16x16x32_bf16 v[36:39], a[236:239], v[132:135], v[36:39]
    s_waitcnt lgkmcnt(0)
    s_barrier
    v_mfma_f32_16x16x32_bf16 v[32:35], a[232:235], v[132:135], v[32:35]
    ds_read_b128 v[64:67], v12 offset:0
    ds_read_b128 v[68:71], v12 offset:4096
    v_mfma_f32_16x16x32_bf16 v[28:31], a[228:231], v[132:135], v[28:31]
    ds_read_b128 v[72:75], v12 offset:8192
    ds_read_b128 v[76:79], v12 offset:12288
    v_mfma_f32_16x16x32_bf16 v[24:27], a[224:227], v[132:135], v[24:27]
    s_waitcnt vmcnt(6)
    v_mfma_f32_16x16x32_bf16 v[24:27], a[240:243], v[136:139], v[24:27]
    buffer_load_dwordx4 v[80:83], v7, s[60:63], 0 offen sc1
    v_mfma_f32_16x16x32_bf16 v[28:31], a[244:247], v[136:139], v[28:31]
    v_mfma_f32_16x16x32_bf16 v[32:35], a[248:251], v[136:139], v[32:35]
    v_mfma_f32_16x16x32_bf16 v[36:39], a[252:255], v[136:139], v[36:39]
    s_waitcnt vmcnt(6)
    v_mfma_f32_16x16x32_bf16 v[36:39], v[172:175], v[100:103], v[36:39]
    s_waitcnt lgkmcnt(0)
    v_add_f32 v64, v64, v68
    v_add_f32 v65, v65, v69
    v_mfma_f32_16x16x32_bf16 v[32:35], v[168:171], v[100:103], v[32:35]
    v_add_f32 v66, v66, v70
    v_add_f32 v67, v67, v71
    v_mfma_f32_16x16x32_bf16 v[28:31], v[164:167], v[100:103], v[28:31]
    v_add_f32 v64, v64, v72
    v_add_f32 v65, v65, v73
    v_mfma_f32_16x16x32_bf16 v[24:27], v[160:163], v[100:103], v[24:27]
    s_waitcnt vmcnt(5)
    v_add_f32 v66, v66, v74
    v_add_f32 v67, v67, v75
    v_mfma_f32_16x16x32_bf16 v[24:27], v[176:179], v[104:107], v[24:27]
    v_add_f32 v64, v64, v76
    v_add_f32 v65, v65, v77
    v_mfma_f32_16x16x32_bf16 v[28:31], v[180:183], v[104:107], v[28:31]
    v_add_f32 v66, v66, v78
    v_add_f32 v67, v67, v79
    v_mfma_f32_16x16x32_bf16 v[32:35], v[184:187], v[104:107], v[32:35]
    v_cvt_pk_bf16_f32 v68, v64, v65
    v_cvt_pk_bf16_f32 v69, v66, v67
    v_mfma_f32_16x16x32_bf16 v[36:39], v[188:191], v[104:107], v[36:39]
    s_waitcnt vmcnt(4)
    v_min_u32 v68, -2, v68
    v_min_u32 v69, -2, v69
    v_mfma_f32_16x16x32_bf16 v[36:39], v[204:207], v[108:111], v[36:39]
    s_mov_b32 s72, 65536
    buffer_store_dwordx2 v[68:69], v5, s[60:63], s72 offen
    v_mfma_f32_16x16x32_bf16 v[32:35], v[200:203], v[108:111], v[32:35]
    v_mfma_f32_16x16x32_bf16 v[28:31], v[196:199], v[108:111], v[28:31]
    v_mfma_f32_16x16x32_bf16 v[24:27], v[192:195], v[108:111], v[24:27]
    s_waitcnt vmcnt(4)
    v_mfma_f32_16x16x32_bf16 v[24:27], v[208:211], v[112:115], v[24:27]
    v_mfma_f32_16x16x32_bf16 v[28:31], v[212:215], v[112:115], v[28:31]
    v_mfma_f32_16x16x32_bf16 v[32:35], v[216:219], v[112:115], v[32:35]
    v_mfma_f32_16x16x32_bf16 v[36:39], v[220:223], v[112:115], v[36:39]
    s_waitcnt vmcnt(3)
    v_mfma_f32_16x16x32_bf16 v[36:39], v[236:239], v[116:119], v[36:39]
    v_mfma_f32_16x16x32_bf16 v[32:35], v[232:235], v[116:119], v[32:35]
    v_mfma_f32_16x16x32_bf16 v[28:31], v[228:231], v[116:119], v[28:31]
    v_mfma_f32_16x16x32_bf16 v[24:27], v[224:227], v[116:119], v[24:27]
    s_waitcnt vmcnt(2)
    v_mfma_f32_16x16x32_bf16 v[24:27], v[240:243], v[120:123], v[24:27]
    v_mfma_f32_16x16x32_bf16 v[28:31], v[244:247], v[120:123], v[28:31]
    v_mfma_f32_16x16x32_bf16 v[32:35], v[248:251], v[120:123], v[32:35]
    v_mfma_f32_16x16x32_bf16 v[36:39], v[252:255], v[120:123], v[36:39]
    s_waitcnt vmcnt(1)
    v_max3_u32 v23, v80, v81, v82
    v_max_u32 v23, v23, v83
    v_cmp_eq_u32 vcc, -1, v23
    s_nop 0
    s_cbranch_vccz L_ret_42
L_spin_41:
    buffer_load_dwordx4 v[80:83], v7, s[60:63], 0 offen sc1
    s_sub_u32 s71, s71, 1
    s_cbranch_scc1 L_bail_43
    s_waitcnt vmcnt(0)
    v_max3_u32 v23, v80, v81, v82
    v_max_u32 v23, v23, v83
    v_cmp_eq_u32 vcc, -1, v23
    s_nop 0
    s_cbranch_vccnz L_spin_41
L_ret_42:
    v_lshlrev_b32 v56, 16, v80
    v_and_b32 v57, 0xffff0000, v80
    v_lshlrev_b32 v58, 16, v81
    v_and_b32 v59, 0xffff0000, v81
    ds_write_b128 v11, v[24:27] offset:16384
    v_lshlrev_b32 v60, 16, v82
    v_and_b32 v61, 0xffff0000, v82
    v_lshlrev_b32 v62, 16, v83
    v_and_b32 v63, 0xffff0000, v83
    v_pk_fma_f32 v[40:41], v[56:57], s[42:43], v[40:41] op_sel_hi:[1,0,1]
    v_pk_fma_f32 v[42:43], v[58:59], s[42:43], v[42:43] op_sel_hi:[1,0,1]
    v_pk_fma_f32 v[44:45], v[60:61], s[42:43], v[44:45] op_sel_hi:[1,0,1]
    v_pk_fma_f32 v[46:47], v[62:63], s[42:43], v[46:47] op_sel_hi:[1,0,1]
    ds_write_b128 v14, v[28:31] offset:16384
    v_pk_mul_f32 v[86:87], v[40:41], v[40:41]
    v_pk_add_f32 v[84:85], v[40:41], v[42:43]
    v_pk_fma_f32 v[86:87], v[42:43], v[42:43], v[86:87]
    v_pk_add_f32 v[84:85], v[84:85], v[44:45]
    v_pk_fma_f32 v[86:87], v[44:45], v[44:45], v[86:87]
    v_pk_add_f32 v[84:85], v[84:85], v[46:47]
    v_pk_fma_f32 v[86:87], v[46:47], v[46:47], v[86:87]
    s_nop 1
    v_permlane32_swap_b32 v84, v86
    ds_write_b128 v11, v[32:35] offset:16512
    v_permlane32_swap_b32 v85, v87
    v_pk_add_f32 v[84:85], v[84:85], v[86:87]
    v_add_f32 v86, v84, v85
    v_add_f32 v84, v84, v85
    s_nop 1
    v_permlane16_swap_b32 v84, v86
    v_add_f32 v84, v84, v86
    s_nop 1
    v_add_f32_dpp v84, v84, v84 row_ror:8 row_mask:0xf bank_mask:0xf
    s_nop 1
    v_add_f32_dpp v84, v84, v84 row_ror:4 row_mask:0xf bank_mask:0xf
    ds_write_b128 v14, v[36:39] offset:16512
    s_nop 0
    v_add_f32_dpp v84, v84, v84 row_ror:2 row_mask:0xf bank_mask:0xf
    s_nop 1
    v_add_f32_dpp v84, v84, v84 row_ror:1 row_mask:0xf bank_mask:0xf
    v_mul_f32 v85, 0x3b000000, v84
    v_mul_f32 v84, 0x3b000000, v84
    s_nop 1
    v_permlane32_swap_b32 v84, v85
    v_fma_f32 v85, -v84, v84, v85
    v_max_f32 v85, 0, v85
    v_add_f32 v85, 0x3727c5ac, v85
    v_rsq_f32 v86, v85
    s_nop 0
    v_mul_f32 v87, -v84, v86
    v_pk_fma_f32 v[56:57], v[40:41], v[86:87], v[86:87] op_sel:[0,0,1] op_sel_hi:[1,0,1]
    v_pk_fma_f32 v[58:59], v[42:43], v[86:87], v[86:87] op_sel:[0,0,1] op_sel_hi:[1,0,1]
    s_waitcnt lgkmcnt(0)
    s_barrier
    ds_read_b128 v[24:27], v12 offset:16384
    ds_read_b128 v[28:31], v12 offset:20480
    ds_read_b128 v[32:35], v12 offset:24576
    ds_read_b128 v[36:39], v12 offset:28672
    v_pk_fma_f32 v[60:61], v[44:45], v[86:87], v[86:87] op_sel:[0,0,1] op_sel_hi:[1,0,1]
    v_pk_fma_f32 v[62:63], v[46:47], v[86:87], v[86:87] op_sel:[0,0,1] op_sel_hi:[1,0,1]
    v_pk_fma_f32 v[40:41], v[56:57], v[48:49], v[40:41]
    v_pk_fma_f32 v[42:43], v[58:59], v[50:51], v[42:43]
    v_pk_fma_f32 v[44:45], v[60:61], v[52:53], v[44:45]
    v_pk_fma_f32 v[46:47], v[62:63], v[54:55], v[46:47]
    v_pk_mul_f32 v[86:87], v[40:41], v[40:41]
    v_pk_add_f32 v[84:85], v[40:41], v[42:43]
    v_pk_fma_f32 v[86:87], v[42:43], v[42:43], v[86:87]
    v_pk_add_f32 v[84:85], v[84:85], v[44:45]
    v_pk_fma_f32 v[86:87], v[44:45], v[44:45], v[86:87]
    v_pk_add_f32 v[84:85], v[84:85], v[46:47]
    v_pk_fma_f32 v[86:87], v[46:47], v[46:47], v[86:87]
    s_nop 1
    v_permlane32_swap_b32 v84, v86
    v_permlane32_swap_b32 v85, v87
    v_pk_add_f32 v[84:85], v[84:85], v[86:87]
    s_waitcnt lgkmcnt(2)
    v_pk_add_f32 v[24:25], v[24:25], v[28:29]
    v_pk_add_f32 v[26:27], v[26:27], v[30:31]
    s_waitcnt lgkmcnt(1)
    v_pk_add_f32 v[24:25], v[24:25], v[32:33]
    v_pk_add_f32 v[26:27], v[26:27], v[34:35]
    s_waitcnt lgkmcnt(0)
    v_pk_add_f32 v[24:25], v[24:25], v[36:37]
    v_pk_add_f32 v[26:27], v[26:27], v[38:39]
    v_cvt_pk_bf16_f32 v28, v24, v25
    v_cvt_pk_bf16_f32 v29, v26, v27
    v_min_u32 v28, -2, v28
    v_min_u32 v29, -2, v29
    s_mov_b32 s72, 98304
    buffer_store_dwordx2 v[28:29], v5, s[60:63], s72 offen
    v_add_f32 v86, v84, v85
    v_add_f32 v84, v84, v85
    s_nop 1
    v_permlane16_swap_b32 v84, v86
    v_add_f32 v84, v84, v86
    s_nop 1
    v_add_f32_dpp v84, v84, v84 row_ror:8 row_mask:0xf bank_mask:0xf
    s_nop 1
    v_add_f32_dpp v84, v84, v84 row_ror:4 row_mask:0xf bank_mask:0xf
    s_nop 1
    v_add_f32_dpp v84, v84, v84 row_ror:2 row_mask:0xf bank_mask:0xf
    s_nop 1
    v_add_f32_dpp v84, v84, v84 row_ror:1 row_mask:0xf bank_mask:0xf
    v_mul_f32 v85, 0x3b000000, v84
    v_mul_f32 v84, 0x3b000000, v84
    s_nop 1
    v_permlane32_swap_b32 v84, v85
    v_fma_f32 v85, -v84, v84, v85
    v_max_f32 v85, 0, v85
    v_add_f32 v85, 0x3727c5ac, v85
    v_mul_f32 v85, 0x3ef5fdf0, v85
    v_rsq_f32 v86, v85
    s_nop 0
    v_mul_f32 v87, -v84, v86
    v_pk_fma_f32 v[56:57], v[40:41], v[86:87], v[86:87] op_sel:[0,0,1] op_sel_hi:[1,0,1]
    v_pk_fma_f32 v[58:59], v[42:43], v[86:87], v[86:87] op_sel:[0,0,1] op_sel_hi:[1,0,1]
    v_pk_fma_f32 v[60:61], v[44:45], v[86:87], v[86:87] op_sel:[0,0,1] op_sel_hi:[1,0,1]
    v_pk_fma_f32 v[62:63], v[46:47], v[86:87], v[86:87] op_sel:[0,0,1] op_sel_hi:[1,0,1]
    v_cvt_pk_bf16_f32 v88, v56, v57
    buffer_load_dwordx4 v[128:131], v7, s[60:63], s86 offen sc1
    v_cvt_pk_bf16_f32 v89, v58, v59
    v_cvt_pk_bf16_f32 v90, v60, v61
    v_cvt_pk_bf16_f32 v91, v62, v63
    buffer_store_dwordx4 v[88:91], v7, s[60:63], 0 offen
    buffer_store_dwordx2 v[86:87], v19, s[60:63], 0 offen offset:0
    v_lshlrev_b32 v104, 16, v148
    v_and_b32 v105, 0xffff0000, v148
    v_lshlrev_b32 v106, 16, v149
    v_and_b32 v107, 0xffff0000, v149
    v_lshlrev_b32 v108, 16, v150
    v_and_b32 v109, 0xffff0000, v150
    v_lshlrev_b32 v110, 16, v151
    v_and_b32 v111, 0xffff0000, v151
    v_lshlrev_b32 v112, 16, v156
    v_and_b32 v113, 0xffff0000, v156
    v_lshlrev_b32 v114, 16, v157
    v_and_b32 v115, 0xffff0000, v157
    v_lshlrev_b32 v116, 16, v158
    v_and_b32 v117, 0xffff0000, v158
    v_lshlrev_b32 v118, 16, v159
    v_and_b32 v119, 0xffff0000, v159
    s_waitcnt vmcnt(2)
    v_max3_u32 v23, v128, v129, v130
    v_max_u32 v23, v23, v131
    v_cmp_eq_u32 vcc, -1, v23
    s_nop 0
    s_cbranch_vccz L_ret_45
L_spin_44:
    buffer_load_dwordx4 v[128:131], v7, s[60:63], s86 offen sc1
    s_sub_u32 s71, s71, 1
    s_cbranch_scc1 L_bail_46
    s_waitcnt vmcnt(0)
    v_max3_u32 v23, v128, v129, v130
    v_max_u32 v23, v23, v131
    v_cmp_eq_u32 vcc, -1, v23
    s_nop 0
    s_cbranch_vccnz L_spin_44
L_ret_45:
    v_lshlrev_b32 v120, 16, v128
    v_and_b32 v121, 0xffff0000, v128
L_hop_6:
    s_cbranch_execz L_hop_back1
    v_lshlrev_b32 v122, 16, v129
    v_and_b32 v123, 0xffff0000, v129
    v_lshlrev_b32 v124, 16, v130
    v_and_b32 v125, 0xffff0000, v130
    v_lshlrev_b32 v126, 16, v131
    v_and_b32 v127, 0xffff0000, v131
    v_pk_fma_f32 v[104:105], v[120:121], s[42:43], v[104:105] op_sel_hi:[1,0,1]
    v_pk_fma_f32 v[106:107], v[122:123], s[42:43], v[106:107] op_sel_hi:[1,0,1]
    v_pk_fma_f32 v[108:109], v[124:125], s[42:43], v[108:109] op_sel_hi:[1,0,1]
    v_pk_fma_f32 v[110:111], v[126:127], s[42:43], v[110:111] op_sel_hi:[1,0,1]
    s_add_u32 s70, s69, 8
    v_mov_b32 v2, s70
    s_waitcnt vmcnt(0)
    buffer_store_dword v2, v3, s[60:63], 0 offen
    v_pk_mul_f32 v[134:135], v[104:105], v[104:105]
    v_pk_add_f32 v[132:133], v[104:105], v[106:107]
    v_pk_fma_f32 v[134:135], v[106:107], v[106:107], v[134:135]
    v_pk_add_f32 v[132:133], v[132:133], v[108:109]
    v_pk_fma_f32 v[134:135], v[108:109], v[108:109], v[134:135]
    v_pk_add_f32 v[132:133], v[132:133], v[110:111]
    v_pk_fma_f32 v[134:135], v[110:111], v[110:111], v[134:135]
    s_nop 1
    v_permlane32_swap_b32 v132, v134
    v_permlane32_swap_b32 v133, v135
    v_pk_add_f32 v[132:133], v[132:133], v[134:135]
    v_add_f32 v134, v132, v133
    v_add_f32 v132, v132, v133
    s_nop 1
    v_permlane16_swap_b32 v132, v134
    v_add_f32 v132, v132, v134
    s_nop 1
    v_add_f32_dpp v132, v132, v132 row_ror:8 row_mask:0xf bank_mask:0xf
    s_nop 1
    v_add_f32_dpp v132, v132, v132 row_ror:4 row_mask:0xf bank_mask:0xf
    s_nop 1
    v_add_f32_dpp v132, v132, v132 row_ror:2 row_mask:0xf bank_mask:0xf
    s_nop 1
    v_add_f32_dpp v132, v132, v132 row_ror:1 row_mask:0xf bank_mask:0xf
    v_mul_f32 v133, 0x3b000000, v132
    v_mul_f32 v132, 0x3b000000, v132
    s_nop 1
    v_permlane32_swap_b32 v132, v133
    v_fma_f32 v133, -v132, v132, v133
    v_max_f32 v133, 0, v133
    v_add_f32 v133, 0x3727c5ac, v133
    v_rsq_f32 v134, v133
    s_nop 0
    v_mul_f32 v135, -v132, v134
    v_pk_fma_f32 v[120:121], v[104:105], v[134:135], v[134:135] op_sel:[0,0,1] op_sel_hi:[1,0,1]
    v_pk_fma_f32 v[122:123], v[106:107], v[134:135], v[134:135] op_sel:[0,0,1] op_sel_hi:[1,0,1]
    v_pk_fma_f32 v[124:125], v[108:109], v[134:135], v[134:135] op_sel:[0,0,1] op_sel_hi:[1,0,1]
    v_pk_fma_f32 v[126:127], v[110:111], v[134:135], v[134:135] op_sel:[0,0,1] op_sel_hi:[1,0,1]
    v_pk_fma_f32 v[104:105], v[120:121], v[112:113], v[104:105]
    v_pk_fma_f32 v[106:107], v[122:123], v[114:115], v[106:107]
    v_pk_fma_f32 v[108:109], v[124:125], v[116:117], v[108:109]
    v_pk_fma_f32 v[110:111], v[126:127], v[118:119], v[110:111]
    v_pk_mul_f32 v[134:135], v[104:105], v[104:105]
    v_pk_add_f32 v[132:133], v[104:105], v[106:107]
    v_pk_fma_f32 v[134:135], v[106:107], v[106:107], v[134:135]
    v_pk_add_f32 v[132:133], v[132:133], v[108:109]
    v_pk_fma_f32 v[134:135], v[108:109], v[108:109], v[134:135]
    v_pk_add_f32 v[132:133], v[132:133], v[110:111]
    v_pk_fma_f32 v[134:135], v[110:111], v[110:111], v[134:135]
    s_nop 1
    v_permlane32_swap_b32 v132, v134
    v_permlane32_swap_b32 v133, v135
    v_pk_add_f32 v[132:133], v[132:133], v[134:135]
    v_add_f32 v134, v132, v133
    v_add_f32 v132, v132, v133
    s_nop 1
    v_permlane16_swap_b32 v132, v134
    v_add_f32 v132, v132, v134
    buffer_load_dword v2, v4, s[60:63], 0 offen sc1
    s_nop 0
    v_add_f32_dpp v132, v132, v132 row_ror:8 row_mask:0xf bank_mask:0xf
    s_nop 1
    v_add_f32_dpp v132, v132, v132 row_ror:4 row_mask:0xf bank_mask:0xf
    s_nop 1
    v_add_f32_dpp v132, v132, v132 row_ror:2 row_mask:0xf bank_mask:0xf
    s_nop 1
    v_add_f32_dpp v132, v132, v132 row_ror:1 row_mask:0xf bank_mask:0xf
    v_mul_f32 v133, 0x3b000000, v132
    v_mul_f32 v132, 0x3b000000, v132
    s_nop 1
    v_permlane32_swap_b32 v132, v133
    v_fma_f32 v133, -v132, v132, v133
    v_max_f32 v133, 0, v133
    v_add_f32 v133, 0x3727c5ac, v133
    v_mul_f32 v133, 0x3ef5fdf0, v133
    v_rsq_f32 v134, v133
    s_nop 0
    v_mul_f32 v135, -v132, v134
    v_pk_fma_f32 v[120:121], v[104:105], v[134:135], v[134:135] op_sel:[0,0,1] op_sel_hi:[1,0,1]
    v_pk_fma_f32 v[122:123], v[106:107], v[134:135], v[134:135] op_sel:[0,0,1] op_sel_hi:[1,0,1]
    v_pk_fma_f32 v[124:125], v[108:109], v[134:135], v[134:135] op_sel:[0,0,1] op_sel_hi:[1,0,1]
    v_pk_fma_f32 v[126:127], v[110:111], v[134:135], v[134:135] op_sel:[0,0,1] op_sel_hi:[1,0,1]
    v_cvt_pk_bf16_f32 v136, v120, v121
    v_cvt_pk_bf16_f32 v137, v122, v123
    v_cvt_pk_bf16_f32 v138, v124, v125
    v_cvt_pk_bf16_f32 v139, v126, v127
    buffer_store_dwordx4 v[136:139], v7, s[60:63], s86 offen
    buffer_store_dwordx2 v[134:135], v19, s[60:63], 0 offen offset:512
    s_waitcnt vmcnt(2)
    v_subrev_u32 v2, s70, v2
    v_cmp_le_u32 vcc, 16, v2
    s_nop 0
    s_cbranch_vccz L_ret_48
L_spin_47:
    buffer_load_dword v2, v4, s[60:63], 0 offen sc1
    s_sub_u32 s71, s71, 1
    s_cbranch_scc1 L_bail_49
    s_waitcnt vmcnt(0)
    v_subrev_u32 v2, s70, v2
    v_cmp_le_u32 vcc, 16, v2
    s_nop 0
    s_cbranch_vccnz L_spin_47
L_ret_48:
    s_cmp_ge_u32 s67, 14
    s_cbranch_scc1 L_g1skip_50
    s_add_u32 m0, s43, 0
    s_mov_b32 s72, 0
    buffer_load_dwordx4 v8, s[60:63], s72 offen offset:0 sc1 lds
    s_add_u32 m0, s43, 7936
    s_nop 0
    buffer_load_dwordx4 v8, s[60:63], s72 offen offset:256 sc1 lds
    s_add_u32 m0, s43, 15872
    s_nop 0
    buffer_load_dwordx4 v8, s[60:63], s72 offen offset:512 sc1 lds
    s_add_u32 m0, s43, 23808
    s_nop 0
    buffer_load_dwordx4 v8, s[60:63], s72 offen offset:768 sc1 lds
    v_or_b32 v16, 9, v17
    s_waitcnt vmcnt(4)
    buffer_store_dword v16, v3, s[60:63], 0 offen
    s_add_u32 m0, s43, 4096
    s_mov_b32 s72, 16384
    buffer_load_dwordx4 v8, s[60:63], s72 offen offset:0 sc1 lds
    s_add_u32 m0, s43, 12032
    s_nop 0
    buffer_load_dwordx4 v8, s[60:63], s72 offen offset:256 sc1 lds
    s_add_u32 m0, s43, 19968
    s_nop 0
    buffer_load_dwordx4 v8, s[60:63], s72 offen offset:512 sc1 lds
    s_add_u32 m0, s43, 27904
    s_nop 0
    buffer_load_dwordx4 v8, s[60:63], s72 offen offset:768 sc1 lds
    s_waitcnt vmcnt(7)
    s_barrier
    ds_read_b128 v[56:59], v96 offset:0
    ds_read_b128 v[60:63], v97 offset:0
    ds_read_b128 v[64:67], v98 offset:0
    ds_read_b128 v[68:71], v99 offset:0
    s_waitcnt lgkmcnt(3)
    v_mfma_f32_16x16x32_bf16 v[28:31], a[4:7], v[56:59], 0
    s_add_u32 m0, s43, 32768
    ds_read_b128 v[72:75], v96 offset:8192
    ds_read_b128 v[76:79], v97 offset:8192
    v_mfma_f32_16x16x32_bf16 v[24:27], a[0:3], v[56:59], 0
    s_mov_b32 s72, 32768
    s_waitcnt lgkmcnt(4)
    v_mfma_f32_16x16x32_bf16 v[24:27], a[8:11], v[60:63], v[24:27]
    buffer_load_dwordx4 v8, s[60:63], s72 offen offset:0 sc1 lds
    v_mfma_f32_16x16x32_bf16 v[28:31], a[12:15], v[60:63], v[28:31]
    s_waitcnt lgkmcnt(2)
    v_mfma_f32_16x16x32_bf16 v[28:31], a[20:23], v[64:67], v[28:31]
    s_add_u32 m0, s43, 40704
    ds_read_b128 v[56:59], v98 offset:8192
    ds_read_b128 v[60:63], v99 offset:8192
    v_mfma_f32_16x16x32_bf16 v[24:27], a[16:19], v[64:67], v[24:27]
    buffer_load_dwordx4 v8, s[60:63], s72 offen offset:256 sc1 lds
    v_mfma_f32_16x16x32_bf16 v[24:27], a[24:27], v[68:71], v[24:27]
    s_waitcnt vmcnt(7)
    s_barrier
    v_mfma_f32_16x16x32_bf16 v[28:31], a[28:31], v[68:71], v[28:31]
    s_waitcnt lgkmcnt(2)
    v_mfma_f32_16x16x32_bf16 v[28:31], a[36:39], v[72:75], v[28:31]
    s_add_u32 m0, s43, 48640
    ds_read_b128 v[64:67], v96 offset:16384
    ds_read_b128 v[68:71], v97 offset:16384
    v_mfma_f32_16x16x32_bf16 v[24:27], a[32:35], v[72:75], v[24:27]
    buffer_load_dwordx4 v8, s[60:63], s72 offen offset:512 sc1 lds
    v_mfma_f32_16x16x32_bf16 v[24:27], a[40:43], v[76:79], v[24:27]
    v_mfma_f32_16x16x32_bf16 v[28:31], a[44:47], v[76:79], v[28:31]
    s_waitcnt lgkmcnt(2)
    v_mfma_f32_16x16x32_bf16 v[28:31], a[52:55], v[56:59], v[28:31]
    s_add_u32 m0, s43, 56576
    ds_read_b128 v[72:75], v98 offset:16384
    ds_read_b128 v[76:79], v99 offset:16384
    v_mfma_f32_16x16x32_bf16 v[24:27], a[48:51], v[56:59], v[24:27]
    buffer_load_dwordx4 v8, s[60:63], s72 offen offset:768 sc1 lds
    v_mfma_f32_16x16x32_bf16 v[24:27], a[56:59], v[60:63], v[24:27]
    v_mfma_f32_16x16x32_bf16 v[28:31], a[60:63], v[60:63], v[28:31]
    s_waitcnt lgkmcnt(2)
    v_mfma_f32_16x16x32_bf16 v[28:31], a[68:71], v[64:67], v[28:31]
    s_add_u32 m0, s43, 36864
    ds_read_b128 v[56:59], v96 offset:24576
    ds_read_b128 v[60:63], v97 offset:24576
    v_mfma_f32_16x16x32_bf16 v[24:27], a[64:67], v[64:67], v[24:27]
    s_mov_b32 s72, 49152
    v_mfma_f32_16x16x32_bf16 v[24:27], a[72:75], v[68:71], v[24:27]
    buffer_load_dwordx4 v8, s[60:63], s72 offen offset:0 sc1 lds
    v_mfma_f32_16x16x32_bf16 v[28:31], a[76:79], v[68:71], v[28:31]
    s_waitcnt lgkmcnt(2)
    v_mfma_f32_16x16x32_bf16 v[28:31], a[84:87], v[72:75], v[28:31]
    s_add_u32 m0, s43, 44800
    ds_read_b128 v[64:67], v98 offset:24576
    ds_read_b128 v[68:71], v99 offset:24576
    v_mfma_f32_16x16x32_bf16 v[24:27], a[80:83], v[72:75], v[24:27]
    s_add_u32 s70, s69, 9
    buffer_load_dword v2, v4, s[60:63], 0 offen sc1
    v_mfma_f32_16x16x32_bf16 v[24:27], a[88:91], v[76:79], v[24:27]
    s_waitcnt vmcnt(6)
    s_barrier
    v_mfma_f32_16x16x32_bf16 v[28:31], a[92:95], v[76:79], v[28:31]
    s_waitcnt lgkmcnt(2)
    buffer_load_dwordx4 v8, s[60:63], s72 offen offset:256 sc1 lds
    v_mfma_f32_16x16x32_bf16 v[28:31], a[100:103], v[56:59], v[28:31]
    s_add_u32 m0, s43, 52736
    ds_read_b128 v[72:75], v96 offset:4096
    ds_read_b128 v[76:79], v97 offset:4096
    v_mfma_f32_16x16x32_bf16 v[24:27], a[96:99], v[56:59], v[24:27]
    buffer_load_dwordx4 v8, s[60:63], s72 offen offset:512 sc1 lds
    v_mfma_f32_16x16x32_bf16 v[24:27], a[104:107], v[60:63], v[24:27]
    v_mfma_f32_16x16x32_bf16 v[28:31], a[108:111], v[60:63], v[28:31]
    s_waitcnt lgkmcnt(2)
    v_mfma_f32_16x16x32_bf16 v[28:31], a[116:119], v[64:67], v[28:31]
    s_add_u32 m0, s43, 60672
    ds_read_b128 v[56:59], v98 offset:4096
    ds_read_b128 v[60:63], v99 offset:4096
    v_mfma_f32_16x16x32_bf16 v[24:27], a[112:115], v[64:67], v[24:27]
    buffer_load_dwordx4 v8, s[60:63], s72 offen offset:768 sc1 lds
    v_mfma_f32_16x16x32_bf16 v[24:27], a[120:123], v[68:71], v[24:27]
    v_mfma_f32_16x16x32_bf16 v[28:31], a[124:127], v[68:71], v[28:31]
    s_waitcnt lgkmcnt(2)
    v_mfma_f32_16x16x32_bf16 v[36:39], a[4:7], v[72:75], 0
    ds_read_b128 v[64:67], v96 offset:12288
    ds_read_b128 v[68:71], v97 offset:12288
    v_mfma_f32_16x16x32_bf16 v[32:35], a[0:3], v[72:75], 0
    v_mfma_f32_16x16x32_bf16 v[32:35], a[8:11], v[76:79], v[32:35]
    v_mfma_f32_16x16x32_bf16 v[36:39], a[12:15], v[76:79], v[36:39]
    s_waitcnt lgkmcnt(2)
    v_mfma_f32_16x16x32_bf16 v[36:39], a[20:23], v[56:59], v[36:39]
    ds_read_b128 v[72:75], v98 offset:12288
    ds_read_b128 v[76:79], v99 offset:12288
    v_mfma_f32_16x16x32_bf16 v[32:35], a[16:19], v[56:59], v[32:35]
    v_mfma_f32_16x16x32_bf16 v[32:35], a[24:27], v[60:63], v[32:35]
    v_exp_f32 v80, -v24
    v_mfma_f32_16x16x32_bf16 v[36:39], a[28:31], v[60:63], v[36:39]
    s_waitcnt lgkmcnt(2)
    v_exp_f32 v81, -v25
    v_mfma_f32_16x16x32_bf16 v[36:39], a[36:39], v[64:67], v[36:39]
    ds_read_b128 v[56:59], v96 offset:20480
    ds_read_b128 v[60:63], v97 offset:20480
    v_add_f32 v80, 1.0, v80
    v_mfma_f32_16x16x32_bf16 v[32:35], a[32:35], v[64:67], v[32:35]
    v_rcp_f32 v80, v80
    v_mfma_f32_16x16x32_bf16 v[32:35], a[40:43], v[68:71], v[32:35]
    v_exp_f32 v82, -v26
    v_mfma_f32_16x16x32_bf16 v[36:39], a[44:47], v[68:71], v[36:39]
    s_waitcnt lgkmcnt(2)
    v_exp_f32 v83, -v27
    v_mul_f32 v80, v80, v24
    v_mfma_f32_16x16x32_bf16 v[36:39], a[52:55], v[72:75], v[36:39]
    ds_read_b128 v[64:67], v98 offset:20480
    ds_read_b128 v[68:71], v99 offset:20480
    v_mfma_f32_16x16x32_bf16 v[32:35], a[48:51], v[72:75], v[32:35]
    s_waitcnt vmcnt(3)
    v_subrev_u32 v2, s70, v2
    v_cmp_le_u32 vcc, 16, v2
    v_add_f32 v81, 1.0, v81
    v_mfma_f32_16x16x32_bf16 v[32:35], a[56:59], v[76:79], v[32:35]
    s_cbranch_vccnz L_slow_52
L_back_53:
    v_mfma_f32_16x16x32_bf16 v[36:39], a[60:63], v[76:79], v[36:39]
    s_waitcnt lgkmcnt(2)
    v_rcp_f32 v81, v81
    v_mfma_f32_16x16x32_bf16 v[36:39], a[68:71], v[56:59], v[36:39]
    s_add_u32 m0, s43, 65536
    ds_read_b128 v[72:75], v96 offset:28672
    ds_read_b128 v[76:79], v97 offset:28672
    v_mul_f32 v81, v81, v25
    v_mfma_f32_16x16x32_bf16 v[32:35], a[64:67], v[56:59], v[32:35]
    s_mov_b32 s72, 65536
    v_exp_f32 v84, -v28
    v_mfma_f32_16x16x32_bf16 v[32:35], a[72:75], v[60:63], v[32:35]
    buffer_load_dwordx4 v8, s[60:63], s72 offen offset:0 sc1 lds
    v_mfma_f32_16x16x32_bf16 v[36:39], a[76:79], v[60:63], v[36:39]
    s_waitcnt lgkmcnt(2)
    v_exp_f32 v85, -v29
    v_cvt_pk_bf16_f32 v88, v80, v81
    v_mfma_f32_16x16x32_bf16 v[36:39], a[84:87], v[64:67], v[36:39]
    s_add_u32 m0, s43, 73472
    ds_read_b128 v[56:59], v98 offset:28672
    ds_read_b128 v[60:63], v99 offset:28672
    v_mfma_f32_16x16x32_bf16 v[32:35], a[80:83], v[64:67], v[32:35]
    buffer_load_dwordx4 v8, s[60:63], s72 offen offset:256 sc1 lds
    v_add_f32 v82, 1.0, v82
    v_mfma_f32_16x16x32_bf16 v[32:35], a[88:91], v[68:71], v[32:35]
    s_barrier
    v_mfma_f32_16x16x32_bf16 v[36:39], a[92:95], v[68:71], v[36:39]
    s_waitcnt lgkmcnt(2)
    v_rcp_f32 v82, v82
    v_mfma_f32_16x16x32_bf16 v[36:39], a[100:103], v[72:75], v[36:39]
    s_add_u32 m0, s43, 81408
    ds_read_b128 v[64:67], v96 offset:32768
    ds_read_b128 v[68:71], v97 offset:32768
    v_mul_f32 v82, v82, v26
    v_mfma_f32_16x16x32_bf16 v[32:35], a[96:99], v[72:75], v[32:35]
    buffer_load_dwordx4 v8, s[60:63], s72 offen offset:512 sc1 lds
    v_mfma_f32_16x16x32_bf16 v[32:35], a[104:107], v[76:79], v[32:35]
    v_exp_f32 v86, -v30
    v_mfma_f32_16x16x32_bf16 v[36:39], a[108:111], v[76:79], v[36:39]
    s_waitcnt lgkmcnt(2)
    v_exp_f32 v87, -v31
    v_add_f32 v83, 1.0, v83
    v_mfma_f32_16x16x32_bf16 v[36:39], a[116:119], v[56:59], v[36:39]
    s_add_u32 m0, s43, 89344
    ds_read_b128 v[72:75], v98 offset:32768
    ds_read_b128 v[76:79], v99 offset:32768
    v_mfma_f32_16x16x32_bf16 v[32:35], a[112:115], v[56:59], v[32:35]
    buffer_load_dwordx4 v8, s[60:63], s72 offen offset:768 sc1 lds
    v_add_f32 v84, 1.0, v84
    v_mfma_f32_16x16x32_bf16 v[32:35], a[120:123], v[60:63], v[32:35]
    v_rcp_f32 v83, v83
    v_mfma_f32_16x16x32_bf16 v[36:39], a[124:127], v[60:63], v[36:39]
    s_waitcnt lgkmcnt(2)
    v_rcp_f32 v84, v84
    v_mfma_f32_16x16x32_bf16 v[44:47], a[4:7], v[64:67], 0
    s_add_u32 m0, s43, 69632
    ds_read_b128 v[56:59], v96 offset:40960
    ds_read_b128 v[60:63], v97 offset:40960
    v_mul_f32 v83, v83, v27
    v_mfma_f32_16x16x32_bf16 v[40:43], a[0:3], v[64:67], 0
    s_mov_b32 s72, 81920
    v_cvt_pk_bf16_f32 v89, v82, v83
    v_mul_f32 v84, v84, v28
    v_mfma_f32_16x16x32_bf16 v[40:43], a[8:11], v[68:71], v[40:43]
    buffer_load_dwordx4 v8, s[60:63], s72 offen offset:0 sc1 lds
    v_mfma_f32_16x16x32_bf16 v[44:47], a[12:15], v[68:71], v[44:47]
    s_waitcnt lgkmcnt(2)
    v_add_f32 v85, 1.0, v85
    v_add_f32 v86, 1.0, v86
    v_add_f32 v87, 1.0, v87
    v_mfma_f32_16x16x32_bf16 v[44:47], a[20:23], v[72:75], v[44:47]
    s_add_u32 m0, s43, 77568
    ds_read_b128 v[64:67], v98 offset:40960
    ds_read_b128 v[68:71], v99 offset:40960
    v_mfma_f32_16x16x32_bf16 v[40:43], a[16:19], v[72:75], v[40:43]
    buffer_load_dwordx4 v8, s[60:63], s72 offen offset:256 sc1 lds
    v_mfma_f32_16x16x32_bf16 v[40:43], a[24:27], v[76:79], v[40:43]
    v_rcp_f32 v85, v85
    v_mfma_f32_16x16x32_bf16 v[44:47], a[28:31], v[76:79], v[44:47]
    s_waitcnt lgkmcnt(2)
    v_rcp_f32 v86, v86
    v_mfma_f32_16x16x32_bf16 v[44:47], a[36:39], v[56:59], v[44:47]
    s_add_u32 m0, s43, 85504
    ds_read_b128 v[72:75], v96 offset:49152
    ds_read_b128 v[76:79], v97 offset:49152
    v_mul_f32 v85, v85, v29
    v_mfma_f32_16x16x32_bf16 v[40:43], a[32:35], v[56:59], v[40:43]
    buffer_load_dwordx4 v8, s[60:63], s72 offen offset:512 sc1 lds
    v_mfma_f32_16x16x32_bf16 v[40:43], a[40:43], v[60:63], v[40:43]
    v_rcp_f32 v87, v87
    v_mfma_f32_16x16x32_bf16 v[44:47], a[44:47], v[60:63], v[44:47]
    s_waitcnt lgkmcnt(2)
    v_cvt_pk_bf16_f32 v90, v84, v85
    v_mul_f32 v86, v86, v30
    v_mul_f32 v87, v87, v31
    v_mfma_f32_16x16x32_bf16 v[44:47], a[52:55], v[64:67], v[44:47]
    s_add_u32 m0, s43, 93440
    ds_read_b128 v[56:59], v98 offset:49152
    ds_read_b128 v[60:63], v99 offset:49152
    v_mfma_f32_16x16x32_bf16 v[40:43], a[48:51], v[64:67], v[40:43]
    buffer_load_dwordx4 v8, s[60:63], s72 offen offset:768 sc1 lds
    v_cvt_pk_bf16_f32 v91, v86, v87
    v_mfma_f32_16x16x32_bf16 v[40:43], a[56:59], v[68:71], v[40:43]
    s_mov_b32 s75, 917504
    buffer_store_dwordx4 v[88:91], v6, s[60:63], s75 offen sc1
    v_mfma_f32_16x16x32_bf16 v[44:47], a[60:63], v[68:71], v[44:47]
    s_waitcnt lgkmcnt(2)
    v_exp_f32 v80, -v32
    v_mfma_f32_16x16x32_bf16 v[44:47], a[68:71], v[72:75], v[44:47]
    s_add_u32 m0, s43, 98304
    ds_read_b128 v[64:67], v96 offset:57344
    ds_read_b128 v[68:71], v97 offset:57344
    v_mfma_f32_16x16x32_bf16 v[40:43], a[64:67], v[72:75], v[40:43]
    s_mov_b32 s72, 98304
    v_exp_f32 v81, -v33
    v_add_f32 v80, 1.0, v80
    v_mfma_f32_16x16x32_bf16 v[40:43], a[72:75], v[76:79], v[40:43]
    buffer_load_dwordx4 v8, s[60:63], s72 offen offset:0 sc1 lds
    v_add_f32 v81, 1.0, v81
    v_mfma_f32_16x16x32_bf16 v[44:47], a[76:79], v[76:79], v[44:47]
    s_waitcnt lgkmcnt(2)
    v_rcp_f32 v80, v80
    v_mfma_f32_16x16x32_bf16 v[44:47], a[84:87], v[56:59], v[44:47]
    s_add_u32 m0, s43, 106240
    ds_read_b128 v[72:75], v98 offset:57344
    ds_read_b128 v[76:79], v99 offset:57344
    v_mul_f32 v80, v80, v32
    v_mfma_f32_16x16x32_bf16 v[40:43], a[80:83], v[56:59], v[40:43]
    buffer_load_dwordx4 v8, s[60:63], s72 offen offset:256 sc1 lds
    v_mfma_f32_16x16x32_bf16 v[40:43], a[88:91], v[60:63], v[40:43]
    s_waitcnt vmcnt(11)
    s_barrier
    v_mfma_f32_16x16x32_bf16 v[44:47], a[92:95], v[60:63], v[44:47]
    s_waitcnt lgkmcnt(2)
    v_rcp_f32 v81, v81
    v_mfma_f32_16x16x32_bf16 v[44:47], a[100:103], v[64:67], v[44:47]
    s_add_u32 m0, s43, 114176
    ds_read_b128 v[56:59], v96 offset:36864
    ds_read_b128 v[60:63], v97 offset:36864
    v_mfma_f32_16x16x32_bf16 v[40:43], a[96:99], v[64:67], v[40:43]
    buffer_load_dwordx4 v8, s[60:63], s72 offen offset:512 sc1 lds
    v_mul_f32 v81, v81, v33
    v_mfma_f32_16x16x32_bf16 v[40:43], a[104:107], v[68:71], v[40:43]
    v_exp_f32 v82, -v34
    v_cvt_pk_bf16_f32 v92, v80, v81
    v_mfma_f32_16x16x32_bf16 v[44:47], a[108:111], v[68:71], v[44:47]
    s_waitcnt lgkmcnt(2)
    v_exp_f32 v83, -v35
    v_mfma_f32_16x16x32_bf16 v[44:47], a[116:119], v[72:75], v[44:47]
    s_add_u32 m0, s43, 122112
    ds_read_b128 v[64:67], v98 offset:36864
    ds_read_b128 v[68:71], v99 offset:36864
    v_add_f32 v82, 1.0, v82
    v_mfma_f32_16x16x32_bf16 v[40:43], a[112:115], v[72:75], v[40:43]
    buffer_load_dwordx4 v8, s[60:63], s72 offen offset:768 sc1 lds
    v_add_f32 v83, 1.0, v83
    v_mfma_f32_16x16x32_bf16 v[40:43], a[120:123], v[76:79], v[40:43]
    v_rcp_f32 v82, v82
    v_mfma_f32_16x16x32_bf16 v[44:47], a[124:127], v[76:79], v[44:47]
    s_waitcnt lgkmcnt(2)
    v_rcp_f32 v83, v83
    v_mul_f32 v82, v82, v34
    v_mfma_f32_16x16x32_bf16 v[52:55], a[4:7], v[56:59], 0
    s_add_u32 m0, s43, 102400
    ds_read_b128 v[72:75], v96 offset:45056
    ds_read_b128 v[76:79], v97 offset:45056
    v_mfma_f32_16x16x32_bf16 v[48:51], a[0:3], v[56:59], 0
    s_mov_b32 s72, 114688
    v_exp_f32 v84, -v36
    v_mul_f32 v83, v83, v35
    v_mfma_f32_16x16x32_bf16 v[48:51], a[8:11], v[60:63], v[48:51]
    buffer_load_dwordx4 v8, s[60:63], s72 offen offset:0 sc1 lds
    v_cvt_pk_bf16_f32 v93, v82, v83
    v_mfma_f32_16x16x32_bf16 v[52:55], a[12:15], v[60:63], v[52:55]
    s_waitcnt lgkmcnt(2)
    v_exp_f32 v85, -v37
    v_mfma_f32_16x16x32_bf16 v[52:55], a[20:23], v[64:67], v[52:55]
    s_add_u32 m0, s43, 110336
    ds_read_b128 v[56:59], v98 offset:45056
    ds_read_b128 v[60:63], v99 offset:45056
    v_add_f32 v84, 1.0, v84
    v_mfma_f32_16x16x32_bf16 v[48:51], a[16:19], v[64:67], v[48:51]
    buffer_load_dwordx4 v8, s[60:63], s72 offen offset:256 sc1 lds
    v_add_f32 v85, 1.0, v85
    v_mfma_f32_16x16x32_bf16 v[48:51], a[24:27], v[68:71], v[48:51]
    v_rcp_f32 v84, v84
    v_mfma_f32_16x16x32_bf16 v[52:55], a[28:31], v[68:71], v[52:55]
    s_waitcnt lgkmcnt(2)
    v_rcp_f32 v85, v85
    v_mul_f32 v84, v84, v36
    v_mfma_f32_16x16x32_bf16 v[52:55], a[36:39], v[72:75], v[52:55]
    s_add_u32 m0, s43, 118272
    ds_read_b128 v[64:67], v96 offset:53248
    ds_read_b128 v[68:71], v97 offset:53248
    v_mfma_f32_16x16x32_bf16 v[48:51], a[32:35], v[72:75], v[48:51]
    buffer_load_dwordx4 v8, s[60:63], s72 offen offset:512 sc1 lds
    v_mul_f32 v85, v85, v37
    v_mfma_f32_16x16x32_bf16 v[48:51], a[40:43], v[76:79], v[48:51]
    v_exp_f32 v86, -v38
    v_cvt_pk_bf16_f32 v94, v84, v85
    v_mfma_f32_16x16x32_bf16 v[52:55], a[44:47], v[76:79], v[52:55]
    s_waitcnt lgkmcnt(2)
    v_exp_f32 v87, -v39
    v_mfma_f32_16x16x32_bf16 v[52:55], a[52:55], v[56:59], v[52:55]
    s_add_u32 m0, s43, 126208
    ds_read_b128 v[72:75], v98 offset:53248
    ds_read_b128 v[76:79], v99 offset:53248
    v_add_f32 v86, 1.0, v86
    v_mfma_f32_16x16x32_bf16 v[48:51], a[48:51], v[56:59], v[48:51]
    buffer_load_dwordx4 v8, s[60:63], s72 offen offset:768 sc1 lds
    v_add_f32 v87, 1.0, v87
    v_mfma_f32_16x16x32_bf16 v[48:51], a[56:59], v[60:63], v[48:51]
    v_rcp_f32 v86, v86
    v_mfma_f32_16x16x32_bf16 v[52:55], a[60:63], v[60:63], v[52:55]
    s_waitcnt lgkmcnt(2)
    v_rcp_f32 v87, v87
    v_mul_f32 v86, v86, v38
    v_mfma_f32_16x16x32_bf16 v[52:55], a[68:71], v[64:67], v[52:55]
    ds_read_b128 v[56:59], v96 offset:61440
    ds_read_b128 v[60:63], v97 offset:61440
    v_mfma_f32_16x16x32_bf16 v[48:51], a[64:67], v[64:67], v[48:51]
    v_xor_b32 v96, 0x10000, v96
    v_xor_b32 v97, 0x10000, v97
    v_mul_f32 v87, v87, v39
    v_mfma_f32_16x16x32_bf16 v[48:51], a[72:75], v[68:71], v[48:51]
    v_cvt_pk_bf16_f32 v95, v86, v87
    v_mfma_f32_16x16x32_bf16 v[52:55], a[76:79], v[68:71], v[52:55]
    s_waitcnt lgkmcnt(2)
    s_mov_b32 s75, 974848
    buffer_store_dwordx4 v[92:95], v6, s[60:63], s75 offen sc1
    v_mfma_f32_16x16x32_bf16 v[52:55], a[84:87], v[72:75], v[52:55]
    ds_read_b128 v[64:67], v98 offset:61440
    ds_read_b128 v[68:71], v99 offset:61440
    v_mfma_f32_16x16x32_bf16 v[48:51], a[80:83], v[72:75], v[48:51]
    v_xor_b32 v98, 0x10000, v98
    v_xor_b32 v99, 0x10000, v99
    v_mfma_f32_16x16x32_bf16 v[48:51], a[88:91], v[76:79], v[48:51]
    s_waitcnt vmcnt(10)
    s_barrier
    v_mfma_f32_16x16x32_bf16 v[52:55], a[92:95], v[76:79], v[52:55]
    s_waitcnt lgkmcnt(2)
    v_or_b32 v16, 10, v17
    v_mfma_f32_16x16x32_bf16 v[52:55], a[100:103], v[56:59], v[52:55]
    ds_read_b128 v[72:75], v96 offset:0
    ds_read_b128 v[76:79], v97 offset:0
    v_mfma_f32_16x16x32_bf16 v[48:51], a[96:99], v[56:59], v[48:51]
    v_exp_f32 v80, -v40
    v_mfma_f32_16x16x32_bf16 v[48:51], a[104:107], v[60:63], v[48:51]
    v_exp_f32 v81, -v41
    v_add_f32 v80, 1.0, v80
    v_mfma_f32_16x16x32_bf16 v[52:55], a[108:111], v[60:63], v[52:55]
    s_waitcnt lgkmcnt(2)
    v_rcp_f32 v80, v80
    v_mfma_f32_16x16x32_bf16 v[52:55], a[116:119], v[64:67], v[52:55]
    ds_read_b128 v[56:59], v98 offset:0
    ds_read_b128 v[60:63], v99 offset:0
    v_mul_f32 v80, v80, v40
    v_mfma_f32_16x16x32_bf16 v[48:51], a[112:115], v[64:67], v[48:51]
    v_exp_f32 v82, -v42
    v_mfma_f32_16x16x32_bf16 v[48:51], a[120:123], v[68:71], v[48:51]
    v_exp_f32 v83, -v43
    v_add_f32 v81, 1.0, v81
    v_mfma_f32_16x16x32_bf16 v[52:55], a[124:127], v[68:71], v[52:55]
    s_waitcnt lgkmcnt(2)
    v_rcp_f32 v81, v81
    v_mfma_f32_16x16x32_bf16 v[28:31], a[4:7], v[72:75], 0
    ds_read_b128 v[64:67], v96 offset:8192
    ds_read_b128 v[68:71], v97 offset:8192
    v_mul_f32 v81, v81, v41
    v_mfma_f32_16x16x32_bf16 v[24:27], a[0:3], v[72:75], 0
    v_exp_f32 v84, -v44
    v_mfma_f32_16x16x32_bf16 v[24:27], a[8:11], v[76:79], v[24:27]
    v_exp_f32 v85, -v45
    v_cvt_pk_bf16_f32 v88, v80, v81
    v_mfma_f32_16x16x32_bf16 v[28:31], a[12:15], v[76:79], v[28:31]
    s_waitcnt lgkmcnt(2)
    v_exp_f32 v86, -v46
    v_mfma_f32_16x16x32_bf16 v[28:31], a[20:23], v[56:59], v[28:31]
    ds_read_b128 v[72:75], v98 offset:8192
    ds_read_b128 v[76:79], v99 offset:8192
    v_add_f32 v82, 1.0, v82
    v_mfma_f32_16x16x32_bf16 v[24:27], a[16:19], v[56:59], v[24:27]
    v_rcp_f32 v82, v82
    v_mfma_f32_16x16x32_bf16 v[24:27], a[24:27], v[60:63], v[24:27]
    v_exp_f32 v87, -v47
    v_mul_f32 v82, v82, v42
    v_mfma_f32_16x16x32_bf16 v[28:31], a[28:31], v[60:63], v[28:31]
    s_waitcnt lgkmcnt(2)
    v_add_f32 v83, 1.0, v83
    v_add_f32 v84, 1.0, v84
    v_mfma_f32_16x16x32_bf16 v[28:31], a[36:39], v[64:67], v[28:31]
    ds_read_b128 v[56:59], v96 offset:16384
    ds_read_b128 v[60:63], v97 offset:16384
    v_add_f32 v85, 1.0, v85
    v_mfma_f32_16x16x32_bf16 v[24:27], a[32:35], v[64:67], v[24:27]
    v_rcp_f32 v83, v83
    v_mfma_f32_16x16x32_bf16 v[24:27], a[40:43], v[68:71], v[24:27]
    v_rcp_f32 v84, v84
    v_mul_f32 v83, v83, v43
    v_mfma_f32_16x16x32_bf16 v[28:31], a[44:47], v[68:71], v[28:31]
    s_waitcnt lgkmcnt(2)
    v_rcp_f32 v85, v85
    v_mfma_f32_16x16x32_bf16 v[28:31], a[52:55], v[72:75], v[28:31]
    ds_read_b128 v[64:67], v98 offset:16384
    ds_read_b128 v[68:71], v99 offset:16384
    v_cvt_pk_bf16_f32 v89, v82, v83
    v_mfma_f32_16x16x32_bf16 v[24:27], a[48:51], v[72:75], v[24:27]
    v_mul_f32 v84, v84, v44
    v_mul_f32 v85, v85, v45
    v_mfma_f32_16x16x32_bf16 v[24:27], a[56:59], v[76:79], v[24:27]
    v_cvt_pk_bf16_f32 v90, v84, v85
    v_add_f32 v86, 1.0, v86
    v_add_f32 v87, 1.0, v87
    v_mfma_f32_16x16x32_bf16 v[28:31], a[60:63], v[76:79], v[28:31]
    s_waitcnt lgkmcnt(2)
    v_rcp_f32 v86, v86
    v_mfma_f32_16x16x32_bf16 v[28:31], a[68:71], v[56:59], v[28:31]
    ds_read_b128 v[72:75], v96 offset:24576
    ds_read_b128 v[76:79], v97 offset:24576
    v_mul_f32 v86, v86, v46
    v_mfma_f32_16x16x32_bf16 v[24:27], a[64:67], v[56:59], v[24:27]
    v_rcp_f32 v87, v87
    v_mfma_f32_16x16x32_bf16 v[24:27], a[72:75], v[60:63], v[24:27]
    v_mul_f32 v87, v87, v47
    v_mfma_f32_16x16x32_bf16 v[28:31], a[76:79], v[60:63], v[28:31]
    s_waitcnt lgkmcnt(2)
    v_cvt_pk_bf16_f32 v91, v86, v87
    v_mfma_f32_16x16x32_bf16 v[28:31], a[84:87], v[64:67], v[28:31]
    ds_read_b128 v[56:59], v98 offset:24576
    ds_read_b128 v[60:63], v99 offset:24576
    v_mfma_f32_16x16x32_bf16 v[24:27], a[80:83], v[64:67], v[24:27]
    s_mov_b32 s75, 1032192
    buffer_store_dwordx4 v[88:91], v6, s[60:63], s75 offen sc1
    v_mfma_f32_16x16x32_bf16 v[24:27], a[88:91], v[68:71], v[24:27]
    v_exp_f32 v80, -v48
    v_mfma_f32_16x16x32_bf16 v[28:31], a[92:95], v[68:71], v[28:31]
    s_waitcnt lgkmcnt(2)
    v_exp_f32 v81, -v49
L_hop_7:
    s_cbranch_execz L_hop_back1
    v_add_f32 v80, 1.0, v80
    v_mfma_f32_16x16x32_bf16 v[28:31], a[100:103], v[72:75], v[28:31]
    ds_read_b128 v[64:67], v96 offset:4096
    ds_read_b128 v[68:71], v97 offset:4096
    v_rcp_f32 v80, v80
    v_mfma_f32_16x16x32_bf16 v[24:27], a[96:99], v[72:75], v[24:27]
    v_exp_f32 v82, -v50
    v_mul_f32 v80, v80, v48
    v_mfma_f32_16x16x32_bf16 v[24:27], a[104:107], v[76:79], v[24:27]
    v_lshrrev_b32 v20, 10, v5
    v_lshlrev_b32 v20, 3, v20
    v_add_f32 v81, 1.0, v81
    v_mfma_f32_16x16x32_bf16 v[28:31], a[108:111], v[76:79], v[28:31]
    s_waitcnt lgkmcnt(2)
    s_mov_b32 s74, 2098176
    buffer_load_dwordx2 v[146:147], v20, s[60:63], s74 offen offset:0 sc1
    v_mfma_f32_16x16x32_bf16 v[28:31], a[116:119], v[56:59], v[28:31]
    ds_read_b128 v[72:75], v98 offset:4096
    ds_read_b128 v[76:79], v99 offset:4096
    v_rcp_f32 v81, v81
    v_mfma_f32_16x16x32_bf16 v[24:27], a[112:115], v[56:59], v[24:27]
    buffer_load_dwordx2 v[150:151], v20, s[60:63], s74 offen offset:256 sc1
    v_mul_f32 v81, v81, v49
    v_mfma_f32_16x16x32_bf16 v[24:27], a[120:123], v[60:63], v[24:27]
    buffer_load_dwordx2 v[154:155], v20, s[60:63], s74 offen offset:512 sc1
    v_cvt_pk_bf16_f32 v92, v80, v81
    v_mfma_f32_16x16x32_bf16 v[28:31], a[124:127], v[60:63], v[28:31]
    s_waitcnt lgkmcnt(2)
    buffer_load_dwordx2 v[158:159], v20, s[60:63], s74 offen offset:768 sc1
    v_add_f32 v82, 1.0, v82
    v_mfma_f32_16x16x32_bf16 v[36:39], a[4:7], v[64:67], 0
    ds_read_b128 v[56:59], v96 offset:12288
    ds_read_b128 v[60:63], v97 offset:12288
    v_rcp_f32 v82, v82
    v_mfma_f32_16x16x32_bf16 v[32:35], a[0:3], v[64:67], 0
    s_mov_b32 s74, 0
    buffer_load_dwordx2 v[144:145], v5, s[60:63], s74 offen sc1
    v_mul_f32 v82, v82, v50
    v_mfma_f32_16x16x32_bf16 v[32:35], a[8:11], v[68:71], v[32:35]
    s_mov_b32 s74, 32768
    buffer_load_dwordx2 v[148:149], v5, s[60:63], s74 offen sc1
    v_mfma_f32_16x16x32_bf16 v[36:39], a[12:15], v[68:71], v[36:39]
    s_waitcnt lgkmcnt(2)
    s_mov_b32 s74, 65536
    buffer_load_dwordx2 v[152:153], v5, s[60:63], s74 offen sc1
    v_mfma_f32_16x16x32_bf16 v[36:39], a[20:23], v[72:75], v[36:39]
    ds_read_b128 v[64:67], v98 offset:12288
    ds_read_b128 v[68:71], v99 offset:12288
    v_exp_f32 v83, -v51
    v_mfma_f32_16x16x32_bf16 v[32:35], a[16:19], v[72:75], v[32:35]
    s_mov_b32 s74, 98304
    buffer_load_dwordx2 v[156:157], v5, s[60:63], s74 offen sc1
    v_add_f32 v83, 1.0, v83
    v_mfma_f32_16x16x32_bf16 v[32:35], a[24:27], v[76:79], v[32:35]
    s_or_b32 s74, s2, s66
    v_or_b32 v21, s74, v1
    v_cmp_eq_u32 s[84:85], 0, v21
    v_mfma_f32_16x16x32_bf16 v[36:39], a[28:31], v[76:79], v[36:39]
    s_waitcnt lgkmcnt(2)
    v_mov_b32 v20, s69
    v_rcp_f32 v83, v83
    v_mfma_f32_16x16x32_bf16 v[36:39], a[36:39], v[56:59], v[36:39]
    ds_read_b128 v[72:75], v96 offset:20480
    ds_read_b128 v[76:79], v97 offset:20480
    v_exp_f32 v84, -v52
    v_mfma_f32_16x16x32_bf16 v[32:35], a[32:35], v[56:59], v[32:35]
    v_cndmask_b32 v21, -1, v21, s[84:85]
    v_exp_f32 v85, -v53
    v_mfma_f32_16x16x32_bf16 v[32:35], a[40:43], v[60:63], v[32:35]
    buffer_store_dword v20, v21, s[52:55], 0 offen sc1
    v_mfma_f32_16x16x32_bf16 v[36:39], a[44:47], v[60:63], v[36:39]
    s_waitcnt lgkmcnt(2)
    v_exp_f32 v86, -v54
    v_mul_f32 v83, v83, v51
    v_mfma_f32_16x16x32_bf16 v[36:39], a[52:55], v[64:67], v[36:39]
    ds_read_b128 v[56:59], v98 offset:20480
    ds_read_b128 v[60:63], v99 offset:20480
    v_exp_f32 v87, -v55
    v_mfma_f32_16x16x32_bf16 v[32:35], a[48:51], v[64:67], v[32:35]
    v_cvt_pk_bf16_f32 v93, v82, v83
    v_add_f32 v84, 1.0, v84
    v_add_f32 v85, 1.0, v85
    v_mfma_f32_16x16x32_bf16 v[32:35], a[56:59], v[68:71], v[32:35]
    v_rcp_f32 v84, v84
    v_add_f32 v86, 1.0, v86
    v_mfma_f32_16x16x32_bf16 v[36:39], a[60:63], v[68:71], v[36:39]
    s_waitcnt lgkmcnt(2)
    v_rcp_f32 v85, v85
    v_mul_f32 v84, v84, v52
    v_mfma_f32_16x16x32_bf16 v[36:39], a[68:71], v[72:75], v[36:39]
    ds_read_b128 v[64:67], v96 offset:28672
    ds_read_b128 v[68:71], v97 offset:28672
    v_rcp_f32 v86, v86
    v_mfma_f32_16x16x32_bf16 v[32:35], a[64:67], v[72:75], v[32:35]
    v_mul_f32 v85, v85, v53
    v_mul_f32 v86, v86, v54
    v_add_f32 v87, 1.0, v87
    v_mfma_f32_16x16x32_bf16 v[32:35], a[72:75], v[76:79], v[32:35]
    s_waitcnt vmcnt(10)
    buffer_store_dword v16, v3, s[60:63], 0 offen
    v_mfma_f32_16x16x32_bf16 v[36:39], a[76:79], v[76:79], v[36:39]
    s_waitcnt lgkmcnt(2)
    v_rcp_f32 v87, v87
    v_cvt_pk_bf16_f32 v94, v84, v85
    v_mfma_f32_16x16x32_bf16 v[36:39], a[84:87], v[56:59], v[36:39]
    ds_read_b128 v[72:75], v98 offset:28672
    ds_read_b128 v[76:79], v99 offset:28672
    v_mul_f32 v87, v87, v55
    v_mfma_f32_16x16x32_bf16 v[32:35], a[80:83], v[56:59], v[32:35]
    v_cvt_pk_bf16_f32 v95, v86, v87
    v_mfma_f32_16x16x32_bf16 v[32:35], a[88:91], v[60:63], v[32:35]
    s_barrier
    v_mfma_f32_16x16x32_bf16 v[36:39], a[92:95], v[60:63], v[36:39]
    s_waitcnt lgkmcnt(2)
    s_mov_b32 s75, 1089536
    buffer_store_dwordx4 v[92:95], v6, s[60:63], s75 offen sc1
    v_mfma_f32_16x16x32_bf16 v[36:39], a[100:103], v[64:67], v[36:39]
    ds_read_b128 v[56:59], v96 offset:32768
    ds_read_b128 v[60:63], v97 offset:32768
    v_mfma_f32_16x16x32_bf16 v[32:35], a[96:99], v[64:67], v[32:35]
    v_or_b32 v16, 11, v17
    v_exp_f32 v80, -v24
    v_mfma_f32_16x16x32_bf16 v[32:35], a[104:107], v[68:71], v[32:35]
    v_exp_f32 v81, -v25
    v_mfma_f32_16x16x32_bf16 v[36:39], a[108:111], v[68:71], v[36:39]
    s_waitcnt lgkmcnt(2)
    v_exp_f32 v82, -v26
    v_mfma_f32_16x16x32_bf16 v[36:39], a[116:119], v[72:75], v[36:39]
    ds_read_b128 v[64:67], v98 offset:32768
    ds_read_b128 v[68:71], v99 offset:32768
    v_add_f32 v80, 1.0, v80
    v_mfma_f32_16x16x32_bf16 v[32:35], a[112:115], v[72:75], v[32:35]
    v_rcp_f32 v80, v80
    v_mfma_f32_16x16x32_bf16 v[32:35], a[120:123], v[76:79], v[32:35]
    v_exp_f32 v83, -v27
    v_mul_f32 v80, v80, v24
    v_mfma_f32_16x16x32_bf16 v[36:39], a[124:127], v[76:79], v[36:39]
    s_waitcnt lgkmcnt(2)
    v_exp_f32 v84, -v28
    v_mfma_f32_16x16x32_bf16 v[44:47], a[4:7], v[56:59], 0
    ds_read_b128 v[72:75], v96 offset:40960
    ds_read_b128 v[76:79], v97 offset:40960
    v_mfma_f32_16x16x32_bf16 v[40:43], a[0:3], v[56:59], 0
    v_exp_f32 v85, -v29
    v_add_f32 v81, 1.0, v81
    v_mfma_f32_16x16x32_bf16 v[40:43], a[8:11], v[60:63], v[40:43]
    v_rcp_f32 v81, v81
    v_mfma_f32_16x16x32_bf16 v[44:47], a[12:15], v[60:63], v[44:47]
    s_waitcnt lgkmcnt(2)
    v_exp_f32 v86, -v30
    v_mfma_f32_16x16x32_bf16 v[44:47], a[20:23], v[64:67], v[44:47]
    ds_read_b128 v[56:59], v98 offset:40960
    ds_read_b128 v[60:63], v99 offset:40960
    v_mul_f32 v81, v81, v25
    v_mfma_f32_16x16x32_bf16 v[40:43], a[16:19], v[64:67], v[40:43]
    v_exp_f32 v87, -v31
    v_mfma_f32_16x16x32_bf16 v[40:43], a[24:27], v[68:71], v[40:43]
    v_cvt_pk_bf16_f32 v88, v80, v81
    v_add_f32 v82, 1.0, v82
    v_add_f32 v83, 1.0, v83
    v_mfma_f32_16x16x32_bf16 v[44:47], a[28:31], v[68:71], v[44:47]
    s_waitcnt lgkmcnt(2)
    v_rcp_f32 v82, v82
    v_mfma_f32_16x16x32_bf16 v[44:47], a[36:39], v[72:75], v[44:47]
    ds_read_b128 v[64:67], v96 offset:49152
    ds_read_b128 v[68:71], v97 offset:49152
    v_mfma_f32_16x16x32_bf16 v[40:43], a[32:35], v[72:75], v[40:43]
    v_rcp_f32 v83, v83
    v_mul_f32 v82, v82, v26
    v_mfma_f32_16x16x32_bf16 v[40:43], a[40:43], v[76:79], v[40:43]
    v_mul_f32 v83, v83, v27
    v_add_f32 v84, 1.0, v84
    v_mfma_f32_16x16x32_bf16 v[44:47], a[44:47], v[76:79], v[44:47]
    s_waitcnt lgkmcnt(2)
    v_rcp_f32 v84, v84
    v_mfma_f32_16x16x32_bf16 v[44:47], a[52:55], v[56:59], v[44:47]
    ds_read_b128 v[72:75], v98 offset:49152
    ds_read_b128 v[76:79], v99 offset:49152
    v_cvt_pk_bf16_f32 v89, v82, v83
    v_mfma_f32_16x16x32_bf16 v[40:43], a[48:51], v[56:59], v[40:43]
    v_mul_f32 v84, v84, v28
    v_add_f32 v85, 1.0, v85
    v_mfma_f32_16x16x32_bf16 v[40:43], a[56:59], v[60:63], v[40:43]
    v_rcp_f32 v85, v85
    v_add_f32 v86, 1.0, v86
    v_mfma_f32_16x16x32_bf16 v[44:47], a[60:63], v[60:63], v[44:47]
    s_waitcnt lgkmcnt(2)
    s_add_u32 s70, s69, 10
    buffer_load_dword v2, v4, s[60:63], 0 offen sc1
    v_mfma_f32_16x16x32_bf16 v[44:47], a[68:71], v[64:67], v[44:47]
    ds_read_b128 v[56:59], v96 offset:57344
    ds_read_b128 v[60:63], v97 offset:57344
    v_mfma_f32_16x16x32_bf16 v[40:43], a[64:67], v[64:67], v[40:43]
    v_rcp_f32 v86, v86
    v_mul_f32 v85, v85, v29
    v_mfma_f32_16x16x32_bf16 v[40:43], a[72:75], v[68:71], v[40:43]
    v_cvt_pk_bf16_f32 v90, v84, v85
    v_mul_f32 v86, v86, v30
    v_mfma_f32_16x16x32_bf16 v[44:47], a[76:79], v[68:71], v[44:47]
    s_waitcnt lgkmcnt(2)
    v_add_f32 v87, 1.0, v87
    v_mfma_f32_16x16x32_bf16 v[44:47], a[84:87], v[72:75], v[44:47]
    ds_read_b128 v[64:67], v98 offset:57344
    ds_read_b128 v[68:71], v99 offset:57344
    v_mfma_f32_16x16x32_bf16 v[40:43], a[80:83], v[72:75], v[40:43]
    v_rcp_f32 v87, v87
    v_mfma_f32_16x16x32_bf16 v[40:43], a[88:91], v[76:79], v[40:43]
    v_mul_f32 v87, v87, v31
    v_mfma_f32_16x16x32_bf16 v[44:47], a[92:95], v[76:79], v[44:47]
    s_waitcnt lgkmcnt(2)
    v_cvt_pk_bf16_f32 v91, v86, v87
    v_mfma_f32_16x16x32_bf16 v[44:47], a[100:103], v[56:59], v[44:47]
    ds_read_b128 v[72:75], v96 offset:36864
    ds_read_b128 v[76:79], v97 offset:36864
    v_mfma_f32_16x16x32_bf16 v[40:43], a[96:99], v[56:59], v[40:43]
    s_mov_b32 s75, 1146880
    buffer_store_dwordx4 v[88:91], v6, s[60:63], s75 offen sc1
    v_mfma_f32_16x16x32_bf16 v[40:43], a[104:107], v[60:63], v[40:43]
    v_exp_f32 v80, -v32
    v_mfma_f32_16x16x32_bf16 v[44:47], a[108:111], v[60:63], v[44:47]
    s_waitcnt lgkmcnt(2)
    v_exp_f32 v81, -v33
    v_add_f32 v80, 1.0, v80
    v_mfma_f32_16x16x32_bf16 v[44:47], a[116:119], v[64:67], v[44:47]
    ds_read_b128 v[56:59], v98 offset:36864
    ds_read_b128 v[60:63], v99 offset:36864
    v_add_f32 v81, 1.0, v81
    v_mfma_f32_16x16x32_bf16 v[40:43], a[112:115], v[64:67], v[40:43]
    v_rcp_f32 v80, v80
    v_mfma_f32_16x16x32_bf16 v[40:43], a[120:123], v[68:71], v[40:43]
    v_rcp_f32 v81, v81
    v_mul_f32 v80, v80, v32
    v_mfma_f32_16x16x32_bf16 v[44:47], a[124:127], v[68:71], v[44:47]
    s_waitcnt lgkmcnt(2)
    v_exp_f32 v82, -v34
    v_mul_f32 v81, v81, v33
    v_mfma_f32_16x16x32_bf16 v[52:55], a[4:7], v[72:75], 0
    ds_read_b128 v[64:67], v96 offset:45056
    ds_read_b128 v[68:71], v97 offset:45056
    v_exp_f32 v83, -v35
    v_mfma_f32_16x16x32_bf16 v[48:51], a[0:3], v[72:75], 0
    s_waitcnt vmcnt(1)
    v_subrev_u32 v2, s70, v2
    v_cmp_le_u32 vcc, 16, v2
    v_cvt_pk_bf16_f32 v92, v80, v81
    v_mfma_f32_16x16x32_bf16 v[48:51], a[8:11], v[76:79], v[48:51]
    s_cbranch_vccnz L_slow_57
L_back_58:
    v_mfma_f32_16x16x32_bf16 v[52:55], a[12:15], v[76:79], v[52:55]
    s_waitcnt lgkmcnt(2)
    buffer_load_dwordx4 v[100:103], v13, s[60:63], s28 offen sc1
    v_add_f32 v82, 1.0, v82
    v_mfma_f32_16x16x32_bf16 v[52:55], a[20:23], v[56:59], v[52:55]
    ds_read_b128 v[72:75], v98 offset:45056
    ds_read_b128 v[76:79], v99 offset:45056
    v_add_f32 v83, 1.0, v83
    v_mfma_f32_16x16x32_bf16 v[48:51], a[16:19], v[56:59], v[48:51]
    buffer_store_dword v16, v3, s[60:63], 0 offen
    v_mfma_f32_16x16x32_bf16 v[48:51], a[24:27], v[60:63], v[48:51]
    v_rcp_f32 v82, v82
    v_mfma_f32_16x16x32_bf16 v[52:55], a[28:31], v[60:63], v[52:55]
    s_waitcnt lgkmcnt(2)
    buffer_load_dwordx4 v[104:107], v13, s[60:63], s29 offen sc1
    v_mul_f32 v82, v82, v34
    v_mfma_f32_16x16x32_bf16 v[52:55], a[36:39], v[64:67], v[52:55]
    ds_read_b128 v[56:59], v96 offset:53248
    ds_read_b128 v[60:63], v97 offset:53248
    v_rcp_f32 v83, v83
    v_mfma_f32_16x16x32_bf16 v[48:51], a[32:35], v[64:67], v[48:51]
    v_exp_f32 v84, -v36
    v_mul_f32 v83, v83, v35
    v_mfma_f32_16x16x32_bf16 v[48:51], a[40:43], v[68:71], v[48:51]
    v_exp_f32 v85, -v37
    v_cvt_pk_bf16_f32 v93, v82, v83
    v_mfma_f32_16x16x32_bf16 v[52:55], a[44:47], v[68:71], v[52:55]
    s_waitcnt lgkmcnt(2)
    buffer_load_dwordx4 v[108:111], v13, s[60:63], s30 offen sc1
    v_add_f32 v84, 1.0, v84
    v_mfma_f32_16x16x32_bf16 v[52:55], a[52:55], v[72:75], v[52:55]
    ds_read_b128 v[64:67], v98 offset:53248
    ds_read_b128 v[68:71], v99 offset:53248
    v_add_f32 v85, 1.0, v85
    v_mfma_f32_16x16x32_bf16 v[48:51], a[48:51], v[72:75], v[48:51]
    v_rcp_f32 v84, v84
    v_mfma_f32_16x16x32_bf16 v[48:51], a[56:59], v[76:79], v[48:51]
    v_rcp_f32 v85, v85
    v_mul_f32 v84, v84, v36
    v_mfma_f32_16x16x32_bf16 v[52:55], a[60:63], v[76:79], v[52:55]
    s_waitcnt lgkmcnt(2)
    buffer_load_dwordx4 v[112:115], v13, s[60:63], s31 offen sc1
    v_mul_f32 v85, v85, v37
    v_mfma_f32_16x16x32_bf16 v[52:55], a[68:71], v[56:59], v[52:55]
    ds_read_b128 v[72:75], v96 offset:61440
    ds_read_b128 v[76:79], v97 offset:61440
    v_exp_f32 v86, -v38
    v_mfma_f32_16x16x32_bf16 v[48:51], a[64:67], v[56:59], v[48:51]
    v_xor_b32 v96, 0x10000, v96
    v_xor_b32 v97, 0x10000, v97
    v_cvt_pk_bf16_f32 v94, v84, v85
    v_mfma_f32_16x16x32_bf16 v[48:51], a[72:75], v[60:63], v[48:51]
    v_exp_f32 v87, -v39
    v_add_f32 v86, 1.0, v86
    v_mfma_f32_16x16x32_bf16 v[52:55], a[76:79], v[60:63], v[52:55]
    s_waitcnt lgkmcnt(2)
    buffer_load_dwordx4 v[116:119], v13, s[60:63], s32 offen sc1
    v_add_f32 v87, 1.0, v87
    v_mfma_f32_16x16x32_bf16 v[52:55], a[84:87], v[64:67], v[52:55]
    ds_read_b128 v[56:59], v98 offset:61440
    ds_read_b128 v[60:63], v99 offset:61440
    v_mfma_f32_16x16x32_bf16 v[48:51], a[80:83], v[64:67], v[48:51]
    v_xor_b32 v98, 0x10000, v98
    v_xor_b32 v99, 0x10000, v99
    v_mfma_f32_16x16x32_bf16 v[48:51], a[88:91], v[68:71], v[48:51]
    v_rcp_f32 v86, v86
    v_mfma_f32_16x16x32_bf16 v[52:55], a[92:95], v[68:71], v[52:55]
    s_waitcnt lgkmcnt(2)
    buffer_load_dwordx4 v[120:123], v13, s[60:63], s33 offen sc1
    v_mul_f32 v86, v86, v38
    v_mfma_f32_16x16x32_bf16 v[52:55], a[100:103], v[72:75], v[52:55]
    v_rcp_f32 v87, v87
    v_mfma_f32_16x16x32_bf16 v[48:51], a[96:99], v[72:75], v[48:51]
    v_mul_f32 v87, v87, v39
    v_mfma_f32_16x16x32_bf16 v[48:51], a[104:107], v[76:79], v[48:51]
    v_cvt_pk_bf16_f32 v95, v86, v87
    v_mfma_f32_16x16x32_bf16 v[52:55], a[108:111], v[76:79], v[52:55]
    s_waitcnt lgkmcnt(0)
    buffer_load_dwordx4 v[124:127], v13, s[60:63], s34 offen sc1
    v_mfma_f32_16x16x32_bf16 v[52:55], a[116:119], v[56:59], v[52:55]
    s_mov_b32 s75, 1204224
    buffer_store_dwordx4 v[92:95], v6, s[60:63], s75 offen sc1
    v_mfma_f32_16x16x32_bf16 v[48:51], a[112:115], v[56:59], v[48:51]
    v_or_b32 v16, 12, v17
    v_mfma_f32_16x16x32_bf16 v[48:51], a[120:123], v[60:63], v[48:51]
    v_exp_f32 v80, -v40
    v_mfma_f32_16x16x32_bf16 v[52:55], a[124:127], v[60:63], v[52:55]
    buffer_load_dwordx4 v[128:131], v13, s[60:63], s35 offen sc1
    v_exp_f32 v81, -v41
    v_exp_f32 v82, -v42
    v_exp_f32 v83, -v43
    v_add_f32 v80, 1.0, v80
    v_add_f32 v81, 1.0, v81
    v_rcp_f32 v80, v80
    v_rcp_f32 v81, v81
    v_exp_f32 v84, -v44
    v_mul_f32 v80, v80, v40
    v_mul_f32 v81, v81, v41
    buffer_load_dwordx4 v[132:135], v13, s[60:63], s36 offen sc1
    v_exp_f32 v85, -v45
    v_cvt_pk_bf16_f32 v88, v80, v81
    v_add_f32 v82, 1.0, v82
    v_add_f32 v83, 1.0, v83
    v_add_f32 v84, 1.0, v84
    v_rcp_f32 v82, v82
    v_rcp_f32 v83, v83
    v_rcp_f32 v84, v84
    v_mul_f32 v82, v82, v42
    v_mul_f32 v83, v83, v43
    s_add_u32 s70, s69, 11
    buffer_load_dwordx4 v[136:139], v13, s[60:63], s37 offen sc1
    buffer_load_dword v2, v4, s[60:63], 0 offen sc1
    v_exp_f32 v86, -v46
    v_cvt_pk_bf16_f32 v89, v82, v83
    v_mul_f32 v84, v84, v44
    v_exp_f32 v87, -v47
    v_add_f32 v85, 1.0, v85
    v_add_f32 v86, 1.0, v86
    v_add_f32 v87, 1.0, v87
    v_rcp_f32 v85, v85
    v_rcp_f32 v86, v86
    v_rcp_f32 v87, v87
    v_mul_f32 v85, v85, v45
    v_mul_f32 v86, v86, v46
    v_mul_f32 v87, v87, v47
    v_cvt_pk_bf16_f32 v90, v84, v85
    v_cvt_pk_bf16_f32 v91, v86, v87
    s_mov_b32 s75, 1261568
    buffer_store_dwordx4 v[88:91], v6, s[60:63], s75 offen sc1
    v_exp_f32 v80, -v48
    v_exp_f32 v81, -v49
    v_exp_f32 v82, -v50
    v_exp_f32 v83, -v51
    v_exp_f32 v84, -v52
    v_exp_f32 v85, -v53
    v_add_f32 v80, 1.0, v80
    v_add_f32 v81, 1.0, v81
    v_add_f32 v82, 1.0, v82
    v_add_f32 v83, 1.0, v83
    s_waitcnt vmcnt(13)
    v_rcp_f32 v80, v80
    v_rcp_f32 v81, v81
    v_rcp_f32 v82, v82
    v_mul_f32 v80, v80, v48
    v_mul_f32 v81, v81, v49
L_g2_51:
    v_mfma_f32_16x16x32_bf16 v[76:79], a[140:143], v[100:103], 0
    v_rcp_f32 v83, v83
    v_mfma_f32_16x16x32_bf16 v[72:75], a[136:139], v[100:103], 0
    v_exp_f32 v86, -v54
    v_mfma_f32_16x16x32_bf16 v[68:71], a[132:135], v[100:103], 0
    v_exp_f32 v87, -v55
    v_mfma_f32_16x16x32_bf16 v[64:67], a[128:131], v[100:103], 0
    s_waitcnt vmcnt(11)
    buffer_load_dwordx4 v[100:103], v13, s[60:63], s38 offen sc1
    v_mfma_f32_16x16x32_bf16 v[64:67], a[144:147], v[104:107], v[64:67]
    v_cvt_pk_bf16_f32 v92, v80, v81
    v_mul_f32 v82, v82, v50
    v_mfma_f32_16x16x32_bf16 v[68:71], a[148:151], v[104:107], v[68:71]
    v_mul_f32 v83, v83, v51
    v_add_f32 v84, 1.0, v84
    v_mfma_f32_16x16x32_bf16 v[72:75], a[152:155], v[104:107], v[72:75]
    v_rcp_f32 v84, v84
    v_mfma_f32_16x16x32_bf16 v[76:79], a[156:159], v[104:107], v[76:79]
    s_waitcnt vmcnt(11)
    buffer_load_dwordx4 v[104:107], v13, s[60:63], s39 offen sc1
    v_mfma_f32_16x16x32_bf16 v[76:79], a[172:175], v[108:111], v[76:79]
    v_cvt_pk_bf16_f32 v93, v82, v83
    v_mul_f32 v84, v84, v52
    v_mfma_f32_16x16x32_bf16 v[72:75], a[168:171], v[108:111], v[72:75]
    v_add_f32 v85, 1.0, v85
    v_add_f32 v86, 1.0, v86
    v_mfma_f32_16x16x32_bf16 v[68:71], a[164:167], v[108:111], v[68:71]
    v_rcp_f32 v85, v85
    v_mfma_f32_16x16x32_bf16 v[64:67], a[160:163], v[108:111], v[64:67]
    s_waitcnt vmcnt(11)
    buffer_load_dwordx4 v[108:111], v13, s[60:63], s40 offen sc1
    v_mfma_f32_16x16x32_bf16 v[64:67], a[176:179], v[112:115], v[64:67]
    v_rcp_f32 v86, v86
    v_mfma_f32_16x16x32_bf16 v[68:71], a[180:183], v[112:115], v[68:71]
    v_mul_f32 v85, v85, v53
    v_mul_f32 v86, v86, v54
    v_mfma_f32_16x16x32_bf16 v[72:75], a[184:187], v[112:115], v[72:75]
    v_cvt_pk_bf16_f32 v94, v84, v85
    v_add_f32 v87, 1.0, v87
    v_mfma_f32_16x16x32_bf16 v[76:79], a[188:191], v[112:115], v[76:79]
    s_waitcnt vmcnt(11)
    buffer_load_dwordx4 v[112:115], v13, s[60:63], s41 offen sc1
    v_add_u32 v13, 114688, v13
    v_mfma_f32_16x16x32_bf16 v[76:79], a[204:207], v[116:119], v[76:79]
    s_waitcnt vmcnt(9)
    buffer_store_dword v16, v3, s[60:63], 0 offen
    v_mfma_f32_16x16x32_bf16 v[72:75], a[200:203], v[116:119], v[72:75]
    v_rcp_f32 v87, v87
    v_mfma_f32_16x16x32_bf16 v[68:71], a[196:199], v[116:119], v[68:71]
    v_mul_f32 v87, v87, v55
    v_mfma_f32_16x16x32_bf16 v[64:67], a[192:195], v[116:119], v[64:67]
    v_cvt_pk_bf16_f32 v95, v86, v87
    v_mfma_f32_16x16x32_bf16 v[64:67], a[208:211], v[120:123], v[64:67]
    s_waitcnt vmcnt(6)
    v_subrev_u32 v2, s70, v2
    v_cmp_le_u32 vcc, 16, v2
    v_mfma_f32_16x16x32_bf16 v[68:71], a[212:215], v[120:123], v[68:71]
    s_cbranch_vccnz L_slow_65
L_back_66:
    v_mfma_f32_16x16x32_bf16 v[72:75], a[216:219], v[120:123], v[72:75]
    buffer_load_dwordx4 v[116:119], v13, s[60:63], s28 offen sc1
    v_mfma_f32_16x16x32_bf16 v[76:79], a[220:223], v[120:123], v[76:79]
    s_mov_b32 s75, 1318912
    buffer_store_dwordx4 v[92:95], v6, s[60:63], s75 offen sc1
    v_mfma_f32_16x16x32_bf16 v[76:79], a[236:239], v[124:127], v[76:79]
    v_or_b32 v16, 13, v17
    v_mfma_f32_16x16x32_bf16 v[72:75], a[232:235], v[124:127], v[72:75]
    v_mfma_f32_16x16x32_bf16 v[68:71], a[228:231], v[124:127], v[68:71]
    buffer_load_dwordx4 v[120:123], v13, s[60:63], s29 offen sc1
    v_mfma_f32_16x16x32_bf16 v[64:67], a[224:227], v[124:127], v[64:67]
    v_mfma_f32_16x16x32_bf16 v[64:67], a[240:243], v[128:131], v[64:67]
    v_mfma_f32_16x16x32_bf16 v[68:71], a[244:247], v[128:131], v[68:71]
    v_mfma_f32_16x16x32_bf16 v[72:75], a[248:251], v[128:131], v[72:75]
    buffer_load_dwordx4 v[124:127], v13, s[60:63], s30 offen sc1
    v_mfma_f32_16x16x32_bf16 v[76:79], a[252:255], v[128:131], v[76:79]
    v_mfma_f32_16x16x32_bf16 v[76:79], v[172:175], v[132:135], v[76:79]
    v_mfma_f32_16x16x32_bf16 v[72:75], v[168:171], v[132:135], v[72:75]
    v_mfma_f32_16x16x32_bf16 v[68:71], v[164:167], v[132:135], v[68:71]
    buffer_load_dwordx4 v[128:131], v13, s[60:63], s31 offen sc1
    v_mfma_f32_16x16x32_bf16 v[64:67], v[160:163], v[132:135], v[64:67]
    v_mfma_f32_16x16x32_bf16 v[64:67], v[176:179], v[136:139], v[64:67]
    v_mfma_f32_16x16x32_bf16 v[68:71], v[180:183], v[136:139], v[68:71]
    v_mfma_f32_16x16x32_bf16 v[72:75], v[184:187], v[136:139], v[72:75]
    buffer_load_dwordx4 v[132:135], v13, s[60:63], s32 offen sc1
    v_mfma_f32_16x16x32_bf16 v[76:79], v[188:191], v[136:139], v[76:79]
    s_waitcnt vmcnt(10)
    s_add_u32 s70, s69, 12
    buffer_load_dword v2, v4, s[60:63], 0 offen sc1
    v_mfma_f32_16x16x32_bf16 v[76:79], v[204:207], v[100:103], v[76:79]
    v_mfma_f32_16x16x32_bf16 v[72:75], v[200:203], v[100:103], v[72:75]
    v_mfma_f32_16x16x32_bf16 v[68:71], v[196:199], v[100:103], v[68:71]
    buffer_load_dwordx4 v[136:139], v13, s[60:63], s33 offen sc1
    v_mfma_f32_16x16x32_bf16 v[64:67], v[192:195], v[100:103], v[64:67]
    s_waitcnt vmcnt(11)
    v_mfma_f32_16x16x32_bf16 v[64:67], v[208:211], v[104:107], v[64:67]
    v_rcp_f32 v22, v146
    v_mfma_f32_16x16x32_bf16 v[68:71], v[212:215], v[104:107], v[68:71]
    v_lshlrev_b32 v146, 16, v145
    v_mul_f32 v23, -v147, v22
    v_mfma_f32_16x16x32_bf16 v[72:75], v[216:219], v[104:107], v[72:75]
    buffer_load_dwordx4 v[100:103], v13, s[60:63], s34 offen sc1
    v_mfma_f32_16x16x32_bf16 v[76:79], v[220:223], v[104:107], v[76:79]
    s_waitcnt vmcnt(11)
    v_and_b32 v147, 0xffff0000, v145
    v_and_b32 v145, 0xffff0000, v144
    v_mfma_f32_16x16x32_bf16 v[76:79], v[236:239], v[108:111], v[76:79]
    v_lshlrev_b32 v144, 16, v144
    v_fma_f32 v146, v146, v22, v23
    v_mfma_f32_16x16x32_bf16 v[72:75], v[232:235], v[108:111], v[72:75]
    v_fma_f32 v147, v147, v22, v23
    v_fma_f32 v145, v145, v22, v23
    v_mfma_f32_16x16x32_bf16 v[68:71], v[228:231], v[108:111], v[68:71]
    buffer_load_dwordx4 v[104:107], v13, s[60:63], s35 offen sc1
    v_mfma_f32_16x16x32_bf16 v[64:67], v[224:227], v[108:111], v[64:67]
    s_waitcnt vmcnt(11)
    v_fma_f32 v144, v144, v22, v23
    v_mfma_f32_16x16x32_bf16 v[64:67], v[240:243], v[112:115], v[64:67]
    v_mfma_f32_16x16x32_bf16 v[68:71], v[244:247], v[112:115], v[68:71]
    v_mfma_f32_16x16x32_bf16 v[72:75], v[248:251], v[112:115], v[72:75]
    buffer_load_dwordx4 v[108:111], v13, s[60:63], s36 offen sc1
    v_mfma_f32_16x16x32_bf16 v[76:79], v[252:255], v[112:115], v[76:79]
    s_waitcnt vmcnt(10)
    v_mfma_f32_16x16x32_bf16 v[36:39], a[140:143], v[116:119], 0
    v_mfma_f32_16x16x32_bf16 v[32:35], a[136:139], v[116:119], 0
    v_mfma_f32_16x16x32_bf16 v[28:31], a[132:135], v[116:119], 0
    buffer_load_dwordx4 v[112:115], v13, s[60:63], s37 offen sc1
    v_mfma_f32_16x16x32_bf16 v[24:27], a[128:131], v[116:119], 0
    s_waitcnt vmcnt(9)
    v_mfma_f32_16x16x32_bf16 v[24:27], a[144:147], v[120:123], v[24:27]
    v_mfma_f32_16x16x32_bf16 v[28:31], a[148:151], v[120:123], v[28:31]
    v_mfma_f32_16x16x32_bf16 v[32:35], a[152:155], v[120:123], v[32:35]
    buffer_load_dwordx4 v[116:119], v13, s[60:63], s38 offen sc1
    v_mfma_f32_16x16x32_bf16 v[36:39], a[156:159], v[120:123], v[36:39]
    s_waitcnt vmcnt(9)
    ds_write_b128 v11, v[64:67] offset:0
    v_mfma_f32_16x16x32_bf16 v[36:39], a[172:175], v[124:127], v[36:39]
    v_mfma_f32_16x16x32_bf16 v[32:35], a[168:171], v[124:127], v[32:35]
    v_mfma_f32_16x16x32_bf16 v[28:31], a[164:167], v[124:127], v[28:31]
    buffer_load_dwordx4 v[120:123], v13, s[60:63], s39 offen sc1
    v_mfma_f32_16x16x32_bf16 v[24:27], a[160:163], v[124:127], v[24:27]
    s_waitcnt vmcnt(9)
    buffer_store_dword v16, v3, s[60:63], 0 offen
    v_mfma_f32_16x16x32_bf16 v[24:27], a[176:179], v[128:131], v[24:27]
    ds_write_b128 v14, v[68:71] offset:0
    v_mfma_f32_16x16x32_bf16 v[28:31], a[180:183], v[128:131], v[28:31]
    v_mfma_f32_16x16x32_bf16 v[32:35], a[184:187], v[128:131], v[32:35]
    buffer_load_dwordx4 v[124:127], v13, s[60:63], s40 offen sc1
    v_mfma_f32_16x16x32_bf16 v[36:39], a[188:191], v[128:131], v[36:39]
    s_waitcnt vmcnt(10)
    ds_write_b128 v11, v[72:75] offset:128
    v_mfma_f32_16x16x32_bf16 v[36:39], a[204:207], v[132:135], v[36:39]
    v_mfma_f32_16x16x32_bf16 v[32:35], a[200:203], v[132:135], v[32:35]
    v_mfma_f32_16x16x32_bf16 v[28:31], a[196:199], v[132:135], v[28:31]
    buffer_load_dwordx4 v[128:131], v13, s[60:63], s41 offen sc1
    v_add_u32 v13, 114688, v13
    v_mfma_f32_16x16x32_bf16 v[24:27], a[192:195], v[132:135], v[24:27]
    s_waitcnt vmcnt(9)
    ds_write_b128 v14, v[76:79] offset:128
    v_mfma_f32_16x16x32_bf16 v[24:27], a[208:211], v[136:139], v[24:27]
    v_subrev_u32 v2, s70, v2
    v_cmp_le_u32 vcc, 16, v2
    v_mfma_f32_16x16x32_bf16 v[28:31], a[212:215], v[136:139], v[28:31]
    s_cbranch_vccnz L_slow_70
L_back_71:
    v_mfma_f32_16x16x32_bf16 v[32:35], a[216:219], v[136:139], v[32:35]
    buffer_load_dwordx4 v[132:135], v13, s[60:63], s28 offen sc1
    v_mfma_f32_16x16x32_bf16 v[36:39], a[220:223], v[136:139], v[36:39]
    s_waitcnt vmcnt(9)
    v_mfma_f32_16x16x32_bf16 v[36:39], a[236:239], v[100:103], v[36:39]
    s_waitcnt lgkmcnt(0)
    s_barrier
    v_mfma_f32_16x16x32_bf16 v[32:35], a[232:235], v[100:103], v[32:35]
    ds_read_b128 v[64:67], v12 offset:0
    ds_read_b128 v[68:71], v12 offset:4096
    v_mfma_f32_16x16x32_bf16 v[28:31], a[228:231], v[100:103], v[28:31]
    buffer_load_dwordx4 v[136:139], v13, s[60:63], s29 offen sc1
    v_mfma_f32_16x16x32_bf16 v[24:27], a[224:227], v[100:103], v[24:27]
    s_waitcnt vmcnt(9)
    ds_read_b128 v[72:75], v12 offset:8192
    ds_read_b128 v[76:79], v12 offset:12288
    v_mfma_f32_16x16x32_bf16 v[24:27], a[240:243], v[104:107], v[24:27]
    v_mfma_f32_16x16x32_bf16 v[28:31], a[244:247], v[104:107], v[28:31]
    v_mfma_f32_16x16x32_bf16 v[32:35], a[248:251], v[104:107], v[32:35]
    buffer_load_dwordx4 v[100:103], v13, s[60:63], s30 offen sc1
    v_mfma_f32_16x16x32_bf16 v[36:39], a[252:255], v[104:107], v[36:39]
    s_waitcnt vmcnt(9)
    v_mfma_f32_16x16x32_bf16 v[36:39], v[172:175], v[108:111], v[36:39]
    v_mfma_f32_16x16x32_bf16 v[32:35], v[168:171], v[108:111], v[32:35]
    s_waitcnt lgkmcnt(0)
    v_add_f32 v64, v64, v68
    v_add_f32 v65, v65, v69
    v_mfma_f32_16x16x32_bf16 v[28:31], v[164:167], v[108:111], v[28:31]
    buffer_load_dwordx4 v[104:107], v13, s[60:63], s31 offen sc1
    v_mfma_f32_16x16x32_bf16 v[24:27], v[160:163], v[108:111], v[24:27]
    s_waitcnt vmcnt(9)
    v_add_f32 v66, v66, v70
    v_add_f32 v67, v67, v71
    v_mfma_f32_16x16x32_bf16 v[24:27], v[176:179], v[112:115], v[24:27]
    v_add_f32 v64, v64, v72
    v_add_f32 v65, v65, v73
    v_mfma_f32_16x16x32_bf16 v[28:31], v[180:183], v[112:115], v[28:31]
    v_add_f32 v66, v66, v74
    v_add_f32 v67, v67, v75
    v_mfma_f32_16x16x32_bf16 v[32:35], v[184:187], v[112:115], v[32:35]
    buffer_load_dwordx4 v[108:111], v13, s[60:63], s32 offen sc1
    v_mfma_f32_16x16x32_bf16 v[36:39], v[188:191], v[112:115], v[36:39]
    s_waitcnt vmcnt(9)
    s_add_u32 s70, s69, 13
    buffer_load_dword v2, v4, s[60:63], 0 offen sc1
    v_mfma_f32_16x16x32_bf16 v[36:39], v[204:207], v[116:119], v[36:39]
    v_add_f32 v64, v64, v76
    v_add_f32 v65, v65, v77
    v_mfma_f32_16x16x32_bf16 v[32:35], v[200:203], v[116:119], v[32:35]
    v_add_f32 v66, v66, v78
    v_add_f32 v67, v67, v79
    v_mfma_f32_16x16x32_bf16 v[28:31], v[196:199], v[116:119], v[28:31]
    buffer_load_dwordx4 v[112:115], v13, s[60:63], s33 offen sc1
    v_mfma_f32_16x16x32_bf16 v[24:27], v[192:195], v[116:119], v[24:27]
    s_waitcnt vmcnt(10)
    v_fma_f32 v64, v64, s42, v144
    v_fma_f32 v65, v65, s42, v145
    v_mfma_f32_16x16x32_bf16 v[24:27], v[208:211], v[120:123], v[24:27]
    v_rcp_f32 v22, v150
    v_mfma_f32_16x16x32_bf16 v[28:31], v[212:215], v[120:123], v[28:31]
    v_lshlrev_b32 v150, 16, v149
    v_mul_f32 v23, -v151, v22
    v_mfma_f32_16x16x32_bf16 v[32:35], v[216:219], v[120:123], v[32:35]
    buffer_load_dwordx4 v[116:119], v13, s[60:63], s34 offen sc1
L_hop_8:
    s_cbranch_execz L_hop_back1
    v_mfma_f32_16x16x32_bf16 v[36:39], v[220:223], v[120:123], v[36:39]
    s_waitcnt vmcnt(9)
    v_and_b32 v151, 0xffff0000, v149
    v_and_b32 v149, 0xffff0000, v148
    v_mfma_f32_16x16x32_bf16 v[36:39], v[236:239], v[124:127], v[36:39]
    v_lshlrev_b32 v148, 16, v148
    v_fma_f32 v150, v150, v22, v23
    v_mfma_f32_16x16x32_bf16 v[32:35], v[232:235], v[124:127], v[32:35]
    v_fma_f32 v151, v151, v22, v23
    v_fma_f32 v149, v149, v22, v23
    v_mfma_f32_16x16x32_bf16 v[28:31], v[228:231], v[124:127], v[28:31]
    buffer_load_dwordx4 v[120:123], v13, s[60:63], s35 offen sc1
    v_mfma_f32_16x16x32_bf16 v[24:27], v[224:227], v[124:127], v[24:27]
    s_waitcnt vmcnt(9)
    v_fma_f32 v148, v148, v22, v23
    v_fma_f32 v66, v66, s42, v146
    v_mfma_f32_16x16x32_bf16 v[24:27], v[240:243], v[128:131], v[24:27]
    v_fma_f32 v67, v67, s42, v147
    v_cvt_pk_bf16_f32 v144, v64, v65
    v_mfma_f32_16x16x32_bf16 v[28:31], v[244:247], v[128:131], v[28:31]
    v_cvt_pk_bf16_f32 v145, v66, v67
    v_mfma_f32_16x16x32_bf16 v[32:35], v[248:251], v[128:131], v[32:35]
    buffer_load_dwordx4 v[124:127], v13, s[60:63], s36 offen sc1
    v_mfma_f32_16x16x32_bf16 v[36:39], v[252:255], v[128:131], v[36:39]
    s_waitcnt vmcnt(9)
    v_mfma_f32_16x16x32_bf16 v[76:79], a[140:143], v[132:135], 0
    v_mfma_f32_16x16x32_bf16 v[72:75], a[136:139], v[132:135], 0
    v_mfma_f32_16x16x32_bf16 v[68:71], a[132:135], v[132:135], 0
    buffer_load_dwordx4 v[128:131], v13, s[60:63], s37 offen sc1
    v_mfma_f32_16x16x32_bf16 v[64:67], a[128:131], v[132:135], 0
    s_waitcnt vmcnt(9)
    v_mfma_f32_16x16x32_bf16 v[64:67], a[144:147], v[136:139], v[64:67]
    v_mfma_f32_16x16x32_bf16 v[68:71], a[148:151], v[136:139], v[68:71]
    v_mfma_f32_16x16x32_bf16 v[72:75], a[152:155], v[136:139], v[72:75]
    buffer_load_dwordx4 v[132:135], v13, s[60:63], s38 offen sc1
    v_mfma_f32_16x16x32_bf16 v[76:79], a[156:159], v[136:139], v[76:79]
    s_waitcnt vmcnt(9)
    ds_write_b128 v11, v[24:27] offset:16384
    v_mfma_f32_16x16x32_bf16 v[76:79], a[172:175], v[100:103], v[76:79]
    v_mfma_f32_16x16x32_bf16 v[72:75], a[168:171], v[100:103], v[72:75]
    v_mfma_f32_16x16x32_bf16 v[68:71], a[164:167], v[100:103], v[68:71]
    buffer_load_dwordx4 v[136:139], v13, s[60:63], s39 offen sc1
    v_mfma_f32_16x16x32_bf16 v[64:67], a[160:163], v[100:103], v[64:67]
    s_waitcnt vmcnt(9)
    ds_write_b128 v14, v[28:31] offset:16384
    v_mfma_f32_16x16x32_bf16 v[64:67], a[176:179], v[104:107], v[64:67]
    v_mfma_f32_16x16x32_bf16 v[68:71], a[180:183], v[104:107], v[68:71]
    v_mfma_f32_16x16x32_bf16 v[72:75], a[184:187], v[104:107], v[72:75]
    buffer_load_dwordx4 v[100:103], v13, s[60:63], s40 offen sc1
    v_mfma_f32_16x16x32_bf16 v[76:79], a[188:191], v[104:107], v[76:79]
    s_waitcnt vmcnt(9)
    ds_write_b128 v11, v[32:35] offset:16512
    v_mfma_f32_16x16x32_bf16 v[76:79], a[204:207], v[108:111], v[76:79]
    v_mfma_f32_16x16x32_bf16 v[72:75], a[200:203], v[108:111], v[72:75]
    v_mfma_f32_16x16x32_bf16 v[68:71], a[196:199], v[108:111], v[68:71]
    buffer_load_dwordx4 v[104:107], v13, s[60:63], s41 offen sc1
    v_add_u32 v13, 114688, v13
    v_mfma_f32_16x16x32_bf16 v[64:67], a[192:195], v[108:111], v[64:67]
    s_waitcnt vmcnt(8)
    ds_write_b128 v14, v[36:39] offset:16512
    v_mfma_f32_16x16x32_bf16 v[64:67], a[208:211], v[112:115], v[64:67]
    v_subrev_u32 v2, s70, v2
    v_cmp_le_u32 vcc, 16, v2
    v_mfma_f32_16x16x32_bf16 v[68:71], a[212:215], v[112:115], v[68:71]
    s_cbranch_vccnz L_slow_75
L_back_76:
    v_mfma_f32_16x16x32_bf16 v[72:75], a[216:219], v[112:115], v[72:75]
    buffer_load_dwordx4 v[108:111], v13, s[60:63], s28 offen sc1
    v_mfma_f32_16x16x32_bf16 v[76:79], a[220:223], v[112:115], v[76:79]
    s_waitcnt vmcnt(8)
    v_mfma_f32_16x16x32_bf16 v[76:79], a[236:239], v[116:119], v[76:79]
    s_waitcnt lgkmcnt(0)
    s_barrier
    v_mfma_f32_16x16x32_bf16 v[72:75], a[232:235], v[116:119], v[72:75]
    ds_read_b128 v[24:27], v12 offset:16384
    ds_read_b128 v[28:31], v12 offset:20480
    v_mfma_f32_16x16x32_bf16 v[68:71], a[228:231], v[116:119], v[68:71]
    buffer_load_dwordx4 v[112:115], v13, s[60:63], s29 offen sc1
    v_mfma_f32_16x16x32_bf16 v[64:67], a[224:227], v[116:119], v[64:67]
    s_waitcnt vmcnt(8)
    ds_read_b128 v[32:35], v12 offset:24576
    ds_read_b128 v[36:39], v12 offset:28672
    v_mfma_f32_16x16x32_bf16 v[64:67], a[240:243], v[120:123], v[64:67]
    v_mfma_f32_16x16x32_bf16 v[68:71], a[244:247], v[120:123], v[68:71]
    v_mfma_f32_16x16x32_bf16 v[72:75], a[248:251], v[120:123], v[72:75]
    buffer_load_dwordx4 v[116:119], v13, s[60:63], s30 offen sc1
    v_mfma_f32_16x16x32_bf16 v[76:79], a[252:255], v[120:123], v[76:79]
    s_waitcnt vmcnt(8)
    v_mfma_f32_16x16x32_bf16 v[76:79], v[172:175], v[124:127], v[76:79]
    v_mfma_f32_16x16x32_bf16 v[72:75], v[168:171], v[124:127], v[72:75]
    s_waitcnt lgkmcnt(0)
    v_add_f32 v24, v24, v28
    v_add_f32 v25, v25, v29
    v_mfma_f32_16x16x32_bf16 v[68:71], v[164:167], v[124:127], v[68:71]
    buffer_load_dwordx4 v[120:123], v13, s[60:63], s31 offen sc1
    v_mfma_f32_16x16x32_bf16 v[64:67], v[160:163], v[124:127], v[64:67]
    s_waitcnt vmcnt(8)
    v_add_f32 v26, v26, v30
    v_add_f32 v27, v27, v31
    v_mfma_f32_16x16x32_bf16 v[64:67], v[176:179], v[128:131], v[64:67]
    v_add_f32 v24, v24, v32
    v_add_f32 v25, v25, v33
    v_mfma_f32_16x16x32_bf16 v[68:71], v[180:183], v[128:131], v[68:71]
    v_add_f32 v26, v26, v34
    v_add_f32 v27, v27, v35
    v_mfma_f32_16x16x32_bf16 v[72:75], v[184:187], v[128:131], v[72:75]
    buffer_load_dwordx4 v[124:127], v13, s[60:63], s32 offen sc1
    v_mfma_f32_16x16x32_bf16 v[76:79], v[188:191], v[128:131], v[76:79]
    s_waitcnt vmcnt(8)
    v_add_f32 v24, v24, v36
    v_add_f32 v25, v25, v37
    v_mfma_f32_16x16x32_bf16 v[76:79], v[204:207], v[132:135], v[76:79]
    v_add_f32 v26, v26, v38
    v_add_f32 v27, v27, v39
    v_mfma_f32_16x16x32_bf16 v[72:75], v[200:203], v[132:135], v[72:75]
    v_fma_f32 v24, v24, s42, v148
    v_fma_f32 v25, v25, s42, v149
    v_mfma_f32_16x16x32_bf16 v[68:71], v[196:199], v[132:135], v[68:71]
    buffer_load_dwordx4 v[128:131], v13, s[60:63], s33 offen sc1
    v_mfma_f32_16x16x32_bf16 v[64:67], v[192:195], v[132:135], v[64:67]
    s_waitcnt vmcnt(8)
    v_fma_f32 v26, v26, s42, v150
    v_fma_f32 v27, v27, s42, v151
    v_mfma_f32_16x16x32_bf16 v[64:67], v[208:211], v[136:139], v[64:67]
    v_rcp_f32 v22, v154
    v_mfma_f32_16x16x32_bf16 v[68:71], v[212:215], v[136:139], v[68:71]
    v_lshlrev_b32 v154, 16, v153
    v_mul_f32 v23, -v155, v22
    v_mfma_f32_16x16x32_bf16 v[72:75], v[216:219], v[136:139], v[72:75]
    buffer_load_dwordx4 v[132:135], v13, s[60:63], s34 offen sc1
    v_mfma_f32_16x16x32_bf16 v[76:79], v[220:223], v[136:139], v[76:79]
    s_waitcnt vmcnt(8)
    v_and_b32 v155, 0xffff0000, v153
    v_and_b32 v153, 0xffff0000, v152
    v_mfma_f32_16x16x32_bf16 v[76:79], v[236:239], v[100:103], v[76:79]
    v_lshlrev_b32 v152, 16, v152
    v_fma_f32 v154, v154, v22, v23
    v_mfma_f32_16x16x32_bf16 v[72:75], v[232:235], v[100:103], v[72:75]
    v_fma_f32 v155, v155, v22, v23
    v_fma_f32 v153, v153, v22, v23
    v_mfma_f32_16x16x32_bf16 v[68:71], v[228:231], v[100:103], v[68:71]
    buffer_load_dwordx4 v[136:139], v13, s[60:63], s35 offen sc1
    v_mfma_f32_16x16x32_bf16 v[64:67], v[224:227], v[100:103], v[64:67]
    s_waitcnt vmcnt(8)
    v_fma_f32 v152, v152, v22, v23
    v_cvt_pk_bf16_f32 v148, v24, v25
    v_mfma_f32_16x16x32_bf16 v[64:67], v[240:243], v[104:107], v[64:67]
    v_cvt_pk_bf16_f32 v149, v26, v27
    v_mfma_f32_16x16x32_bf16 v[68:71], v[244:247], v[104:107], v[68:71]
    v_mfma_f32_16x16x32_bf16 v[72:75], v[248:251], v[104:107], v[72:75]
    buffer_load_dwordx4 v[100:103], v13, s[60:63], s36 offen sc1
    v_mfma_f32_16x16x32_bf16 v[76:79], v[252:255], v[104:107], v[76:79]
    s_waitcnt vmcnt(8)
    v_mfma_f32_16x16x32_bf16 v[36:39], a[140:143], v[108:111], 0
    v_mfma_f32_16x16x32_bf16 v[32:35], a[136:139], v[108:111], 0
    v_mfma_f32_16x16x32_bf16 v[28:31], a[132:135], v[108:111], 0
    buffer_load_dwordx4 v[104:107], v13, s[60:63], s37 offen sc1
    v_mfma_f32_16x16x32_bf16 v[24:27], a[128:131], v[108:111], 0
    s_waitcnt vmcnt(8)
    v_mfma_f32_16x16x32_bf16 v[24:27], a[144:147], v[112:115], v[24:27]
    v_mfma_f32_16x16x32_bf16 v[28:31], a[148:151], v[112:115], v[28:31]
    v_mfma_f32_16x16x32_bf16 v[32:35], a[152:155], v[112:115], v[32:35]
    buffer_load_dwordx4 v[108:111], v13, s[60:63], s38 offen sc1
    v_mfma_f32_16x16x32_bf16 v[36:39], a[156:159], v[112:115], v[36:39]
    s_waitcnt vmcnt(8)
    ds_write_b128 v11, v[64:67] offset:0
    v_mfma_f32_16x16x32_bf16 v[36:39], a[172:175], v[116:119], v[36:39]
    v_mfma_f32_16x16x32_bf16 v[32:35], a[168:171], v[116:119], v[32:35]
    v_mfma_f32_16x16x32_bf16 v[28:31], a[164:167], v[116:119], v[28:31]
    buffer_load_dwordx4 v[112:115], v13, s[60:63], s39 offen sc1
    v_mfma_f32_16x16x32_bf16 v[24:27], a[160:163], v[116:119], v[24:27]
    s_waitcnt vmcnt(8)
    ds_write_b128 v14, v[68:71] offset:0
    v_mfma_f32_16x16x32_bf16 v[24:27], a[176:179], v[120:123], v[24:27]
    v_mfma_f32_16x16x32_bf16 v[28:31], a[180:183], v[120:123], v[28:31]
    v_mfma_f32_16x16x32_bf16 v[32:35], a[184:187], v[120:123], v[32:35]
    buffer_load_dwordx4 v[116:119], v13, s[60:63], s40 offen sc1
    v_mfma_f32_16x16x32_bf16 v[36:39], a[188:191], v[120:123], v[36:39]
    s_waitcnt vmcnt(8)
    ds_write_b128 v11, v[72:75] offset:128
    v_mfma_f32_16x16x32_bf16 v[36:39], a[204:207], v[124:127], v[36:39]
    v_mfma_f32_16x16x32_bf16 v[32:35], a[200:203], v[124:127], v[32:35]
    v_mfma_f32_16x16x32_bf16 v[28:31], a[196:199], v[124:127], v[28:31]
    buffer_load_dwordx4 v[120:123], v13, s[60:63], s41 offen sc1
    v_add_u32 v13, 573440, v13
    v_mfma_f32_16x16x32_bf16 v[24:27], a[192:195], v[124:127], v[24:27]
    s_waitcnt vmcnt(8)
    s_mov_b32 s72, 0
    buffer_store_dwordx2 v[144:145], v5, s[56:59], s72 offen sc1
    v_mfma_f32_16x16x32_bf16 v[24:27], a[208:211], v[128:131], v[24:27]
    s_mov_b32 s72, 32768
    buffer_store_dwordx2 v[148:149], v5, s[56:59], s72 offen sc1
    v_mfma_f32_16x16x32_bf16 v[28:31], a[212:215], v[128:131], v[28:31]
    ds_write_b128 v14, v[76:79] offset:128
    v_mfma_f32_16x16x32_bf16 v[32:35], a[216:219], v[128:131], v[32:35]
    v_mfma_f32_16x16x32_bf16 v[36:39], a[220:223], v[128:131], v[36:39]
    s_waitcnt vmcnt(9)
    v_mfma_f32_16x16x32_bf16 v[36:39], a[236:239], v[132:135], v[36:39]
    v_mfma_f32_16x16x32_bf16 v[32:35], a[232:235], v[132:135], v[32:35]
    v_mfma_f32_16x16x32_bf16 v[28:31], a[228:231], v[132:135], v[28:31]
    s_waitcnt lgkmcnt(0)
    s_barrier
    v_mfma_f32_16x16x32_bf16 v[24:27], a[224:227], v[132:135], v[24:27]
    s_waitcnt vmcnt(8)
    ds_read_b128 v[64:67], v12 offset:0
    ds_read_b128 v[68:71], v12 offset:4096
    v_mfma_f32_16x16x32_bf16 v[24:27], a[240:243], v[136:139], v[24:27]
    ds_read_b128 v[72:75], v12 offset:8192
    ds_read_b128 v[76:79], v12 offset:12288
    v_mfma_f32_16x16x32_bf16 v[28:31], a[244:247], v[136:139], v[28:31]
    v_mfma_f32_16x16x32_bf16 v[32:35], a[248:251], v[136:139], v[32:35]
    v_mfma_f32_16x16x32_bf16 v[36:39], a[252:255], v[136:139], v[36:39]
    s_waitcnt vmcnt(7)
    v_mfma_f32_16x16x32_bf16 v[36:39], v[172:175], v[100:103], v[36:39]
    v_mfma_f32_16x16x32_bf16 v[32:35], v[168:171], v[100:103], v[32:35]
    v_mfma_f32_16x16x32_bf16 v[28:31], v[164:167], v[100:103], v[28:31]
    s_waitcnt lgkmcnt(0)
    v_add_f32 v64, v64, v68
    v_add_f32 v65, v65, v69
    v_mfma_f32_16x16x32_bf16 v[24:27], v[160:163], v[100:103], v[24:27]
    s_waitcnt vmcnt(6)
    v_add_f32 v66, v66, v70
    v_add_f32 v67, v67, v71
    v_mfma_f32_16x16x32_bf16 v[24:27], v[176:179], v[104:107], v[24:27]
    v_add_f32 v64, v64, v72
    v_add_f32 v65, v65, v73
    v_mfma_f32_16x16x32_bf16 v[28:31], v[180:183], v[104:107], v[28:31]
    v_add_f32 v66, v66, v74
    v_add_f32 v67, v67, v75
    v_mfma_f32_16x16x32_bf16 v[32:35], v[184:187], v[104:107], v[32:35]
    v_add_f32 v64, v64, v76
    v_add_f32 v65, v65, v77
    v_mfma_f32_16x16x32_bf16 v[36:39], v[188:191], v[104:107], v[36:39]
    s_waitcnt vmcnt(5)
    v_add_f32 v66, v66, v78
    v_add_f32 v67, v67, v79
    v_mfma_f32_16x16x32_bf16 v[36:39], v[204:207], v[108:111], v[36:39]
    v_fma_f32 v64, v64, s42, v152
    v_fma_f32 v65, v65, s42, v153
    v_mfma_f32_16x16x32_bf16 v[32:35], v[200:203], v[108:111], v[32:35]
    v_fma_f32 v66, v66, s42, v154
    v_fma_f32 v67, v67, s42, v155
    v_mfma_f32_16x16x32_bf16 v[28:31], v[196:199], v[108:111], v[28:31]
    v_cvt_pk_bf16_f32 v152, v64, v65
    v_cvt_pk_bf16_f32 v153, v66, v67
    v_mfma_f32_16x16x32_bf16 v[24:27], v[192:195], v[108:111], v[24:27]
    s_waitcnt vmcnt(4)
    s_mov_b32 s72, 65536
    buffer_store_dwordx2 v[152:153], v5, s[56:59], s72 offen sc1
    v_mfma_f32_16x16x32_bf16 v[24:27], v[208:211], v[112:115], v[24:27]
    v_rcp_f32 v22, v158
    v_mfma_f32_16x16x32_bf16 v[28:31], v[212:215], v[112:115], v[28:31]
    v_lshlrev_b32 v158, 16, v157
    v_mul_f32 v23, -v159, v22
    v_mfma_f32_16x16x32_bf16 v[32:35], v[216:219], v[112:115], v[32:35]
    v_and_b32 v159, 0xffff0000, v157
    v_and_b32 v157, 0xffff0000, v156
    v_mfma_f32_16x16x32_bf16 v[36:39], v[220:223], v[112:115], v[36:39]
    s_waitcnt vmcnt(4)
    v_lshlrev_b32 v156, 16, v156
    v_fma_f32 v158, v158, v22, v23
    v_mfma_f32_16x16x32_bf16 v[36:39], v[236:239], v[116:119], v[36:39]
    v_fma_f32 v159, v159, v22, v23
    v_fma_f32 v157, v157, v22, v23
    v_mfma_f32_16x16x32_bf16 v[32:35], v[232:235], v[116:119], v[32:35]
    v_fma_f32 v156, v156, v22, v23
    v_mfma_f32_16x16x32_bf16 v[28:31], v[228:231], v[116:119], v[28:31]
    v_mfma_f32_16x16x32_bf16 v[24:27], v[224:227], v[116:119], v[24:27]
    s_waitcnt vmcnt(3)
    v_mfma_f32_16x16x32_bf16 v[24:27], v[240:243], v[120:123], v[24:27]
    v_mfma_f32_16x16x32_bf16 v[28:31], v[244:247], v[120:123], v[28:31]
    v_mfma_f32_16x16x32_bf16 v[32:35], v[248:251], v[120:123], v[32:35]
    v_mfma_f32_16x16x32_bf16 v[36:39], v[252:255], v[120:123], v[36:39]
    s_mov_b32 s72, 98304
    s_nop 3
    ds_write_b128 v11, v[24:27] offset:16384
    ds_write_b128 v14, v[28:31] offset:16384
    ds_write_b128 v11, v[32:35] offset:16512
    ds_write_b128 v14, v[36:39] offset:16512
    s_waitcnt lgkmcnt(0)
    s_barrier
    ds_read_b128 v[24:27], v12 offset:16384
    ds_read_b128 v[28:31], v12 offset:20480
    ds_read_b128 v[32:35], v12 offset:24576
    ds_read_b128 v[36:39], v12 offset:28672
    s_waitcnt lgkmcnt(2)
    v_pk_add_f32 v[24:25], v[24:25], v[28:29]
    v_pk_add_f32 v[26:27], v[26:27], v[30:31]
    s_waitcnt lgkmcnt(1)
    v_pk_add_f32 v[24:25], v[24:25], v[32:33]
    v_pk_add_f32 v[26:27], v[26:27], v[34:35]
    s_waitcnt lgkmcnt(0)
    v_pk_add_f32 v[24:25], v[24:25], v[36:37]
    v_pk_add_f32 v[26:27], v[26:27], v[38:39]
    v_pk_fma_f32 v[24:25], v[24:25], s[42:43], v[156:157] op_sel_hi:[1,0,1]
    v_pk_fma_f32 v[26:27], v[26:27], s[42:43], v[158:159] op_sel_hi:[1,0,1]
    v_cvt_pk_bf16_f32 v28, v24, v25
    v_cvt_pk_bf16_f32 v29, v26, v27
    buffer_store_dwordx2 v[28:29], v5, s[56:59], s72 offen sc1
L_fin:
L_end:
    s_endpgm
L_g1skip_13:
    s_add_u32 s70, s69, 5
    v_mov_b32 v2, s70
    s_waitcnt vmcnt(0) lgkmcnt(0)
    buffer_store_dword v2, v3, s[60:63], 0 offen
    s_mov_b32 s50, 0x1c0000
    ds_read_b64_tr_b16 a[144:145], v9 offset:8192
    ds_read_b64_tr_b16 a[146:147], v9 offset:10240
    ds_read_b64_tr_b16 a[148:149], v10 offset:8192
    ds_read_b64_tr_b16 a[150:151], v10 offset:10240
    ds_read_b64_tr_b16 a[152:153], v9 offset:8256
    ds_read_b64_tr_b16 a[154:155], v9 offset:10304
    ds_read_b64_tr_b16 a[156:157], v10 offset:8256
    ds_read_b64_tr_b16 a[158:159], v10 offset:10304
    ds_read_b64_tr_b16 a[160:161], v9 offset:12288
    ds_read_b64_tr_b16 a[162:163], v9 offset:14336
    ds_read_b64_tr_b16 a[164:165], v10 offset:12288
    ds_read_b64_tr_b16 a[166:167], v10 offset:14336
    ds_read_b64_tr_b16 a[168:169], v9 offset:12352
    ds_read_b64_tr_b16 a[170:171], v9 offset:14400
    ds_read_b64_tr_b16 a[172:173], v10 offset:12352
    ds_read_b64_tr_b16 a[174:175], v10 offset:14400
    ds_read_b64_tr_b16 a[176:177], v9 offset:16384
    ds_read_b64_tr_b16 a[178:179], v9 offset:18432
    ds_read_b64_tr_b16 a[180:181], v10 offset:16384
    ds_read_b64_tr_b16 a[182:183], v10 offset:18432
    ds_read_b64_tr_b16 a[184:185], v9 offset:16448
    ds_read_b64_tr_b16 a[186:187], v9 offset:18496
    ds_read_b64_tr_b16 a[188:189], v10 offset:16448
    ds_read_b64_tr_b16 a[190:191], v10 offset:18496
    ds_read_b64_tr_b16 a[192:193], v9 offset:20480
    ds_read_b64_tr_b16 a[194:195], v9 offset:22528
    ds_read_b64_tr_b16 a[196:197], v10 offset:20480
    ds_read_b64_tr_b16 a[198:199], v10 offset:22528
    ds_read_b64_tr_b16 a[200:201], v9 offset:20544
    ds_read_b64_tr_b16 a[202:203], v9 offset:22592
    ds_read_b64_tr_b16 a[204:205], v10 offset:20544
    ds_read_b64_tr_b16 a[206:207], v10 offset:22592
    ds_read_b64_tr_b16 a[208:209], v9 offset:24576
    ds_read_b64_tr_b16 a[210:211], v9 offset:26624
    ds_read_b64_tr_b16 a[212:213], v10 offset:24576
    ds_read_b64_tr_b16 a[214:215], v10 offset:26624
    ds_read_b64_tr_b16 a[216:217], v9 offset:24640
    ds_read_b64_tr_b16 a[218:219], v9 offset:26688
    ds_read_b64_tr_b16 a[220:221], v10 offset:24640
    ds_read_b64_tr_b16 a[222:223], v10 offset:26688
    ds_read_b64_tr_b16 a[224:225], v9 offset:28672
    ds_read_b64_tr_b16 a[226:227], v9 offset:30720
    ds_read_b64_tr_b16 a[228:229], v10 offset:28672
    ds_read_b64_tr_b16 a[230:231], v10 offset:30720
    ds_read_b64_tr_b16 a[232:233], v9 offset:28736
    ds_read_b64_tr_b16 a[234:235], v9 offset:30784
    ds_read_b64_tr_b16 a[236:237], v10 offset:28736
    ds_read_b64_tr_b16 a[238:239], v10 offset:30784
    ds_read_b64_tr_b16 a[240:241], v9 offset:0
    ds_read_b64_tr_b16 a[242:243], v9 offset:2048
    ds_read_b64_tr_b16 a[244:245], v10 offset:0
    ds_read_b64_tr_b16 a[246:247], v10 offset:2048
    ds_read_b64_tr_b16 a[248:249], v9 offset:64
    ds_read_b64_tr_b16 a[250:251], v9 offset:2112
    ds_read_b64_tr_b16 a[252:253], v10 offset:64
    ds_read_b64_tr_b16 a[254:255], v10 offset:2112
    s_lshl_b32 s77, s28, 5
    s_add_u32 m0, s3, 4096
    s_nop 0
    buffer_load_dwordx4 v15, s[48:51], s77 offen lds
    s_add_u32 m0, s3, 5120
    s_add_u32 s77, s77, 8192
    buffer_load_dwordx4 v15, s[48:51], s77 offen lds
    s_add_u32 m0, s3, 6144
    s_add_u32 s77, s77, 8192
    buffer_load_dwordx4 v15, s[48:51], s77 offen lds
    s_add_u32 m0, s3, 7168
    s_add_u32 s77, s77, 8192
    buffer_load_dwordx4 v15, s[48:51], s77 offen lds
    s_waitcnt lgkmcnt(15)
    s_lshl_b32 s77, s36, 5
    s_add_u32 m0, s3, 8192
    s_nop 0
    buffer_load_dwordx4 v15, s[48:51], s77 offen lds
    s_add_u32 m0, s3, 9216
    s_add_u32 s77, s77, 8192
    buffer_load_dwordx4 v15, s[48:51], s77 offen lds
    s_add_u32 m0, s3, 10240
    s_add_u32 s77, s77, 8192
    buffer_load_dwordx4 v15, s[48:51], s77 offen lds
    s_add_u32 m0, s3, 11264
    s_add_u32 s77, s77, 8192
    buffer_load_dwordx4 v15, s[48:51], s77 offen lds
    s_lshl_b32 s77, s37, 5
    s_add_u32 m0, s3, 12288
    s_nop 0
    buffer_load_dwordx4 v15, s[48:51], s77 offen lds
    s_add_u32 m0, s3, 13312
    s_add_u32 s77, s77, 8192
    buffer_load_dwordx4 v15, s[48:51], s77 offen lds
    s_add_u32 m0, s3, 14336
    s_add_u32 s77, s77, 8192
    buffer_load_dwordx4 v15, s[48:51], s77 offen lds
    s_add_u32 m0, s3, 15360
    s_add_u32 s77, s77, 8192
    buffer_load_dwordx4 v15, s[48:51], s77 offen lds
    s_lshl_b32 s77, s38, 5
    s_add_u32 m0, s3, 16384
    s_nop 0
    buffer_load_dwordx4 v15, s[48:51], s77 offen lds
    s_add_u32 m0, s3, 17408
    s_add_u32 s77, s77, 8192
    buffer_load_dwordx4 v15, s[48:51], s77 offen lds
    s_add_u32 m0, s3, 18432
    s_add_u32 s77, s77, 8192
    buffer_load_dwordx4 v15, s[48:51], s77 offen lds
    s_add_u32 m0, s3, 19456
    s_add_u32 s77, s77, 8192
    buffer_load_dwordx4 v15, s[48:51], s77 offen lds
    s_lshl_b32 s77, s39, 5
    s_add_u32 m0, s3, 20480
    s_nop 0
    buffer_load_dwordx4 v15, s[48:51], s77 offen lds
    s_add_u32 m0, s3, 21504
    s_add_u32 s77, s77, 8192
    buffer_load_dwordx4 v15, s[48:51], s77 offen lds
    s_add_u32 m0, s3, 22528
    s_add_u32 s77, s77, 8192
    buffer_load_dwordx4 v15, s[48:51], s77 offen lds
    s_add_u32 m0, s3, 23552
    s_add_u32 s77, s77, 8192
    buffer_load_dwordx4 v15, s[48:51], s77 offen lds
    s_lshl_b32 s77, s40, 5
    s_add_u32 m0, s3, 24576
    s_nop 0
    buffer_load_dwordx4 v15, s[48:51], s77 offen lds
    s_add_u32 m0, s3, 25600
    s_add_u32 s77, s77, 8192
    buffer_load_dwordx4 v15, s[48:51], s77 offen lds
    s_add_u32 m0, s3, 26624
    s_add_u32 s77, s77, 8192
    buffer_load_dwordx4 v15, s[48:51], s77 offen lds
    s_add_u32 m0, s3, 27648
    s_add_u32 s77, s77, 8192
    buffer_load_dwordx4 v15, s[48:51], s77 offen lds
    s_waitcnt lgkmcnt(8)
    s_lshl_b32 s77, s41, 5
    s_add_u32 m0, s3, 28672
    s_nop 0
    buffer_load_dwordx4 v15, s[48:51], s77 offen lds
    s_add_u32 m0, s3, 29696
    s_add_u32 s77, s77, 8192
    buffer_load_dwordx4 v15, s[48:51], s77 offen lds
    s_add_u32 m0, s3, 30720
    s_add_u32 s77, s77, 8192
    buffer_load_dwordx4 v15, s[48:51], s77 offen lds
    s_add_u32 m0, s3, 31744
    s_add_u32 s77, s77, 8192
    buffer_load_dwordx4 v15, s[48:51], s77 offen lds
    s_waitcnt vmcnt(24)
    ds_read_b64_tr_b16 a[128:129], v9 offset:4096
    ds_read_b64_tr_b16 a[130:131], v9 offset:6144
    ds_read_b64_tr_b16 a[132:133], v10 offset:4096
    ds_read_b64_tr_b16 a[134:135], v10 offset:6144
    ds_read_b64_tr_b16 a[136:137], v9 offset:4160
    ds_read_b64_tr_b16 a[138:139], v9 offset:6208
    ds_read_b64_tr_b16 a[140:141], v10 offset:4160
    ds_read_b64_tr_b16 a[142:143], v10 offset:6208
    s_waitcnt vmcnt(20)
    ds_read_b64_tr_b16 v[160:161], v9 offset:8192
    ds_read_b64_tr_b16 v[162:163], v9 offset:10240
    ds_read_b64_tr_b16 v[164:165], v10 offset:8192
    ds_read_b64_tr_b16 v[166:167], v10 offset:10240
    ds_read_b64_tr_b16 v[168:169], v9 offset:8256
    ds_read_b64_tr_b16 v[170:171], v9 offset:10304
    ds_read_b64_tr_b16 v[172:173], v10 offset:8256
    ds_read_b64_tr_b16 v[174:175], v10 offset:10304
    s_waitcnt vmcnt(16)
    ds_read_b64_tr_b16 v[176:177], v9 offset:12288
    ds_read_b64_tr_b16 v[178:179], v9 offset:14336
    ds_read_b64_tr_b16 v[180:181], v10 offset:12288
    ds_read_b64_tr_b16 v[182:183], v10 offset:14336
    ds_read_b64_tr_b16 v[184:185], v9 offset:12352
    ds_read_b64_tr_b16 v[186:187], v9 offset:14400
    ds_read_b64_tr_b16 v[188:189], v10 offset:12352
    ds_read_b64_tr_b16 v[190:191], v10 offset:14400
    s_waitcnt vmcnt(12)
    ds_read_b64_tr_b16 v[192:193], v9 offset:16384
    ds_read_b64_tr_b16 v[194:195], v9 offset:18432
    ds_read_b64_tr_b16 v[196:197], v10 offset:16384
    ds_read_b64_tr_b16 v[198:199], v10 offset:18432
    ds_read_b64_tr_b16 v[200:201], v9 offset:16448
    ds_read_b64_tr_b16 v[202:203], v9 offset:18496
    ds_read_b64_tr_b16 v[204:205], v10 offset:16448
    ds_read_b64_tr_b16 v[206:207], v10 offset:18496
    s_waitcnt vmcnt(8)
    ds_read_b64_tr_b16 v[208:209], v9 offset:20480
    ds_read_b64_tr_b16 v[210:211], v9 offset:22528
    ds_read_b64_tr_b16 v[212:213], v10 offset:20480
    ds_read_b64_tr_b16 v[214:215], v10 offset:22528
    ds_read_b64_tr_b16 v[216:217], v9 offset:20544
    ds_read_b64_tr_b16 v[218:219], v9 offset:22592
    ds_read_b64_tr_b16 v[220:221], v10 offset:20544
    ds_read_b64_tr_b16 v[222:223], v10 offset:22592
    s_waitcnt vmcnt(4)
    ds_read_b64_tr_b16 v[224:225], v9 offset:24576
    ds_read_b64_tr_b16 v[226:227], v9 offset:26624
    ds_read_b64_tr_b16 v[228:229], v10 offset:24576
    ds_read_b64_tr_b16 v[230:231], v10 offset:26624
    ds_read_b64_tr_b16 v[232:233], v9 offset:24640
    ds_read_b64_tr_b16 v[234:235], v9 offset:26688
    ds_read_b64_tr_b16 v[236:237], v10 offset:24640
    ds_read_b64_tr_b16 v[238:239], v10 offset:26688
    s_waitcnt vmcnt(0)
    ds_read_b64_tr_b16 v[240:241], v9 offset:28672
    ds_read_b64_tr_b16 v[242:243], v9 offset:30720
    ds_read_b64_tr_b16 v[244:245], v10 offset:28672
    ds_read_b64_tr_b16 v[246:247], v10 offset:30720
    ds_read_b64_tr_b16 v[248:249], v9 offset:28736
    ds_read_b64_tr_b16 v[250:251], v9 offset:30784
    ds_read_b64_tr_b16 v[252:253], v10 offset:28736
    ds_read_b64_tr_b16 v[254:255], v10 offset:30784
    s_waitcnt lgkmcnt(0)
    s_barrier
    v_or_b32 v16, 4, v17
    v_or_b32 v16, 5, v17
    s_add_u32 s70, s69, 4
L_spin_23:
    buffer_load_dword v2, v4, s[60:63], 0 offen sc1
    s_sub_u32 s71, s71, 1
    s_cbranch_scc1 L_bail_25
    s_waitcnt vmcnt(0)
    v_subrev_u32 v2, s70, v2
    v_cmp_le_u32 vcc, 16, v2
    s_nop 0
    s_cbranch_vccnz L_spin_23
L_ret_24:
    v_mov_b32 v20, -1
    v_mov_b32 v21, -1
    v_mov_b32 v22, -1
    v_mov_b32 v23, -1
    buffer_store_dwordx4 v[20:23], v7, s[60:63], 0 offen
    buffer_store_dwordx4 v[20:23], v7, s[60:63], s86 offen
    buffer_load_dwordx4 v[100:103], v13, s[60:63], s28 offen sc1
    buffer_load_dwordx4 v[104:107], v13, s[60:63], s29 offen sc1
    buffer_load_dwordx4 v[108:111], v13, s[60:63], s30 offen sc1
    buffer_load_dwordx4 v[112:115], v13, s[60:63], s31 offen sc1
    buffer_load_dwordx4 v[116:119], v13, s[60:63], s32 offen sc1
    v_or_b32 v16, 6, v17
    buffer_load_dwordx4 v[120:123], v13, s[60:63], s33 offen sc1
    buffer_load_dwordx4 v[124:127], v13, s[60:63], s34 offen sc1
    buffer_load_dwordx4 v[128:131], v13, s[60:63], s35 offen sc1
    s_add_u32 s70, s69, 5
    buffer_load_dword v2, v4, s[60:63], 0 offen sc1
    buffer_load_dwordx4 v[132:135], v13, s[60:63], s36 offen sc1
    buffer_load_dwordx4 v[136:139], v13, s[60:63], s37 offen sc1
    s_waitcnt vmcnt(0) lgkmcnt(0)
    s_branch L_g2_17
L_g1skip_50:
    s_add_u32 s70, s69, 11
    v_mov_b32 v2, s70
    s_waitcnt vmcnt(0) lgkmcnt(0)
    buffer_store_dword v2, v3, s[60:63], 0 offen
    s_add_u32 s70, s69, 9
L_spin_80:
    buffer_load_dword v2, v4, s[60:63], 0 offen sc1
    s_sub_u32 s71, s71, 1
    s_cbranch_scc1 L_bail_82
    s_waitcnt vmcnt(0)
    v_subrev_u32 v2, s70, v2
    v_cmp_le_u32 vcc, 16, v2
    s_nop 0
    s_cbranch_vccnz L_spin_80
L_ret_81:
    v_lshrrev_b32 v20, 10, v5
    v_lshlrev_b32 v20, 3, v20
    s_mov_b32 s74, 2098176
    buffer_load_dwordx2 v[146:147], v20, s[60:63], s74 offen offset:0 sc1
    buffer_load_dwordx2 v[150:151], v20, s[60:63], s74 offen offset:256 sc1
    buffer_load_dwordx2 v[154:155], v20, s[60:63], s74 offen offset:512 sc1
    buffer_load_dwordx2 v[158:159], v20, s[60:63], s74 offen offset:768 sc1
    s_mov_b32 s74, 0
    buffer_load_dwordx2 v[144:145], v5, s[60:63], s74 offen sc1
    s_mov_b32 s74, 32768
    buffer_load_dwordx2 v[148:149], v5, s[60:63], s74 offen sc1
    s_mov_b32 s74, 65536
    buffer_load_dwordx2 v[152:153], v5, s[60:63], s74 offen sc1
    s_mov_b32 s74, 98304
    buffer_load_dwordx2 v[156:157], v5, s[60:63], s74 offen sc1
    s_or_b32 s74, s2, s66
    v_or_b32 v21, s74, v1
    v_cmp_eq_u32 s[84:85], 0, v21
    v_mov_b32 v20, s69
    s_nop 0
    s_nop 0
    v_cndmask_b32 v21, -1, v21, s[84:85]
    buffer_store_dword v20, v21, s[52:55], 0 offen sc1
    v_or_b32 v16, 10, v17
    v_or_b32 v16, 11, v17
    s_add_u32 s70, s69, 10
L_spin_62:
    buffer_load_dword v2, v4, s[60:63], 0 offen sc1
    s_sub_u32 s71, s71, 1
    s_cbranch_scc1 L_bail_64
    s_waitcnt vmcnt(0)
    v_subrev_u32 v2, s70, v2
    v_cmp_le_u32 vcc, 16, v2
    s_nop 0
    s_cbranch_vccnz L_spin_62
L_ret_63:
    buffer_load_dwordx4 v[100:103], v13, s[60:63], s28 offen sc1
    buffer_load_dwordx4 v[104:107], v13, s[60:63], s29 offen sc1
    buffer_load_dwordx4 v[108:111], v13, s[60:63], s30 offen sc1
    buffer_load_dwordx4 v[112:115], v13, s[60:63], s31 offen sc1
    buffer_load_dwordx4 v[116:119], v13, s[60:63], s32 offen sc1
    buffer_load_dwordx4 v[120:123], v13, s[60:63], s33 offen sc1
    buffer_load_dwordx4 v[124:127], v13, s[60:63], s34 offen sc1
    v_or_b32 v16, 12, v17
    buffer_load_dwordx4 v[128:131], v13, s[60:63], s35 offen sc1
    buffer_load_dwordx4 v[132:135], v13, s[60:63], s36 offen sc1
    buffer_load_dwordx4 v[136:139], v13, s[60:63], s37 offen sc1
    s_add_u32 s70, s69, 11
    buffer_load_dword v2, v4, s[60:63], 0 offen sc1
    s_waitcnt vmcnt(0) lgkmcnt(0)
    s_branch L_g2_51
L_cpf_end:
L_global:
    s_waitcnt vmcnt(0) lgkmcnt(0)
    s_nop 4
    v_pk_fma_f32 v[40:41], v[24:25], s[82:83], s[82:83] op_sel:[0,0,1] op_sel_hi:[1,0,1]
    v_pk_fma_f32 v[42:43], v[26:27], s[82:83], s[82:83] op_sel:[0,0,1] op_sel_hi:[1,0,1]
    v_pk_fma_f32 v[44:45], v[28:29], s[82:83], s[82:83] op_sel:[0,0,1] op_sel_hi:[1,0,1]
    v_pk_fma_f32 v[46:47], v[30:31], s[82:83], s[82:83] op_sel:[0,0,1] op_sel_hi:[1,0,1]
    v_cvt_pk_bf16_f32 v80, v40, v41
    v_cvt_pk_bf16_f32 v81, v42, v43
    v_cvt_pk_bf16_f32 v82, v44, v45
    v_cvt_pk_bf16_f32 v83, v46, v47
    buffer_store_dwordx4 v[80:83], v7, s[60:63], 0 offen sc1
    v_pk_fma_f32 v[48:49], v[32:33], s[84:85], s[84:85] op_sel:[0,0,1] op_sel_hi:[1,0,1]
    v_pk_fma_f32 v[50:51], v[34:35], s[84:85], s[84:85] op_sel:[0,0,1] op_sel_hi:[1,0,1]
    v_pk_fma_f32 v[52:53], v[36:37], s[84:85], s[84:85] op_sel:[0,0,1] op_sel_hi:[1,0,1]
    v_pk_fma_f32 v[54:55], v[38:39], s[84:85], s[84:85] op_sel:[0,0,1] op_sel_hi:[1,0,1]
    v_cvt_pk_bf16_f32 v84, v48, v49
    v_cvt_pk_bf16_f32 v85, v50, v51
    v_cvt_pk_bf16_f32 v86, v52, v53
    v_cvt_pk_bf16_f32 v87, v54, v55
    buffer_store_dwordx4 v[84:87], v7, s[60:63], s86 offen sc1
    v_cvt_pk_bf16_f32 v144, v24, v25
    v_cvt_pk_bf16_f32 v145, v26, v27
    v_cvt_pk_bf16_f32 v146, v28, v29
    v_cvt_pk_bf16_f32 v147, v30, v31
    v_cvt_pk_bf16_f32 v148, v32, v33
    v_cvt_pk_bf16_f32 v149, v34, v35
    v_cvt_pk_bf16_f32 v150, v36, v37
    v_cvt_pk_bf16_f32 v151, v38, v39
    s_add_u32 m0, s3, 3072
    s_add_u32 s77, s77, s24
    buffer_load_dwordx4 v16, s[44:47], s77 offen lds
    v_mov_b32 v17, s69
    s_add_u32 s70, s69, 3
    v_mov_b32 v2, s70
    s_waitcnt vmcnt(1)
    buffer_store_dword v2, v3, s[60:63], 0 offen sc1
    s_cmp_ge_u32 s67, 14
    s_cbranch_scc1 L_g1skip_83
    s_barrier
    s_lshl_b32 s3, s66, 13
    s_add_u32 m0, s3, 131072
    s_lshl_b32 s77, s37, 5
    buffer_load_dwordx4 v15, s[48:51], s77 offen lds
    s_add_u32 m0, s3, 132096
    s_add_u32 s77, s77, 8192
    buffer_load_dwordx4 v15, s[48:51], s77 offen lds
    s_add_u32 m0, s3, 133120
    s_add_u32 s77, s77, 8192
    buffer_load_dwordx4 v15, s[48:51], s77 offen lds
    s_add_u32 m0, s3, 134144
    s_add_u32 s77, s77, 8192
    buffer_load_dwordx4 v15, s[48:51], s77 offen lds
    s_waitcnt vmcnt(5)
    s_barrier
    ds_read_b64_tr_b16 a[0:1], v110 offset:0
    ds_read_b64_tr_b16 a[2:3], v110 offset:1024
    ds_read_b64_tr_b16 a[4:5], v111 offset:0
    ds_read_b64_tr_b16 a[6:7], v111 offset:1024
    ds_read_b64_tr_b16 a[8:9], v110 offset:8192
    ds_read_b64_tr_b16 a[10:11], v110 offset:9216
    ds_read_b64_tr_b16 a[12:13], v111 offset:8192
    ds_read_b64_tr_b16 a[14:15], v111 offset:9216
    ds_read_b64_tr_b16 a[16:17], v110 offset:16384
    ds_read_b64_tr_b16 a[18:19], v110 offset:17408
    ds_read_b64_tr_b16 a[20:21], v111 offset:16384
    ds_read_b64_tr_b16 a[22:23], v111 offset:17408
    ds_read_b64_tr_b16 a[24:25], v110 offset:24576
    ds_read_b64_tr_b16 a[26:27], v110 offset:25600
    ds_read_b64_tr_b16 a[28:29], v111 offset:24576
    ds_read_b64_tr_b16 a[30:31], v111 offset:25600
    buffer_load_dword v2, v4, s[60:63], 0 offen sc1
    ds_read_b64_tr_b16 a[32:33], v110 offset:32768
    ds_read_b64_tr_b16 a[34:35], v110 offset:33792
    ds_read_b64_tr_b16 a[36:37], v111 offset:32768
    ds_read_b64_tr_b16 a[38:39], v111 offset:33792
    ds_read_b64_tr_b16 a[40:41], v110 offset:40960
    ds_read_b64_tr_b16 a[42:43], v110 offset:41984
    ds_read_b64_tr_b16 a[44:45], v111 offset:40960
    ds_read_b64_tr_b16 a[46:47], v111 offset:41984
    ds_read_b64_tr_b16 a[48:49], v110 offset:49152
    ds_read_b64_tr_b16 a[50:51], v110 offset:50176
    ds_read_b64_tr_b16 a[52:53], v111 offset:49152
    ds_read_b64_tr_b16 a[54:55], v111 offset:50176
    ds_read_b64_tr_b16 a[56:57], v110 offset:57344
    ds_read_b64_tr_b16 a[58:59], v110 offset:58368
    ds_read_b64_tr_b16 a[60:61], v111 offset:57344
    ds_read_b64_tr_b16 a[62:63], v111 offset:58368
    ds_read_b64_tr_b16 a[64:65], v100 offset:0
    ds_read_b64_tr_b16 a[66:67], v100 offset:1024
    ds_read_b64_tr_b16 a[68:69], v101 offset:0
    ds_read_b64_tr_b16 a[70:71], v101 offset:1024
    ds_read_b64_tr_b16 a[72:73], v100 offset:8192
    ds_read_b64_tr_b16 a[74:75], v100 offset:9216
    ds_read_b64_tr_b16 a[76:77], v101 offset:8192
    ds_read_b64_tr_b16 a[78:79], v101 offset:9216
    ds_read_b64_tr_b16 a[80:81], v100 offset:16384
    ds_read_b64_tr_b16 a[82:83], v100 offset:17408
    ds_read_b64_tr_b16 a[84:85], v101 offset:16384
    ds_read_b64_tr_b16 a[86:87], v101 offset:17408
    ds_read_b64_tr_b16 a[88:89], v100 offset:24576
    ds_read_b64_tr_b16 a[90:91], v100 offset:25600
    ds_read_b64_tr_b16 a[92:93], v101 offset:24576
    ds_read_b64_tr_b16 a[94:95], v101 offset:25600
    ds_read_b64_tr_b16 a[96:97], v100 offset:32768
    ds_read_b64_tr_b16 a[98:99], v100 offset:33792
    ds_read_b64_tr_b16 a[100:101], v101 offset:32768
    ds_read_b64_tr_b16 a[102:103], v101 offset:33792
    ds_read_b64_tr_b16 a[104:105], v100 offset:40960
    ds_read_b64_tr_b16 a[106:107], v100 offset:41984
    ds_read_b64_tr_b16 a[108:109], v101 offset:40960
    ds_read_b64_tr_b16 a[110:111], v101 offset:41984
    ds_read_b64_tr_b16 a[112:113], v100 offset:49152
    ds_read_b64_tr_b16 a[114:115], v100 offset:50176
    ds_read_b64_tr_b16 a[116:117], v101 offset:49152
    ds_read_b64_tr_b16 a[118:119], v101 offset:50176
    ds_read_b64_tr_b16 a[120:121], v100 offset:57344
    ds_read_b64_tr_b16 a[122:123], v100 offset:58368
    ds_read_b64_tr_b16 a[124:125], v101 offset:57344
    ds_read_b64_tr_b16 a[126:127], v101 offset:58368
    s_waitcnt vmcnt(0)
    v_subrev_u32 v2, s70, v2
    v_cmp_le_u32 vcc, 16, v2
    s_nop 0
    s_cbranch_vccz L_ret_85
L_spin_84:
    buffer_load_dword v2, v4, s[60:63], 0 offen sc1
    s_sub_u32 s71, s71, 1
    s_cbranch_scc1 L_bail_86
    s_waitcnt vmcnt(0)
    v_subrev_u32 v2, s70, v2
    v_cmp_le_u32 vcc, 16, v2
    s_nop 0
    s_cbranch_vccnz L_spin_84
L_ret_85:
    s_waitcnt lgkmcnt(15)
    s_barrier
    s_add_u32 m0, s43, 0
    s_mov_b32 s72, 0
    buffer_load_dwordx4 v8, s[60:63], s72 offen offset:0 sc1 lds
    s_add_u32 m0, s43, 7936
    s_nop 0
    buffer_load_dwordx4 v8, s[60:63], s72 offen offset:256 sc1 lds
    s_add_u32 m0, s43, 15872
    s_nop 0
    buffer_load_dwordx4 v8, s[60:63], s72 offen offset:512 sc1 lds
    s_add_u32 m0, s43, 23808
    s_nop 0
    buffer_load_dwordx4 v8, s[60:63], s72 offen offset:768 sc1 lds
    s_add_u32 m0, s43, 4096
    s_mov_b32 s72, 16384
    buffer_load_dwordx4 v8, s[60:63], s72 offen offset:0 sc1 lds
    s_add_u32 m0, s43, 12032
    s_nop 0
    buffer_load_dwordx4 v8, s[60:63], s72 offen offset:256 sc1 lds
    s_add_u32 m0, s43, 19968
    s_nop 0
    buffer_load_dwordx4 v8, s[60:63], s72 offen offset:512 sc1 lds
    s_add_u32 m0, s43, 27904
    s_nop 0
    buffer_load_dwordx4 v8, s[60:63], s72 offen offset:768 sc1 lds
    s_waitcnt lgkmcnt(0)
    s_waitcnt vmcnt(6)
    s_barrier
    ds_read_b128 v[56:59], v96 offset:0
    ds_read_b128 v[60:63], v97 offset:0
    ds_read_b128 v[64:67], v98 offset:0
    ds_read_b128 v[68:71], v99 offset:0
    s_waitcnt lgkmcnt(3)
    v_mfma_f32_16x16x32_bf16 v[28:31], a[4:7], v[56:59], 0
    s_add_u32 m0, s43, 32768
    ds_read_b128 v[72:75], v96 offset:8192
    ds_read_b128 v[76:79], v97 offset:8192
    v_mfma_f32_16x16x32_bf16 v[24:27], a[0:3], v[56:59], 0
    s_mov_b32 s72, 32768
    s_waitcnt lgkmcnt(4)
    v_mfma_f32_16x16x32_bf16 v[24:27], a[8:11], v[60:63], v[24:27]
    buffer_load_dwordx4 v8, s[60:63], s72 offen offset:0 sc1 lds
    v_mfma_f32_16x16x32_bf16 v[28:31], a[12:15], v[60:63], v[28:31]
    s_waitcnt lgkmcnt(2)
    v_mfma_f32_16x16x32_bf16 v[28:31], a[20:23], v[64:67], v[28:31]
    s_add_u32 m0, s43, 40704
    ds_read_b128 v[56:59], v98 offset:8192
    ds_read_b128 v[60:63], v99 offset:8192
    v_mfma_f32_16x16x32_bf16 v[24:27], a[16:19], v[64:67], v[24:27]
    s_mul_i32 s74, s66, 24576
    buffer_load_dwordx4 v8, s[60:63], s72 offen offset:256 sc1 lds
    v_mfma_f32_16x16x32_bf16 v[24:27], a[24:27], v[68:71], v[24:27]
    s_waitcnt vmcnt(6)
    s_barrier
    v_mfma_f32_16x16x32_bf16 v[28:31], a[28:31], v[68:71], v[28:31]
    s_waitcnt lgkmcnt(2)
    v_subrev_u32 v9, s74, v9
    v_subrev_u32 v10, s74, v10
    v_mfma_f32_16x16x32_bf16 v[28:31], a[36:39], v[72:75], v[28:31]
    s_add_u32 m0, s43, 48640
    ds_read_b128 v[64:67], v96 offset:16384
    ds_read_b128 v[68:71], v97 offset:16384
    v_mfma_f32_16x16x32_bf16 v[24:27], a[32:35], v[72:75], v[24:27]
    buffer_load_dwordx4 v8, s[60:63], s72 offen offset:512 sc1 lds
    v_mfma_f32_16x16x32_bf16 v[24:27], a[40:43], v[76:79], v[24:27]
    v_add_u32 v18, 131072, v9
    v_add_u32 v0, 131072, v10
    v_mfma_f32_16x16x32_bf16 v[28:31], a[44:47], v[76:79], v[28:31]
    s_waitcnt lgkmcnt(2)
    v_mfma_f32_16x16x32_bf16 v[28:31], a[52:55], v[56:59], v[28:31]
    s_add_u32 m0, s43, 56576
    ds_read_b128 v[72:75], v98 offset:16384
    ds_read_b128 v[76:79], v99 offset:16384
    v_mfma_f32_16x16x32_bf16 v[24:27], a[48:51], v[56:59], v[24:27]
    buffer_load_dwordx4 v8, s[60:63], s72 offen offset:768 sc1 lds
    v_mfma_f32_16x16x32_bf16 v[24:27], a[56:59], v[60:63], v[24:27]
    v_mfma_f32_16x16x32_bf16 v[28:31], a[60:63], v[60:63], v[28:31]
    s_waitcnt lgkmcnt(2)
    v_mfma_f32_16x16x32_bf16 v[28:31], a[68:71], v[64:67], v[28:31]
    s_add_u32 m0, s43, 36864
    ds_read_b128 v[56:59], v96 offset:24576
    ds_read_b128 v[60:63], v97 offset:24576
    v_mfma_f32_16x16x32_bf16 v[24:27], a[64:67], v[64:67], v[24:27]
    s_mov_b32 s72, 49152
    v_mfma_f32_16x16x32_bf16 v[24:27], a[72:75], v[68:71], v[24:27]
    buffer_load_dwordx4 v8, s[60:63], s72 offen offset:0 sc1 lds
    v_mfma_f32_16x16x32_bf16 v[28:31], a[76:79], v[68:71], v[28:31]
    s_waitcnt lgkmcnt(2)
    v_mfma_f32_16x16x32_bf16 v[28:31], a[84:87], v[72:75], v[28:31]
    s_add_u32 m0, s43, 44800
    ds_read_b128 v[64:67], v98 offset:24576
    ds_read_b128 v[68:71], v99 offset:24576
    v_mfma_f32_16x16x32_bf16 v[24:27], a[80:83], v[72:75], v[24:27]
    buffer_load_dwordx4 v8, s[60:63], s72 offen offset:256 sc1 lds
    v_mfma_f32_16x16x32_bf16 v[24:27], a[88:91], v[76:79], v[24:27]
    s_waitcnt vmcnt(6)
    s_barrier
    v_mfma_f32_16x16x32_bf16 v[28:31], a[92:95], v[76:79], v[28:31]
    s_waitcnt lgkmcnt(2)
    v_mfma_f32_16x16x32_bf16 v[28:31], a[100:103], v[56:59], v[28:31]
    s_add_u32 m0, s43, 52736
    ds_read_b128 v[72:75], v96 offset:4096
    ds_read_b128 v[76:79], v97 offset:4096
    v_mfma_f32_16x16x32_bf16 v[24:27], a[96:99], v[56:59], v[24:27]
    buffer_load_dwordx4 v8, s[60:63], s72 offen offset:512 sc1 lds
    v_mfma_f32_16x16x32_bf16 v[24:27], a[104:107], v[60:63], v[24:27]
    v_mfma_f32_16x16x32_bf16 v[28:31], a[108:111], v[60:63], v[28:31]
    s_waitcnt lgkmcnt(2)
    v_mfma_f32_16x16x32_bf16 v[28:31], a[116:119], v[64:67], v[28:31]
    s_add_u32 m0, s43, 60672
    ds_read_b128 v[56:59], v98 offset:4096
    ds_read_b128 v[60:63], v99 offset:4096
    v_mfma_f32_16x16x32_bf16 v[24:27], a[112:115], v[64:67], v[24:27]
    buffer_load_dwordx4 v8, s[60:63], s72 offen offset:768 sc1 lds
    v_mfma_f32_16x16x32_bf16 v[24:27], a[120:123], v[68:71], v[24:27]
    v_mfma_f32_16x16x32_bf16 v[28:31], a[124:127], v[68:71], v[28:31]
    s_waitcnt lgkmcnt(2)
    v_mfma_f32_16x16x32_bf16 v[36:39], a[4:7], v[72:75], 0
    s_add_u32 m0, s43, 65536
    ds_read_b128 v[64:67], v96 offset:12288
    ds_read_b128 v[68:71], v97 offset:12288
    v_mfma_f32_16x16x32_bf16 v[32:35], a[0:3], v[72:75], 0
    s_mov_b32 s72, 65536
    v_mfma_f32_16x16x32_bf16 v[32:35], a[8:11], v[76:79], v[32:35]
    buffer_load_dwordx4 v8, s[60:63], s72 offen offset:0 sc1 lds
    v_mfma_f32_16x16x32_bf16 v[36:39], a[12:15], v[76:79], v[36:39]
    s_waitcnt lgkmcnt(2)
    v_mfma_f32_16x16x32_bf16 v[36:39], a[20:23], v[56:59], v[36:39]
    s_add_u32 m0, s43, 73472
    ds_read_b128 v[72:75], v98 offset:12288
    ds_read_b128 v[76:79], v99 offset:12288
    v_mfma_f32_16x16x32_bf16 v[32:35], a[16:19], v[56:59], v[32:35]
    buffer_load_dwordx4 v8, s[60:63], s72 offen offset:256 sc1 lds
    v_mfma_f32_16x16x32_bf16 v[32:35], a[24:27], v[60:63], v[32:35]
    v_exp_f32 v80, -v24
    v_mfma_f32_16x16x32_bf16 v[36:39], a[28:31], v[60:63], v[36:39]
    s_waitcnt lgkmcnt(2)
    v_exp_f32 v81, -v25
    v_mfma_f32_16x16x32_bf16 v[36:39], a[36:39], v[64:67], v[36:39]
    s_add_u32 m0, s43, 81408
    ds_read_b128 v[56:59], v96 offset:20480
    ds_read_b128 v[60:63], v97 offset:20480
    v_mfma_f32_16x16x32_bf16 v[32:35], a[32:35], v[64:67], v[32:35]
    buffer_load_dwordx4 v8, s[60:63], s72 offen offset:512 sc1 lds
    v_add_f32 v80, 1.0, v80
    v_mfma_f32_16x16x32_bf16 v[32:35], a[40:43], v[68:71], v[32:35]
    v_rcp_f32 v80, v80
    v_mfma_f32_16x16x32_bf16 v[36:39], a[44:47], v[68:71], v[36:39]
    s_waitcnt lgkmcnt(2)
    v_exp_f32 v82, -v26
    v_mfma_f32_16x16x32_bf16 v[36:39], a[52:55], v[72:75], v[36:39]
    s_add_u32 m0, s43, 89344
    ds_read_b128 v[64:67], v98 offset:20480
    ds_read_b128 v[68:71], v99 offset:20480
    v_mfma_f32_16x16x32_bf16 v[32:35], a[48:51], v[72:75], v[32:35]
    buffer_load_dwordx4 v8, s[60:63], s72 offen offset:768 sc1 lds
    v_mul_f32 v80, v80, v24
    v_mfma_f32_16x16x32_bf16 v[32:35], a[56:59], v[76:79], v[32:35]
    v_exp_f32 v83, -v27
    v_mfma_f32_16x16x32_bf16 v[36:39], a[60:63], v[76:79], v[36:39]
    s_waitcnt lgkmcnt(2)
    v_exp_f32 v84, -v28
    v_mfma_f32_16x16x32_bf16 v[36:39], a[68:71], v[56:59], v[36:39]
    s_add_u32 m0, s43, 69632
    ds_read_b128 v[72:75], v96 offset:28672
    ds_read_b128 v[76:79], v97 offset:28672
    v_mfma_f32_16x16x32_bf16 v[32:35], a[64:67], v[56:59], v[32:35]
    s_mov_b32 s72, 81920
    v_exp_f32 v85, -v29
    v_add_f32 v81, 1.0, v81
    v_mfma_f32_16x16x32_bf16 v[32:35], a[72:75], v[60:63], v[32:35]
    buffer_load_dwordx4 v8, s[60:63], s72 offen offset:0 sc1 lds
    v_mfma_f32_16x16x32_bf16 v[36:39], a[76:79], v[60:63], v[36:39]
    s_waitcnt lgkmcnt(2)
    v_rcp_f32 v81, v81
    v_mfma_f32_16x16x32_bf16 v[36:39], a[84:87], v[64:67], v[36:39]
    s_add_u32 m0, s43, 77568
    ds_read_b128 v[56:59], v98 offset:28672
    ds_read_b128 v[60:63], v99 offset:28672
    v_mfma_f32_16x16x32_bf16 v[32:35], a[80:83], v[64:67], v[32:35]
    buffer_load_dwordx4 v8, s[60:63], s72 offen offset:256 sc1 lds
    v_mul_f32 v81, v81, v25
    v_mfma_f32_16x16x32_bf16 v[32:35], a[88:91], v[68:71], v[32:35]
    s_waitcnt vmcnt(10)
    s_barrier
    v_mfma_f32_16x16x32_bf16 v[36:39], a[92:95], v[68:71], v[36:39]
    s_waitcnt lgkmcnt(2)
    v_exp_f32 v86, -v30
    v_mfma_f32_16x16x32_bf16 v[36:39], a[100:103], v[72:75], v[36:39]
    s_add_u32 m0, s43, 85504
    ds_read_b128 v[64:67], v96 offset:32768
    ds_read_b128 v[68:71], v97 offset:32768
    v_mfma_f32_16x16x32_bf16 v[32:35], a[96:99], v[72:75], v[32:35]
    buffer_load_dwordx4 v8, s[60:63], s72 offen offset:512 sc1 lds
    v_cvt_pk_bf16_f32 v88, v80, v81
    v_mfma_f32_16x16x32_bf16 v[32:35], a[104:107], v[76:79], v[32:35]
    v_exp_f32 v87, -v31
    v_mfma_f32_16x16x32_bf16 v[36:39], a[108:111], v[76:79], v[36:39]
    s_waitcnt lgkmcnt(2)
    v_add_f32 v82, 1.0, v82
    v_add_f32 v83, 1.0, v83
    v_mfma_f32_16x16x32_bf16 v[36:39], a[116:119], v[56:59], v[36:39]
    s_add_u32 m0, s43, 93440
    ds_read_b128 v[72:75], v98 offset:32768
    ds_read_b128 v[76:79], v99 offset:32768
    v_mfma_f32_16x16x32_bf16 v[32:35], a[112:115], v[56:59], v[32:35]
    buffer_load_dwordx4 v8, s[60:63], s72 offen offset:768 sc1 lds
    v_add_f32 v84, 1.0, v84
    v_mfma_f32_16x16x32_bf16 v[32:35], a[120:123], v[60:63], v[32:35]
    v_rcp_f32 v82, v82
    v_mfma_f32_16x16x32_bf16 v[36:39], a[124:127], v[60:63], v[36:39]
    s_waitcnt lgkmcnt(2)
    v_rcp_f32 v83, v83
    v_mfma_f32_16x16x32_bf16 v[44:47], a[4:7], v[64:67], 0
    s_add_u32 m0, s43, 98304
    ds_read_b128 v[56:59], v96 offset:40960
    ds_read_b128 v[60:63], v97 offset:40960
    v_mfma_f32_16x16x32_bf16 v[40:43], a[0:3], v[64:67], 0
    s_mov_b32 s72, 98304
    v_rcp_f32 v84, v84
    v_mul_f32 v82, v82, v26
    v_mfma_f32_16x16x32_bf16 v[40:43], a[8:11], v[68:71], v[40:43]
    buffer_load_dwordx4 v8, s[60:63], s72 offen offset:0 sc1 lds
    v_mfma_f32_16x16x32_bf16 v[44:47], a[12:15], v[68:71], v[44:47]
    s_waitcnt lgkmcnt(2)
    v_mul_f32 v83, v83, v27
    v_mul_f32 v84, v84, v28
    v_mfma_f32_16x16x32_bf16 v[44:47], a[20:23], v[72:75], v[44:47]
    s_add_u32 m0, s43, 106240
    ds_read_b128 v[64:67], v98 offset:40960
    ds_read_b128 v[68:71], v99 offset:40960
    v_mfma_f32_16x16x32_bf16 v[40:43], a[16:19], v[72:75], v[40:43]
    buffer_load_dwordx4 v8, s[60:63], s72 offen offset:256 sc1 lds
    v_cvt_pk_bf16_f32 v89, v82, v83
    v_mfma_f32_16x16x32_bf16 v[40:43], a[24:27], v[76:79], v[40:43]
    v_add_f32 v85, 1.0, v85
    v_add_f32 v86, 1.0, v86
    v_mfma_f32_16x16x32_bf16 v[44:47], a[28:31], v[76:79], v[44:47]
    s_waitcnt lgkmcnt(2)
    v_rcp_f32 v85, v85
    v_mfma_f32_16x16x32_bf16 v[44:47], a[36:39], v[56:59], v[44:47]
    s_add_u32 m0, s43, 114176
    ds_read_b128 v[72:75], v96 offset:49152
    ds_read_b128 v[76:79], v97 offset:49152
    v_mfma_f32_16x16x32_bf16 v[40:43], a[32:35], v[56:59], v[40:43]
    buffer_load_dwordx4 v8, s[60:63], s72 offen offset:512 sc1 lds
    v_mul_f32 v85, v85, v29
    v_mfma_f32_16x16x32_bf16 v[40:43], a[40:43], v[60:63], v[40:43]
    v_rcp_f32 v86, v86
    v_mfma_f32_16x16x32_bf16 v[44:47], a[44:47], v[60:63], v[44:47]
    s_waitcnt lgkmcnt(2)
    v_cvt_pk_bf16_f32 v90, v84, v85
    v_mul_f32 v86, v86, v30
    v_mfma_f32_16x16x32_bf16 v[44:47], a[52:55], v[64:67], v[44:47]
    s_add_u32 m0, s43, 122112
    ds_read_b128 v[56:59], v98 offset:49152
    ds_read_b128 v[60:63], v99 offset:49152
    v_mfma_f32_16x16x32_bf16 v[40:43], a[48:51], v[64:67], v[40:43]
    buffer_load_dwordx4 v8, s[60:63], s72 offen offset:768 sc1 lds
    v_add_f32 v87, 1.0, v87
    v_mfma_f32_16x16x32_bf16 v[40:43], a[56:59], v[68:71], v[40:43]
    v_rcp_f32 v87, v87
    v_mfma_f32_16x16x32_bf16 v[44:47], a[60:63], v[68:71], v[44:47]
    s_waitcnt lgkmcnt(2)
    v_mul_f32 v87, v87, v31
    v_mfma_f32_16x16x32_bf16 v[44:47], a[68:71], v[72:75], v[44:47]
    s_add_u32 m0, s43, 102400
    ds_read_b128 v[64:67], v96 offset:57344
    ds_read_b128 v[68:71], v97 offset:57344
    v_mfma_f32_16x16x32_bf16 v[40:43], a[64:67], v[72:75], v[40:43]
    s_mov_b32 s72, 114688
    v_cvt_pk_bf16_f32 v91, v86, v87
    v_mfma_f32_16x16x32_bf16 v[40:43], a[72:75], v[76:79], v[40:43]
    buffer_load_dwordx4 v8, s[60:63], s72 offen offset:0 sc1 lds
    v_mfma_f32_16x16x32_bf16 v[44:47], a[76:79], v[76:79], v[44:47]
    s_waitcnt lgkmcnt(2)
    s_mov_b32 s75, 0
    buffer_store_dwordx4 v[88:91], v6, s[60:63], s75 offen sc1
    v_mfma_f32_16x16x32_bf16 v[44:47], a[84:87], v[56:59], v[44:47]
    s_add_u32 m0, s43, 110336
    ds_read_b128 v[72:75], v98 offset:57344
    ds_read_b128 v[76:79], v99 offset:57344
    v_mfma_f32_16x16x32_bf16 v[40:43], a[80:83], v[56:59], v[40:43]
    buffer_load_dwordx4 v8, s[60:63], s72 offen offset:256 sc1 lds
    v_mfma_f32_16x16x32_bf16 v[40:43], a[88:91], v[60:63], v[40:43]
    s_waitcnt vmcnt(11)
    s_barrier
    v_mfma_f32_16x16x32_bf16 v[44:47], a[92:95], v[60:63], v[44:47]
    s_waitcnt lgkmcnt(2)
    v_exp_f32 v80, -v32
    v_mfma_f32_16x16x32_bf16 v[44:47], a[100:103], v[64:67], v[44:47]
    s_add_u32 m0, s43, 118272
    ds_read_b128 v[56:59], v96 offset:36864
    ds_read_b128 v[60:63], v97 offset:36864
    v_add_f32 v80, 1.0, v80
    v_mfma_f32_16x16x32_bf16 v[40:43], a[96:99], v[64:67], v[40:43]
    buffer_load_dwordx4 v8, s[60:63], s72 offen offset:512 sc1 lds
    v_mfma_f32_16x16x32_bf16 v[40:43], a[104:107], v[68:71], v[40:43]
    v_rcp_f32 v80, v80
    v_exp_f32 v81, -v33
    v_mfma_f32_16x16x32_bf16 v[44:47], a[108:111], v[68:71], v[44:47]
    s_waitcnt lgkmcnt(2)
    v_exp_f32 v82, -v34
    v_mul_f32 v80, v80, v32
    v_mfma_f32_16x16x32_bf16 v[44:47], a[116:119], v[72:75], v[44:47]
    s_add_u32 m0, s43, 126208
    ds_read_b128 v[64:67], v98 offset:36864
    ds_read_b128 v[68:71], v99 offset:36864
    v_add_f32 v81, 1.0, v81
    v_mfma_f32_16x16x32_bf16 v[40:43], a[112:115], v[72:75], v[40:43]
    buffer_load_dwordx4 v8, s[60:63], s72 offen offset:768 sc1 lds
    v_add_f32 v82, 1.0, v82
    v_mfma_f32_16x16x32_bf16 v[40:43], a[120:123], v[76:79], v[40:43]
    s_add_u32 m0, s3, 135168
    v_rcp_f32 v81, v81
    v_mfma_f32_16x16x32_bf16 v[44:47], a[124:127], v[76:79], v[44:47]
    s_waitcnt lgkmcnt(2)
    v_rcp_f32 v82, v82
    v_mul_f32 v81, v81, v33
    v_mfma_f32_16x16x32_bf16 v[52:55], a[4:7], v[56:59], 0
    s_lshl_b32 s77, s38, 5
    ds_read_b128 v[72:75], v96 offset:45056
    ds_read_b128 v[76:79], v97 offset:45056
    v_cvt_pk_bf16_f32 v92, v80, v81
    v_mfma_f32_16x16x32_bf16 v[48:51], a[0:3], v[56:59], 0
    buffer_load_dwordx4 v15, s[48:51], s77 offen lds
    v_mul_f32 v82, v82, v34
    v_mfma_f32_16x16x32_bf16 v[48:51], a[8:11], v[60:63], v[48:51]
    s_add_u32 m0, s3, 136192
    v_exp_f32 v83, -v35
    v_exp_f32 v84, -v36
    v_mfma_f32_16x16x32_bf16 v[52:55], a[12:15], v[60:63], v[52:55]
    s_waitcnt lgkmcnt(2)
    v_exp_f32 v85, -v37
    v_add_f32 v83, 1.0, v83
    v_mfma_f32_16x16x32_bf16 v[52:55], a[20:23], v[64:67], v[52:55]
    s_add_u32 s77, s77, 8192
    ds_read_b128 v[56:59], v98 offset:45056
    ds_read_b128 v[60:63], v99 offset:45056
    v_add_f32 v84, 1.0, v84
    v_mfma_f32_16x16x32_bf16 v[48:51], a[16:19], v[64:67], v[48:51]
    buffer_load_dwordx4 v15, s[48:51], s77 offen lds
    v_add_f32 v85, 1.0, v85
    v_mfma_f32_16x16x32_bf16 v[48:51], a[24:27], v[68:71], v[48:51]
    s_add_u32 m0, s3, 137216
    v_rcp_f32 v83, v83
    v_mfma_f32_16x16x32_bf16 v[52:55], a[28:31], v[68:71], v[52:55]
    s_waitcnt lgkmcnt(2)
    v_rcp_f32 v84, v84
    v_mul_f32 v83, v83, v35
    v_mfma_f32_16x16x32_bf16 v[52:55], a[36:39], v[72:75], v[52:55]
    s_add_u32 s77, s77, 8192
    ds_read_b128 v[64:67], v96 offset:53248
    ds_read_b128 v[68:71], v97 offset:53248
    v_cvt_pk_bf16_f32 v93, v82, v83
    v_mfma_f32_16x16x32_bf16 v[48:51], a[32:35], v[72:75], v[48:51]
    buffer_load_dwordx4 v15, s[48:51], s77 offen lds
    v_mul_f32 v84, v84, v36
    v_mfma_f32_16x16x32_bf16 v[48:51], a[40:43], v[76:79], v[48:51]
    s_add_u32 m0, s3, 138240
    v_rcp_f32 v85, v85
    v_exp_f32 v86, -v38
    v_mfma_f32_16x16x32_bf16 v[52:55], a[44:47], v[76:79], v[52:55]
    s_waitcnt lgkmcnt(2)
    v_exp_f32 v87, -v39
    v_mul_f32 v85, v85, v37
    v_mfma_f32_16x16x32_bf16 v[52:55], a[52:55], v[56:59], v[52:55]
    s_add_u32 s77, s77, 8192
    ds_read_b128 v[72:75], v98 offset:53248
    ds_read_b128 v[76:79], v99 offset:53248
    v_cvt_pk_bf16_f32 v94, v84, v85
    v_mfma_f32_16x16x32_bf16 v[48:51], a[48:51], v[56:59], v[48:51]
    buffer_load_dwordx4 v15, s[48:51], s77 offen lds
    v_add_f32 v86, 1.0, v86
    v_mfma_f32_16x16x32_bf16 v[48:51], a[56:59], v[60:63], v[48:51]
    v_rcp_f32 v86, v86
    v_add_f32 v87, 1.0, v87
    v_mfma_f32_16x16x32_bf16 v[52:55], a[60:63], v[60:63], v[52:55]
    s_waitcnt lgkmcnt(2)
    v_rcp_f32 v87, v87
    v_mul_f32 v86, v86, v38
    v_mfma_f32_16x16x32_bf16 v[52:55], a[68:71], v[64:67], v[52:55]
    s_add_u32 m0, s3, 0
    ds_read_b128 v[56:59], v96 offset:61440
    ds_read_b128 v[60:63], v97 offset:61440
    v_mul_f32 v87, v87, v39
    v_mfma_f32_16x16x32_bf16 v[48:51], a[64:67], v[64:67], v[48:51]
    s_lshl_b32 s77, s39, 5
    v_xor_b32 v96, 0x10000, v96
    v_xor_b32 v97, 0x10000, v97
    v_cvt_pk_bf16_f32 v95, v86, v87
    v_mfma_f32_16x16x32_bf16 v[48:51], a[72:75], v[68:71], v[48:51]
    s_mov_b32 s75, 57344
    buffer_load_dwordx4 v15, s[48:51], s77 offen lds
    buffer_store_dwordx4 v[92:95], v6, s[60:63], s75 offen sc1
    v_mfma_f32_16x16x32_bf16 v[52:55], a[76:79], v[68:71], v[52:55]
    s_waitcnt lgkmcnt(2)
    v_exp_f32 v80, -v40
    v_mfma_f32_16x16x32_bf16 v[52:55], a[84:87], v[72:75], v[52:55]
    ds_read_b128 v[64:67], v98 offset:61440
    ds_read_b128 v[68:71], v99 offset:61440
    v_add_f32 v80, 1.0, v80
    v_mfma_f32_16x16x32_bf16 v[48:51], a[80:83], v[72:75], v[48:51]
    v_xor_b32 v98, 0x10000, v98
    v_xor_b32 v99, 0x10000, v99
    v_mfma_f32_16x16x32_bf16 v[48:51], a[88:91], v[76:79], v[48:51]
    s_add_u32 m0, s3, 1024
    v_rcp_f32 v80, v80
    v_mfma_f32_16x16x32_bf16 v[52:55], a[92:95], v[76:79], v[52:55]
    s_waitcnt lgkmcnt(2)
    v_exp_f32 v81, -v41
    v_mul_f32 v80, v80, v40
    v_mfma_f32_16x16x32_bf16 v[52:55], a[100:103], v[56:59], v[52:55]
    s_add_u32 s77, s77, 8192
    ds_read_b128 v[72:75], v96 offset:0
    ds_read_b128 v[76:79], v97 offset:0
    v_mfma_f32_16x16x32_bf16 v[48:51], a[96:99], v[56:59], v[48:51]
    buffer_load_dwordx4 v15, s[48:51], s77 offen lds
    v_add_f32 v81, 1.0, v81
    v_mfma_f32_16x16x32_bf16 v[48:51], a[104:107], v[60:63], v[48:51]
    v_rcp_f32 v81, v81
    v_mfma_f32_16x16x32_bf16 v[52:55], a[108:111], v[60:63], v[52:55]
    s_waitcnt lgkmcnt(2)
    v_exp_f32 v82, -v42
    v_mfma_f32_16x16x32_bf16 v[52:55], a[116:119], v[64:67], v[52:55]
    s_add_u32 m0, s3, 2048
    ds_read_b128 v[56:59], v98 offset:0
    ds_read_b128 v[60:63], v99 offset:0
    v_mul_f32 v81, v81, v41
    v_mfma_f32_16x16x32_bf16 v[48:51], a[112:115], v[64:67], v[48:51]
    s_add_u32 s77, s77, 8192
    v_exp_f32 v83, -v43
    v_mfma_f32_16x16x32_bf16 v[48:51], a[120:123], v[68:71], v[48:51]
    buffer_load_dwordx4 v15, s[48:51], s77 offen lds
    v_mfma_f32_16x16x32_bf16 v[52:55], a[124:127], v[68:71], v[52:55]
    s_waitcnt lgkmcnt(2)
    v_exp_f32 v84, -v44
    v_cvt_pk_bf16_f32 v88, v80, v81
    v_mfma_f32_16x16x32_bf16 v[28:31], a[4:7], v[72:75], 0
    ds_read_b128 v[64:67], v96 offset:8192
    ds_read_b128 v[68:71], v97 offset:8192
    v_mfma_f32_16x16x32_bf16 v[24:27], a[0:3], v[72:75], 0
    v_exp_f32 v85, -v45
    v_add_f32 v82, 1.0, v82
    v_mfma_f32_16x16x32_bf16 v[24:27], a[8:11], v[76:79], v[24:27]
    s_add_u32 m0, s3, 3072
    v_rcp_f32 v82, v82
    v_mfma_f32_16x16x32_bf16 v[28:31], a[12:15], v[76:79], v[28:31]
    s_waitcnt lgkmcnt(2)
    v_exp_f32 v86, -v46
    v_mfma_f32_16x16x32_bf16 v[28:31], a[20:23], v[56:59], v[28:31]
    s_add_u32 s77, s77, 8192
    ds_read_b128 v[72:75], v98 offset:8192
    ds_read_b128 v[76:79], v99 offset:8192
    v_mul_f32 v82, v82, v42
    v_mfma_f32_16x16x32_bf16 v[24:27], a[16:19], v[56:59], v[24:27]
    buffer_load_dwordx4 v15, s[48:51], s77 offen lds
    v_mfma_f32_16x16x32_bf16 v[24:27], a[24:27], v[60:63], v[24:27]
    v_exp_f32 v87, -v47
    v_mfma_f32_16x16x32_bf16 v[28:31], a[28:31], v[60:63], v[28:31]
    s_waitcnt lgkmcnt(2)
    v_add_f32 v83, 1.0, v83
    v_add_f32 v84, 1.0, v84
    v_add_f32 v85, 1.0, v85
    v_mfma_f32_16x16x32_bf16 v[28:31], a[36:39], v[64:67], v[28:31]
    s_add_u32 m0, s3, 4096
    ds_read_b128 v[56:59], v96 offset:16384
    ds_read_b128 v[60:63], v97 offset:16384
    v_mfma_f32_16x16x32_bf16 v[24:27], a[32:35], v[64:67], v[24:27]
    s_lshl_b32 s77, s40, 5
    v_rcp_f32 v83, v83
    v_add_f32 v86, 1.0, v86
    v_mfma_f32_16x16x32_bf16 v[24:27], a[40:43], v[68:71], v[24:27]
    buffer_load_dwordx4 v15, s[48:51], s77 offen lds
    v_mfma_f32_16x16x32_bf16 v[28:31], a[44:47], v[68:71], v[28:31]
    s_waitcnt lgkmcnt(2)
    v_rcp_f32 v84, v84
    v_mfma_f32_16x16x32_bf16 v[28:31], a[52:55], v[72:75], v[28:31]
    ds_read_b128 v[64:67], v98 offset:16384
    ds_read_b128 v[68:71], v99 offset:16384
    v_mul_f32 v83, v83, v43
    v_mfma_f32_16x16x32_bf16 v[24:27], a[48:51], v[72:75], v[24:27]
    v_rcp_f32 v85, v85
    v_mfma_f32_16x16x32_bf16 v[24:27], a[56:59], v[76:79], v[24:27]
    s_add_u32 m0, s3, 5120
    v_rcp_f32 v86, v86
    v_mfma_f32_16x16x32_bf16 v[28:31], a[60:63], v[76:79], v[28:31]
    s_waitcnt lgkmcnt(2)
    v_cvt_pk_bf16_f32 v89, v82, v83
    v_mul_f32 v84, v84, v44
    v_mul_f32 v85, v85, v45
    v_mfma_f32_16x16x32_bf16 v[28:31], a[68:71], v[56:59], v[28:31]
    s_add_u32 s77, s77, 8192
    ds_read_b128 v[72:75], v96 offset:24576
    ds_read_b128 v[76:79], v97 offset:24576
    v_mfma_f32_16x16x32_bf16 v[24:27], a[64:67], v[56:59], v[24:27]
    buffer_load_dwordx4 v15, s[48:51], s77 offen lds
    v_cvt_pk_bf16_f32 v90, v84, v85
    v_mfma_f32_16x16x32_bf16 v[24:27], a[72:75], v[60:63], v[24:27]
    v_mul_f32 v86, v86, v46
    v_add_f32 v87, 1.0, v87
    v_mfma_f32_16x16x32_bf16 v[28:31], a[76:79], v[60:63], v[28:31]
    s_waitcnt lgkmcnt(2)
    v_rcp_f32 v87, v87
    v_mfma_f32_16x16x32_bf16 v[28:31], a[84:87], v[64:67], v[28:31]
    s_add_u32 m0, s3, 6144
    ds_read_b128 v[56:59], v98 offset:24576
    ds_read_b128 v[60:63], v99 offset:24576
    v_mul_f32 v87, v87, v47
    v_mfma_f32_16x16x32_bf16 v[24:27], a[80:83], v[64:67], v[24:27]
    s_add_u32 s77, s77, 8192
    v_cvt_pk_bf16_f32 v91, v86, v87
    v_mfma_f32_16x16x32_bf16 v[24:27], a[88:91], v[68:71], v[24:27]
    s_waitcnt vmcnt(11)
    s_barrier
    v_mfma_f32_16x16x32_bf16 v[28:31], a[92:95], v[68:71], v[28:31]
    s_waitcnt lgkmcnt(2)
    buffer_load_dwordx4 v15, s[48:51], s77 offen lds
    v_mfma_f32_16x16x32_bf16 v[28:31], a[100:103], v[72:75], v[28:31]
    ds_read_b128 v[64:67], v96 offset:4096
    ds_read_b128 v[68:71], v97 offset:4096
    v_mfma_f32_16x16x32_bf16 v[24:27], a[96:99], v[72:75], v[24:27]
    s_mov_b32 s75, 114688
    buffer_store_dwordx4 v[88:91], v6, s[60:63], s75 offen sc1
    v_or_b32 v16, 4, v17
    v_mfma_f32_16x16x32_bf16 v[24:27], a[104:107], v[76:79], v[24:27]
    s_add_u32 m0, s3, 7168
    v_exp_f32 v80, -v48
    v_mfma_f32_16x16x32_bf16 v[28:31], a[108:111], v[76:79], v[28:31]
    s_waitcnt lgkmcnt(2)
    v_exp_f32 v81, -v49
    v_add_f32 v80, 1.0, v80
    v_mfma_f32_16x16x32_bf16 v[28:31], a[116:119], v[56:59], v[28:31]
    s_add_u32 s77, s77, 8192
    ds_read_b128 v[72:75], v98 offset:4096
    ds_read_b128 v[76:79], v99 offset:4096
    v_mfma_f32_16x16x32_bf16 v[24:27], a[112:115], v[56:59], v[24:27]
    buffer_load_dwordx4 v15, s[48:51], s77 offen lds
    v_mfma_f32_16x16x32_bf16 v[24:27], a[120:123], v[60:63], v[24:27]
    v_rcp_f32 v80, v80
    v_add_f32 v81, 1.0, v81
    v_mfma_f32_16x16x32_bf16 v[28:31], a[124:127], v[60:63], v[28:31]
    s_waitcnt lgkmcnt(2)
    v_rcp_f32 v81, v81
    v_mfma_f32_16x16x32_bf16 v[36:39], a[4:7], v[64:67], 0
    s_add_u32 m0, s3, 32768
    ds_read_b128 v[56:59], v96 offset:12288
    ds_read_b128 v[60:63], v97 offset:12288
    v_mul_f32 v80, v80, v48
    v_mfma_f32_16x16x32_bf16 v[32:35], a[0:3], v[64:67], 0
    s_lshl_b32 s77, s41, 5
    v_exp_f32 v82, -v50
    v_mfma_f32_16x16x32_bf16 v[32:35], a[8:11], v[68:71], v[32:35]
    buffer_load_dwordx4 v15, s[48:51], s77 offen lds
    v_mfma_f32_16x16x32_bf16 v[36:39], a[12:15], v[68:71], v[36:39]
    s_waitcnt lgkmcnt(2)
    v_exp_f32 v83, -v51
    v_mul_f32 v81, v81, v49
    v_mfma_f32_16x16x32_bf16 v[36:39], a[20:23], v[72:75], v[36:39]
    ds_read_b128 v[64:67], v98 offset:12288
    ds_read_b128 v[68:71], v99 offset:12288
    v_mfma_f32_16x16x32_bf16 v[32:35], a[16:19], v[72:75], v[32:35]
    v_exp_f32 v84, -v52
    v_mfma_f32_16x16x32_bf16 v[32:35], a[24:27], v[76:79], v[32:35]
    s_add_u32 m0, s3, 33792
    v_exp_f32 v85, -v53
    v_cvt_pk_bf16_f32 v92, v80, v81
    v_mfma_f32_16x16x32_bf16 v[36:39], a[28:31], v[76:79], v[36:39]
    s_waitcnt lgkmcnt(2)
    v_exp_f32 v86, -v54
    v_mfma_f32_16x16x32_bf16 v[36:39], a[36:39], v[56:59], v[36:39]
    s_add_u32 s77, s77, 8192
    ds_read_b128 v[72:75], v96 offset:20480
    ds_read_b128 v[76:79], v97 offset:20480
    v_add_f32 v82, 1.0, v82
    v_mfma_f32_16x16x32_bf16 v[32:35], a[32:35], v[56:59], v[32:35]
    buffer_load_dwordx4 v15, s[48:51], s77 offen lds
    v_mfma_f32_16x16x32_bf16 v[32:35], a[40:43], v[60:63], v[32:35]
    v_rcp_f32 v82, v82
    v_mfma_f32_16x16x32_bf16 v[36:39], a[44:47], v[60:63], v[36:39]
    s_waitcnt lgkmcnt(2)
    v_exp_f32 v87, -v55
    v_mul_f32 v82, v82, v50
    v_mfma_f32_16x16x32_bf16 v[36:39], a[52:55], v[64:67], v[36:39]
    s_add_u32 m0, s3, 34816
    ds_read_b128 v[56:59], v98 offset:20480
    ds_read_b128 v[60:63], v99 offset:20480
    v_mfma_f32_16x16x32_bf16 v[32:35], a[48:51], v[64:67], v[32:35]
    s_add_u32 s77, s77, 8192
    v_add_f32 v83, 1.0, v83
    v_add_f32 v84, 1.0, v84
    v_mfma_f32_16x16x32_bf16 v[32:35], a[56:59], v[68:71], v[32:35]
    buffer_load_dwordx4 v15, s[48:51], s77 offen lds
    v_add_f32 v85, 1.0, v85
    v_mfma_f32_16x16x32_bf16 v[36:39], a[60:63], v[68:71], v[36:39]
    s_waitcnt lgkmcnt(2)
    v_rcp_f32 v83, v83
    v_mfma_f32_16x16x32_bf16 v[36:39], a[68:71], v[72:75], v[36:39]
    ds_read_b128 v[64:67], v96 offset:28672
    ds_read_b128 v[68:71], v97 offset:28672
    v_mul_f32 v83, v83, v51
    v_mfma_f32_16x16x32_bf16 v[32:35], a[64:67], v[72:75], v[32:35]
    s_waitcnt vmcnt(11)
    buffer_store_dword v16, v3, s[60:63], 0 offen sc1
    v_mfma_f32_16x16x32_bf16 v[32:35], a[72:75], v[76:79], v[32:35]
    s_add_u32 m0, s3, 35840
    v_rcp_f32 v84, v84
    v_mfma_f32_16x16x32_bf16 v[36:39], a[76:79], v[76:79], v[36:39]
    s_waitcnt lgkmcnt(2)
    v_rcp_f32 v85, v85
    v_cvt_pk_bf16_f32 v93, v82, v83
    v_mfma_f32_16x16x32_bf16 v[36:39], a[84:87], v[56:59], v[36:39]
    s_add_u32 s77, s77, 8192
    ds_read_b128 v[72:75], v98 offset:28672
    ds_read_b128 v[76:79], v99 offset:28672
    v_mfma_f32_16x16x32_bf16 v[32:35], a[80:83], v[56:59], v[32:35]
    buffer_load_dwordx4 v15, s[48:51], s77 offen lds
    v_mfma_f32_16x16x32_bf16 v[32:35], a[88:91], v[60:63], v[32:35]
    v_mul_f32 v84, v84, v52
    v_mul_f32 v85, v85, v53
    v_add_f32 v86, 1.0, v86
    v_mfma_f32_16x16x32_bf16 v[36:39], a[92:95], v[60:63], v[36:39]
    s_waitcnt lgkmcnt(2)
    v_rcp_f32 v86, v86
    v_mfma_f32_16x16x32_bf16 v[36:39], a[100:103], v[64:67], v[36:39]
    ds_read_b128 v[56:59], v96 offset:32768
    ds_read_b128 v[60:63], v97 offset:32768
    v_cvt_pk_bf16_f32 v94, v84, v85
    v_mfma_f32_16x16x32_bf16 v[32:35], a[96:99], v[64:67], v[32:35]
    v_mul_f32 v86, v86, v54
    v_add_f32 v87, 1.0, v87
    v_mfma_f32_16x16x32_bf16 v[32:35], a[104:107], v[68:71], v[32:35]
    v_rcp_f32 v87, v87
    v_mfma_f32_16x16x32_bf16 v[36:39], a[108:111], v[68:71], v[36:39]
    s_waitcnt lgkmcnt(2)
    v_mul_f32 v87, v87, v55
    v_mfma_f32_16x16x32_bf16 v[36:39], a[116:119], v[72:75], v[36:39]
    ds_read_b128 v[64:67], v98 offset:32768
    ds_read_b128 v[68:71], v99 offset:32768
    v_mfma_f32_16x16x32_bf16 v[32:35], a[112:115], v[72:75], v[32:35]
    v_cvt_pk_bf16_f32 v95, v86, v87
    v_mfma_f32_16x16x32_bf16 v[32:35], a[120:123], v[76:79], v[32:35]
    s_mov_b32 s75, 172032
    buffer_store_dwordx4 v[92:95], v6, s[60:63], s75 offen sc1
    v_mfma_f32_16x16x32_bf16 v[36:39], a[124:127], v[76:79], v[36:39]
    s_waitcnt lgkmcnt(2)
    v_or_b32 v16, 5, v17
    v_mfma_f32_16x16x32_bf16 v[44:47], a[4:7], v[56:59], 0
    ds_read_b128 v[72:75], v96 offset:40960
    ds_read_b128 v[76:79], v97 offset:40960
    v_mfma_f32_16x16x32_bf16 v[40:43], a[0:3], v[56:59], 0
    v_exp_f32 v80, -v24
    v_mfma_f32_16x16x32_bf16 v[40:43], a[8:11], v[60:63], v[40:43]
    v_exp_f32 v81, -v25
    v_mfma_f32_16x16x32_bf16 v[44:47], a[12:15], v[60:63], v[44:47]
    s_waitcnt lgkmcnt(2)
    v_exp_f32 v82, -v26
    v_mfma_f32_16x16x32_bf16 v[44:47], a[20:23], v[64:67], v[44:47]
    ds_read_b128 v[56:59], v98 offset:40960
    ds_read_b128 v[60:63], v99 offset:40960
    v_mfma_f32_16x16x32_bf16 v[40:43], a[16:19], v[64:67], v[40:43]
    v_exp_f32 v83, -v27
    v_add_f32 v80, 1.0, v80
    v_mfma_f32_16x16x32_bf16 v[40:43], a[24:27], v[68:71], v[40:43]
    v_rcp_f32 v80, v80
    v_mfma_f32_16x16x32_bf16 v[44:47], a[28:31], v[68:71], v[44:47]
    s_waitcnt lgkmcnt(2)
    v_exp_f32 v84, -v28
    v_mfma_f32_16x16x32_bf16 v[44:47], a[36:39], v[72:75], v[44:47]
    ds_read_b128 v[64:67], v96 offset:49152
    ds_read_b128 v[68:71], v97 offset:49152
    v_mfma_f32_16x16x32_bf16 v[40:43], a[32:35], v[72:75], v[40:43]
    v_exp_f32 v85, -v29
    v_mul_f32 v80, v80, v24
    v_mfma_f32_16x16x32_bf16 v[40:43], a[40:43], v[76:79], v[40:43]
    v_exp_f32 v86, -v30
    v_mfma_f32_16x16x32_bf16 v[44:47], a[44:47], v[76:79], v[44:47]
    s_waitcnt lgkmcnt(2)
    v_exp_f32 v87, -v31
    v_mfma_f32_16x16x32_bf16 v[44:47], a[52:55], v[56:59], v[44:47]
    ds_read_b128 v[72:75], v98 offset:49152
    ds_read_b128 v[76:79], v99 offset:49152
    v_mfma_f32_16x16x32_bf16 v[40:43], a[48:51], v[56:59], v[40:43]
    v_add_f32 v81, 1.0, v81
    v_add_f32 v82, 1.0, v82
    v_add_f32 v83, 1.0, v83
    v_mfma_f32_16x16x32_bf16 v[40:43], a[56:59], v[60:63], v[40:43]
    v_rcp_f32 v81, v81
    v_mfma_f32_16x16x32_bf16 v[44:47], a[60:63], v[60:63], v[44:47]
    s_waitcnt lgkmcnt(2)
    v_rcp_f32 v82, v82
    v_mfma_f32_16x16x32_bf16 v[44:47], a[68:71], v[64:67], v[44:47]
    ds_read_b128 v[56:59], v96 offset:57344
    ds_read_b128 v[60:63], v97 offset:57344
    v_mfma_f32_16x16x32_bf16 v[40:43], a[64:67], v[64:67], v[40:43]
    v_rcp_f32 v83, v83
    v_mul_f32 v81, v81, v25
    v_mfma_f32_16x16x32_bf16 v[40:43], a[72:75], v[68:71], v[40:43]
    v_cvt_pk_bf16_f32 v88, v80, v81
    v_mul_f32 v82, v82, v26
    v_mfma_f32_16x16x32_bf16 v[44:47], a[76:79], v[68:71], v[44:47]
    s_waitcnt lgkmcnt(2)
    v_mul_f32 v83, v83, v27
    v_add_f32 v84, 1.0, v84
    v_mfma_f32_16x16x32_bf16 v[44:47], a[84:87], v[72:75], v[44:47]
    ds_read_b128 v[64:67], v98 offset:57344
    ds_read_b128 v[68:71], v99 offset:57344
    v_mfma_f32_16x16x32_bf16 v[40:43], a[80:83], v[72:75], v[40:43]
    v_rcp_f32 v84, v84
    v_cvt_pk_bf16_f32 v89, v82, v83
    v_mfma_f32_16x16x32_bf16 v[40:43], a[88:91], v[76:79], v[40:43]
    v_mul_f32 v84, v84, v28
    v_add_f32 v85, 1.0, v85
    v_mfma_f32_16x16x32_bf16 v[44:47], a[92:95], v[76:79], v[44:47]
    s_waitcnt lgkmcnt(2)
    s_add_u32 s70, s69, 4
    buffer_load_dword v2, v4, s[60:63], 0 offen sc1
    v_mfma_f32_16x16x32_bf16 v[44:47], a[100:103], v[56:59], v[44:47]
    ds_read_b128 v[72:75], v96 offset:36864
    ds_read_b128 v[76:79], v97 offset:36864
    v_mfma_f32_16x16x32_bf16 v[40:43], a[96:99], v[56:59], v[40:43]
    v_rcp_f32 v85, v85
    v_add_f32 v86, 1.0, v86
    v_mfma_f32_16x16x32_bf16 v[40:43], a[104:107], v[60:63], v[40:43]
    v_rcp_f32 v86, v86
    v_mfma_f32_16x16x32_bf16 v[44:47], a[108:111], v[60:63], v[44:47]
    s_waitcnt lgkmcnt(2)
    v_mul_f32 v85, v85, v29
    v_mul_f32 v86, v86, v30
    v_mfma_f32_16x16x32_bf16 v[44:47], a[116:119], v[64:67], v[44:47]
    ds_read_b128 v[56:59], v98 offset:36864
    ds_read_b128 v[60:63], v99 offset:36864
    v_mfma_f32_16x16x32_bf16 v[40:43], a[112:115], v[64:67], v[40:43]
    v_cvt_pk_bf16_f32 v90, v84, v85
    v_add_f32 v87, 1.0, v87
    v_mfma_f32_16x16x32_bf16 v[40:43], a[120:123], v[68:71], v[40:43]
    v_rcp_f32 v87, v87
    v_mfma_f32_16x16x32_bf16 v[44:47], a[124:127], v[68:71], v[44:47]
    s_waitcnt lgkmcnt(2)
    v_mul_f32 v87, v87, v31
    v_mfma_f32_16x16x32_bf16 v[52:55], a[4:7], v[72:75], 0
    ds_read_b128 v[64:67], v96 offset:45056
    ds_read_b128 v[68:71], v97 offset:45056
    v_mfma_f32_16x16x32_bf16 v[48:51], a[0:3], v[72:75], 0
    v_cvt_pk_bf16_f32 v91, v86, v87
    v_mfma_f32_16x16x32_bf16 v[48:51], a[8:11], v[76:79], v[48:51]
    s_mov_b32 s75, 229376
    buffer_store_dwordx4 v[88:91], v6, s[60:63], s75 offen sc1
    v_mfma_f32_16x16x32_bf16 v[52:55], a[12:15], v[76:79], v[52:55]
    s_waitcnt lgkmcnt(2)
    v_exp_f32 v80, -v32
    v_mfma_f32_16x16x32_bf16 v[52:55], a[20:23], v[56:59], v[52:55]
    ds_read_b128 v[72:75], v98 offset:45056
    ds_read_b128 v[76:79], v99 offset:45056
    v_add_f32 v80, 1.0, v80
    v_mfma_f32_16x16x32_bf16 v[48:51], a[16:19], v[56:59], v[48:51]
    s_waitcnt vmcnt(2)
    buffer_store_dword v16, v3, s[60:63], 0 offen sc1
    v_mfma_f32_16x16x32_bf16 v[48:51], a[24:27], v[60:63], v[48:51]
    v_rcp_f32 v80, v80
    v_mfma_f32_16x16x32_bf16 v[52:55], a[28:31], v[60:63], v[52:55]
    s_waitcnt lgkmcnt(2)
    v_exp_f32 v81, -v33
    v_mul_f32 v80, v80, v32
    v_mfma_f32_16x16x32_bf16 v[52:55], a[36:39], v[64:67], v[52:55]
    ds_read_b128 v[56:59], v96 offset:53248
    ds_read_b128 v[60:63], v97 offset:53248
    v_add_f32 v81, 1.0, v81
    v_mfma_f32_16x16x32_bf16 v[48:51], a[32:35], v[64:67], v[48:51]
    s_waitcnt vmcnt(2)
    v_subrev_u32 v2, s70, v2
    v_cmp_le_u32 vcc, 16, v2
    v_rcp_f32 v81, v81
    v_mfma_f32_16x16x32_bf16 v[48:51], a[40:43], v[68:71], v[48:51]
    s_cbranch_vccnz L_slow_88
L_back_89:
    v_mfma_f32_16x16x32_bf16 v[52:55], a[44:47], v[68:71], v[52:55]
    s_waitcnt lgkmcnt(2)
    v_mov_b32 v20, -1
    v_mov_b32 v21, -1
    v_mul_f32 v81, v81, v33
    v_mfma_f32_16x16x32_bf16 v[52:55], a[52:55], v[72:75], v[52:55]
    ds_read_b128 v[64:67], v98 offset:53248
    ds_read_b128 v[68:71], v99 offset:53248
    v_cvt_pk_bf16_f32 v92, v80, v81
    v_mfma_f32_16x16x32_bf16 v[48:51], a[48:51], v[72:75], v[48:51]
    v_mov_b32 v22, -1
    v_mov_b32 v23, -1
    v_exp_f32 v82, -v34
    v_mfma_f32_16x16x32_bf16 v[48:51], a[56:59], v[76:79], v[48:51]
    buffer_store_dwordx4 v[20:23], v7, s[60:63], 0 offen sc1
    v_mfma_f32_16x16x32_bf16 v[52:55], a[60:63], v[76:79], v[52:55]
    s_waitcnt lgkmcnt(2)
    buffer_store_dwordx4 v[20:23], v7, s[60:63], s86 offen sc1
    v_mfma_f32_16x16x32_bf16 v[52:55], a[68:71], v[56:59], v[52:55]
    ds_read_b128 v[72:75], v96 offset:61440
    ds_read_b128 v[76:79], v97 offset:61440
    v_add_f32 v82, 1.0, v82
    v_mfma_f32_16x16x32_bf16 v[48:51], a[64:67], v[56:59], v[48:51]
    v_xor_b32 v96, 0x10000, v96
    v_xor_b32 v97, 0x10000, v97
    v_rcp_f32 v82, v82
    v_mfma_f32_16x16x32_bf16 v[48:51], a[72:75], v[60:63], v[48:51]
    buffer_load_dwordx4 v[100:103], v13, s[60:63], s28 offen sc1
    v_mul_f32 v82, v82, v34
    v_mfma_f32_16x16x32_bf16 v[52:55], a[76:79], v[60:63], v[52:55]
    s_waitcnt lgkmcnt(2)
    v_exp_f32 v83, -v35
    v_mfma_f32_16x16x32_bf16 v[52:55], a[84:87], v[64:67], v[52:55]
    ds_read_b128 v[56:59], v98 offset:61440
    ds_read_b128 v[60:63], v99 offset:61440
    v_add_f32 v83, 1.0, v83
    v_mfma_f32_16x16x32_bf16 v[48:51], a[80:83], v[64:67], v[48:51]
    v_xor_b32 v98, 0x10000, v98
    v_xor_b32 v99, 0x10000, v99
    v_rcp_f32 v83, v83
    v_mfma_f32_16x16x32_bf16 v[48:51], a[88:91], v[68:71], v[48:51]
    buffer_load_dwordx4 v[104:107], v13, s[60:63], s29 offen sc1
    v_mul_f32 v83, v83, v35
    v_mfma_f32_16x16x32_bf16 v[52:55], a[92:95], v[68:71], v[52:55]
    s_waitcnt lgkmcnt(2)
    v_exp_f32 v84, -v36
    v_cvt_pk_bf16_f32 v93, v82, v83
    v_mfma_f32_16x16x32_bf16 v[52:55], a[100:103], v[72:75], v[52:55]
    v_exp_f32 v85, -v37
    v_add_f32 v84, 1.0, v84
    v_mfma_f32_16x16x32_bf16 v[48:51], a[96:99], v[72:75], v[48:51]
    v_rcp_f32 v84, v84
    v_exp_f32 v86, -v38
    v_mfma_f32_16x16x32_bf16 v[48:51], a[104:107], v[76:79], v[48:51]
    buffer_load_dwordx4 v[108:111], v13, s[60:63], s30 offen sc1
    v_mul_f32 v84, v84, v36
    v_mfma_f32_16x16x32_bf16 v[52:55], a[108:111], v[76:79], v[52:55]
    s_waitcnt lgkmcnt(0)
    v_exp_f32 v87, -v39
    v_add_f32 v85, 1.0, v85
    v_mfma_f32_16x16x32_bf16 v[52:55], a[116:119], v[56:59], v[52:55]
    v_rcp_f32 v85, v85
    v_add_f32 v86, 1.0, v86
    v_mfma_f32_16x16x32_bf16 v[48:51], a[112:115], v[56:59], v[48:51]
    v_rcp_f32 v86, v86
    v_mul_f32 v85, v85, v37
    v_add_f32 v87, 1.0, v87
    v_mfma_f32_16x16x32_bf16 v[48:51], a[120:123], v[60:63], v[48:51]
    buffer_load_dwordx4 v[112:115], v13, s[60:63], s31 offen sc1
    v_cvt_pk_bf16_f32 v94, v84, v85
    v_mfma_f32_16x16x32_bf16 v[52:55], a[124:127], v[60:63], v[52:55]
    v_rcp_f32 v87, v87
    v_mul_f32 v86, v86, v38
    v_mul_f32 v87, v87, v39
    buffer_load_dwordx4 v[116:119], v13, s[60:63], s32 offen sc1
    v_cvt_pk_bf16_f32 v95, v86, v87
    s_mov_b32 s75, 286720
    buffer_store_dwordx4 v[92:95], v6, s[60:63], s75 offen sc1
    v_or_b32 v16, 6, v17
    buffer_load_dwordx4 v[120:123], v13, s[60:63], s33 offen sc1
    v_exp_f32 v80, -v40
    v_exp_f32 v81, -v41
    v_exp_f32 v82, -v42
    v_exp_f32 v83, -v43
    v_exp_f32 v84, -v44
    v_exp_f32 v85, -v45
    v_add_f32 v80, 1.0, v80
    v_add_f32 v81, 1.0, v81
    buffer_load_dwordx4 v[124:127], v13, s[60:63], s34 offen sc1
    v_rcp_f32 v80, v80
    v_add_f32 v82, 1.0, v82
    v_add_f32 v83, 1.0, v83
    v_mul_f32 v80, v80, v40
    v_add_f32 v84, 1.0, v84
    v_rcp_f32 v81, v81
    v_rcp_f32 v82, v82
    v_rcp_f32 v83, v83
    v_mul_f32 v81, v81, v41
    v_mul_f32 v82, v82, v42
    buffer_load_dwordx4 v[128:131], v13, s[60:63], s35 offen sc1
    v_rcp_f32 v84, v84
    v_exp_f32 v86, -v46
    v_cvt_pk_bf16_f32 v88, v80, v81
    v_mul_f32 v83, v83, v43
    s_add_u32 s70, s69, 5
    buffer_load_dword v2, v4, s[60:63], 0 offen sc1
    v_exp_f32 v87, -v47
    v_cvt_pk_bf16_f32 v89, v82, v83
    v_mul_f32 v84, v84, v44
    v_add_f32 v85, 1.0, v85
    v_add_f32 v86, 1.0, v86
    buffer_load_dwordx4 v[132:135], v13, s[60:63], s36 offen sc1
    v_rcp_f32 v85, v85
    v_rcp_f32 v86, v86
    v_add_f32 v87, 1.0, v87
    v_mul_f32 v85, v85, v45
    v_rcp_f32 v87, v87
    v_cvt_pk_bf16_f32 v90, v84, v85
    v_mul_f32 v86, v86, v46
    v_mul_f32 v87, v87, v47
    buffer_load_dwordx4 v[136:139], v13, s[60:63], s37 offen sc1
    v_cvt_pk_bf16_f32 v91, v86, v87
    s_mov_b32 s75, 344064
    buffer_store_dwordx4 v[88:91], v6, s[60:63], s75 offen sc1
    ds_read_b64_tr_b16 v[176:177], v18 offset:0
    ds_read_b64_tr_b16 v[178:179], v18 offset:2048
    ds_read_b64_tr_b16 v[180:181], v0 offset:0
    ds_read_b64_tr_b16 v[182:183], v0 offset:2048
    ds_read_b64_tr_b16 v[184:185], v18 offset:64
    ds_read_b64_tr_b16 v[186:187], v18 offset:2112
    ds_read_b64_tr_b16 v[188:189], v0 offset:64
    ds_read_b64_tr_b16 v[190:191], v0 offset:2112
    ds_read_b64_tr_b16 v[192:193], v18 offset:4096
    ds_read_b64_tr_b16 v[194:195], v18 offset:6144
    ds_read_b64_tr_b16 v[196:197], v0 offset:4096
    ds_read_b64_tr_b16 v[198:199], v0 offset:6144
    ds_read_b64_tr_b16 v[200:201], v18 offset:4160
    ds_read_b64_tr_b16 v[202:203], v18 offset:6208
    ds_read_b64_tr_b16 v[204:205], v0 offset:4160
    ds_read_b64_tr_b16 v[206:207], v0 offset:6208
    ds_read_b64_tr_b16 v[208:209], v9 offset:0
    ds_read_b64_tr_b16 v[210:211], v9 offset:2048
    ds_read_b64_tr_b16 v[212:213], v10 offset:0
    ds_read_b64_tr_b16 v[214:215], v10 offset:2048
    ds_read_b64_tr_b16 v[216:217], v9 offset:64
    ds_read_b64_tr_b16 v[218:219], v9 offset:2112
    ds_read_b64_tr_b16 v[220:221], v10 offset:64
    ds_read_b64_tr_b16 v[222:223], v10 offset:2112
    ds_read_b64_tr_b16 v[224:225], v9 offset:4096
    ds_read_b64_tr_b16 v[226:227], v9 offset:6144
    ds_read_b64_tr_b16 v[228:229], v10 offset:4096
    ds_read_b64_tr_b16 v[230:231], v10 offset:6144
    ds_read_b64_tr_b16 v[232:233], v9 offset:4160
    ds_read_b64_tr_b16 v[234:235], v9 offset:6208
    ds_read_b64_tr_b16 v[236:237], v10 offset:4160
    ds_read_b64_tr_b16 v[238:239], v10 offset:6208
    ds_read_b64_tr_b16 v[240:241], v9 offset:32768
    ds_read_b64_tr_b16 v[242:243], v9 offset:34816
    ds_read_b64_tr_b16 v[244:245], v10 offset:32768
    ds_read_b64_tr_b16 v[246:247], v10 offset:34816
    ds_read_b64_tr_b16 v[248:249], v9 offset:32832
    ds_read_b64_tr_b16 v[250:251], v9 offset:34880
    ds_read_b64_tr_b16 v[252:253], v10 offset:32832
    ds_read_b64_tr_b16 v[254:255], v10 offset:34880
    v_exp_f32 v80, -v48
    v_exp_f32 v81, -v49
    v_exp_f32 v82, -v50
    v_exp_f32 v83, -v51
    v_exp_f32 v84, -v52
    v_exp_f32 v85, -v53
    v_add_f32 v80, 1.0, v80
    v_add_f32 v81, 1.0, v81
    v_add_f32 v82, 1.0, v82
    v_add_f32 v83, 1.0, v83
    s_waitcnt vmcnt(12)
    v_rcp_f32 v80, v80
    v_rcp_f32 v81, v81
    v_rcp_f32 v82, v82
    v_mul_f32 v80, v80, v48
    v_mul_f32 v81, v81, v49
L_g2_87:
    v_mfma_f32_16x16x32_bf16 v[76:79], a[140:143], v[100:103], 0
    v_rcp_f32 v83, v83
    v_mfma_f32_16x16x32_bf16 v[72:75], a[136:139], v[100:103], 0
    v_exp_f32 v86, -v54
    v_mfma_f32_16x16x32_bf16 v[68:71], a[132:135], v[100:103], 0
    v_exp_f32 v87, -v55
    v_mfma_f32_16x16x32_bf16 v[64:67], a[128:131], v[100:103], 0
    s_waitcnt vmcnt(11)
    buffer_load_dwordx4 v[100:103], v13, s[60:63], s38 offen sc1
    v_mfma_f32_16x16x32_bf16 v[64:67], a[144:147], v[104:107], v[64:67]
    v_cvt_pk_bf16_f32 v92, v80, v81
    v_mul_f32 v82, v82, v50
    v_mfma_f32_16x16x32_bf16 v[68:71], a[148:151], v[104:107], v[68:71]
    v_mul_f32 v83, v83, v51
    v_add_f32 v84, 1.0, v84
    v_mfma_f32_16x16x32_bf16 v[72:75], a[152:155], v[104:107], v[72:75]
    v_rcp_f32 v84, v84
    v_mfma_f32_16x16x32_bf16 v[76:79], a[156:159], v[104:107], v[76:79]
    s_waitcnt vmcnt(11)
    buffer_load_dwordx4 v[104:107], v13, s[60:63], s39 offen sc1
    v_mfma_f32_16x16x32_bf16 v[76:79], a[172:175], v[108:111], v[76:79]
    v_cvt_pk_bf16_f32 v93, v82, v83
    v_mul_f32 v84, v84, v52
    v_mfma_f32_16x16x32_bf16 v[72:75], a[168:171], v[108:111], v[72:75]
    v_add_f32 v85, 1.0, v85
    v_add_f32 v86, 1.0, v86
    v_mfma_f32_16x16x32_bf16 v[68:71], a[164:167], v[108:111], v[68:71]
    s_waitcnt vmcnt(9)
    buffer_store_dword v16, v3, s[60:63], 0 offen sc1
    v_mfma_f32_16x16x32_bf16 v[64:67], a[160:163], v[108:111], v[64:67]
    buffer_load_dwordx4 v[108:111], v13, s[60:63], s40 offen sc1
    v_mfma_f32_16x16x32_bf16 v[64:67], a[176:179], v[112:115], v[64:67]
    v_rcp_f32 v85, v85
    v_mfma_f32_16x16x32_bf16 v[68:71], a[180:183], v[112:115], v[68:71]
    v_rcp_f32 v86, v86
    v_mfma_f32_16x16x32_bf16 v[72:75], a[184:187], v[112:115], v[72:75]
    v_mul_f32 v85, v85, v53
    v_mul_f32 v86, v86, v54
    v_mfma_f32_16x16x32_bf16 v[76:79], a[188:191], v[112:115], v[76:79]
    buffer_load_dwordx4 v[112:115], v13, s[60:63], s41 offen sc1
    v_add_u32 v13, 114688, v13
    v_mfma_f32_16x16x32_bf16 v[76:79], a[204:207], v[116:119], v[76:79]
    v_cvt_pk_bf16_f32 v94, v84, v85
    v_add_f32 v87, 1.0, v87
    v_mfma_f32_16x16x32_bf16 v[72:75], a[200:203], v[116:119], v[72:75]
    v_rcp_f32 v87, v87
    v_mfma_f32_16x16x32_bf16 v[68:71], a[196:199], v[116:119], v[68:71]
    v_mul_f32 v87, v87, v55
    v_mfma_f32_16x16x32_bf16 v[64:67], a[192:195], v[116:119], v[64:67]
    s_waitcnt vmcnt(11)
    v_cvt_pk_bf16_f32 v95, v86, v87
    v_mfma_f32_16x16x32_bf16 v[64:67], a[208:211], v[120:123], v[64:67]
    s_waitcnt vmcnt(8)
    v_subrev_u32 v2, s70, v2
    v_cmp_le_u32 vcc, 16, v2
    v_mfma_f32_16x16x32_bf16 v[68:71], a[212:215], v[120:123], v[68:71]
    s_cbranch_vccnz L_slow_96
L_back_97:
    v_mfma_f32_16x16x32_bf16 v[72:75], a[216:219], v[120:123], v[72:75]
    buffer_load_dwordx4 v[116:119], v13, s[60:63], s28 offen sc1
    v_mfma_f32_16x16x32_bf16 v[76:79], a[220:223], v[120:123], v[76:79]
    s_mov_b32 s75, 401408
    buffer_store_dwordx4 v[92:95], v6, s[60:63], s75 offen sc1
    v_mfma_f32_16x16x32_bf16 v[76:79], a[236:239], v[124:127], v[76:79]
    v_or_b32 v16, 7, v17
    v_mfma_f32_16x16x32_bf16 v[72:75], a[232:235], v[124:127], v[72:75]
    v_mfma_f32_16x16x32_bf16 v[68:71], a[228:231], v[124:127], v[68:71]
    buffer_load_dwordx4 v[120:123], v13, s[60:63], s29 offen sc1
    v_mfma_f32_16x16x32_bf16 v[64:67], a[224:227], v[124:127], v[64:67]
    v_mfma_f32_16x16x32_bf16 v[64:67], a[240:243], v[128:131], v[64:67]
    v_mfma_f32_16x16x32_bf16 v[68:71], a[244:247], v[128:131], v[68:71]
    v_mfma_f32_16x16x32_bf16 v[72:75], a[248:251], v[128:131], v[72:75]
    buffer_load_dwordx4 v[124:127], v13, s[60:63], s30 offen sc1
    v_mfma_f32_16x16x32_bf16 v[76:79], a[252:255], v[128:131], v[76:79]
    s_waitcnt vmcnt(11)
    v_mfma_f32_16x16x32_bf16 v[76:79], v[172:175], v[132:135], v[76:79]
    v_mfma_f32_16x16x32_bf16 v[72:75], v[168:171], v[132:135], v[72:75]
    v_mfma_f32_16x16x32_bf16 v[68:71], v[164:167], v[132:135], v[68:71]
    buffer_load_dwordx4 v[128:131], v13, s[60:63], s31 offen sc1
    v_mfma_f32_16x16x32_bf16 v[64:67], v[160:163], v[132:135], v[64:67]
    s_waitcnt vmcnt(11)
    s_waitcnt lgkmcnt(15)
    v_mfma_f32_16x16x32_bf16 v[64:67], v[176:179], v[136:139], v[64:67]
    v_mfma_f32_16x16x32_bf16 v[68:71], v[180:183], v[136:139], v[68:71]
    v_mfma_f32_16x16x32_bf16 v[72:75], v[184:187], v[136:139], v[72:75]
    buffer_load_dwordx4 v[132:135], v13, s[60:63], s32 offen sc1
    v_mfma_f32_16x16x32_bf16 v[76:79], v[188:191], v[136:139], v[76:79]
    s_waitcnt vmcnt(10)
    s_add_u32 s70, s69, 6
    buffer_load_dword v2, v4, s[60:63], 0 offen sc1
    v_mfma_f32_16x16x32_bf16 v[76:79], v[204:207], v[100:103], v[76:79]
    v_mfma_f32_16x16x32_bf16 v[72:75], v[200:203], v[100:103], v[72:75]
    v_mfma_f32_16x16x32_bf16 v[68:71], v[196:199], v[100:103], v[68:71]
    buffer_load_dwordx4 v[136:139], v13, s[60:63], s33 offen sc1
    v_mfma_f32_16x16x32_bf16 v[64:67], v[192:195], v[100:103], v[64:67]
    s_waitcnt vmcnt(11)
    v_mfma_f32_16x16x32_bf16 v[64:67], v[208:211], v[104:107], v[64:67]
    v_mfma_f32_16x16x32_bf16 v[68:71], v[212:215], v[104:107], v[68:71]
    v_mfma_f32_16x16x32_bf16 v[72:75], v[216:219], v[104:107], v[72:75]
    buffer_load_dwordx4 v[100:103], v13, s[60:63], s34 offen sc1
    v_mfma_f32_16x16x32_bf16 v[76:79], v[220:223], v[104:107], v[76:79]
    s_waitcnt vmcnt(10)
    s_waitcnt lgkmcnt(8)
    v_mfma_f32_16x16x32_bf16 v[76:79], v[236:239], v[108:111], v[76:79]
    v_mfma_f32_16x16x32_bf16 v[72:75], v[232:235], v[108:111], v[72:75]
    v_mfma_f32_16x16x32_bf16 v[68:71], v[228:231], v[108:111], v[68:71]
    buffer_load_dwordx4 v[104:107], v13, s[60:63], s35 offen sc1
    v_mfma_f32_16x16x32_bf16 v[64:67], v[224:227], v[108:111], v[64:67]
    s_waitcnt vmcnt(10)
    s_waitcnt lgkmcnt(6)
    v_mfma_f32_16x16x32_bf16 v[64:67], v[240:243], v[112:115], v[64:67]
    s_waitcnt lgkmcnt(4)
    v_mfma_f32_16x16x32_bf16 v[68:71], v[244:247], v[112:115], v[68:71]
    s_waitcnt lgkmcnt(2)
    v_mfma_f32_16x16x32_bf16 v[72:75], v[248:251], v[112:115], v[72:75]
    buffer_load_dwordx4 v[108:111], v13, s[60:63], s36 offen sc1
    s_waitcnt lgkmcnt(0)
    v_mfma_f32_16x16x32_bf16 v[76:79], v[252:255], v[112:115], v[76:79]
    s_waitcnt vmcnt(10)
    v_mfma_f32_16x16x32_bf16 v[36:39], a[140:143], v[116:119], 0
    v_mfma_f32_16x16x32_bf16 v[32:35], a[136:139], v[116:119], 0
    v_mfma_f32_16x16x32_bf16 v[28:31], a[132:135], v[116:119], 0
    buffer_load_dwordx4 v[112:115], v13, s[60:63], s37 offen sc1
    v_mfma_f32_16x16x32_bf16 v[24:27], a[128:131], v[116:119], 0
    s_waitcnt vmcnt(9)
    v_mfma_f32_16x16x32_bf16 v[24:27], a[144:147], v[120:123], v[24:27]
    v_mfma_f32_16x16x32_bf16 v[28:31], a[148:151], v[120:123], v[28:31]
    buffer_store_dword v16, v3, s[60:63], 0 offen sc1
    v_mfma_f32_16x16x32_bf16 v[32:35], a[152:155], v[120:123], v[32:35]
    buffer_load_dwordx4 v[116:119], v13, s[60:63], s38 offen sc1
    v_mfma_f32_16x16x32_bf16 v[36:39], a[156:159], v[120:123], v[36:39]
    s_waitcnt vmcnt(10)
    ds_write_b128 v11, v[64:67] offset:0
    v_mfma_f32_16x16x32_bf16 v[36:39], a[172:175], v[124:127], v[36:39]
    v_mfma_f32_16x16x32_bf16 v[32:35], a[168:171], v[124:127], v[32:35]
    v_mfma_f32_16x16x32_bf16 v[28:31], a[164:167], v[124:127], v[28:31]
    buffer_load_dwordx4 v[120:123], v13, s[60:63], s39 offen sc1
    v_mfma_f32_16x16x32_bf16 v[24:27], a[160:163], v[124:127], v[24:27]
    s_waitcnt vmcnt(10)
    ds_write_b128 v14, v[68:71] offset:0
    v_mfma_f32_16x16x32_bf16 v[24:27], a[176:179], v[128:131], v[24:27]
    v_mfma_f32_16x16x32_bf16 v[28:31], a[180:183], v[128:131], v[28:31]
    v_mfma_f32_16x16x32_bf16 v[32:35], a[184:187], v[128:131], v[32:35]
    buffer_load_dwordx4 v[124:127], v13, s[60:63], s40 offen sc1
    v_mfma_f32_16x16x32_bf16 v[36:39], a[188:191], v[128:131], v[36:39]
    s_waitcnt vmcnt(10)
    ds_write_b128 v11, v[72:75] offset:128
    v_mfma_f32_16x16x32_bf16 v[36:39], a[204:207], v[132:135], v[36:39]
    v_mfma_f32_16x16x32_bf16 v[32:35], a[200:203], v[132:135], v[32:35]
    v_mfma_f32_16x16x32_bf16 v[28:31], a[196:199], v[132:135], v[28:31]
    buffer_load_dwordx4 v[128:131], v13, s[60:63], s41 offen sc1
    v_add_u32 v13, 114688, v13
    v_mfma_f32_16x16x32_bf16 v[24:27], a[192:195], v[132:135], v[24:27]
    s_waitcnt vmcnt(9)
    ds_write_b128 v14, v[76:79] offset:128
    v_mfma_f32_16x16x32_bf16 v[24:27], a[208:211], v[136:139], v[24:27]
    v_subrev_u32 v2, s70, v2
    v_cmp_le_u32 vcc, 16, v2
    v_mfma_f32_16x16x32_bf16 v[28:31], a[212:215], v[136:139], v[28:31]
    s_cbranch_vccnz L_slow_101
L_back_102:
    v_mfma_f32_16x16x32_bf16 v[32:35], a[216:219], v[136:139], v[32:35]
    buffer_load_dwordx4 v[132:135], v13, s[60:63], s28 offen sc1
    v_mfma_f32_16x16x32_bf16 v[36:39], a[220:223], v[136:139], v[36:39]
    s_waitcnt vmcnt(9)
    v_mfma_f32_16x16x32_bf16 v[36:39], a[236:239], v[100:103], v[36:39]
    s_waitcnt lgkmcnt(0)
    s_barrier
    v_mfma_f32_16x16x32_bf16 v[32:35], a[232:235], v[100:103], v[32:35]
    ds_read_b128 v[64:67], v12 offset:0
    ds_read_b128 v[68:71], v12 offset:4096
    v_mfma_f32_16x16x32_bf16 v[28:31], a[228:231], v[100:103], v[28:31]
    buffer_load_dwordx4 v[136:139], v13, s[60:63], s29 offen sc1
    v_mfma_f32_16x16x32_bf16 v[24:27], a[224:227], v[100:103], v[24:27]
    s_waitcnt vmcnt(9)
    ds_read_b128 v[72:75], v12 offset:8192
    ds_read_b128 v[76:79], v12 offset:12288
    v_mfma_f32_16x16x32_bf16 v[24:27], a[240:243], v[104:107], v[24:27]
    v_mfma_f32_16x16x32_bf16 v[28:31], a[244:247], v[104:107], v[28:31]
    v_mfma_f32_16x16x32_bf16 v[32:35], a[248:251], v[104:107], v[32:35]
    buffer_load_dwordx4 v[100:103], v13, s[60:63], s30 offen sc1
    v_mfma_f32_16x16x32_bf16 v[36:39], a[252:255], v[104:107], v[36:39]
    s_waitcnt vmcnt(9)
    v_mfma_f32_16x16x32_bf16 v[36:39], v[172:175], v[108:111], v[36:39]
    v_mfma_f32_16x16x32_bf16 v[32:35], v[168:171], v[108:111], v[32:35]
    s_waitcnt lgkmcnt(0)
    v_add_f32 v64, v64, v68
    v_add_f32 v65, v65, v69
    v_mfma_f32_16x16x32_bf16 v[28:31], v[164:167], v[108:111], v[28:31]
    buffer_load_dwordx4 v[104:107], v13, s[60:63], s31 offen sc1
    v_mfma_f32_16x16x32_bf16 v[24:27], v[160:163], v[108:111], v[24:27]
    s_waitcnt vmcnt(9)
    v_add_f32 v66, v66, v70
    v_add_f32 v67, v67, v71
    v_mfma_f32_16x16x32_bf16 v[24:27], v[176:179], v[112:115], v[24:27]
    v_add_f32 v64, v64, v72
    v_add_f32 v65, v65, v73
    v_mfma_f32_16x16x32_bf16 v[28:31], v[180:183], v[112:115], v[28:31]
    v_add_f32 v66, v66, v74
    v_add_f32 v67, v67, v75
    v_mfma_f32_16x16x32_bf16 v[32:35], v[184:187], v[112:115], v[32:35]
    buffer_load_dwordx4 v[108:111], v13, s[60:63], s32 offen sc1
    v_mfma_f32_16x16x32_bf16 v[36:39], v[188:191], v[112:115], v[36:39]
    s_waitcnt vmcnt(8)
    s_add_u32 s70, s69, 7
    buffer_load_dword v2, v4, s[60:63], 0 offen sc1
    v_mfma_f32_16x16x32_bf16 v[36:39], v[204:207], v[116:119], v[36:39]
    v_add_f32 v64, v64, v76
    v_add_f32 v65, v65, v77
    v_mfma_f32_16x16x32_bf16 v[32:35], v[200:203], v[116:119], v[32:35]
    v_add_f32 v66, v66, v78
    v_add_f32 v67, v67, v79
    v_mfma_f32_16x16x32_bf16 v[28:31], v[196:199], v[116:119], v[28:31]
    buffer_load_dwordx4 v[112:115], v13, s[60:63], s33 offen sc1
    v_mfma_f32_16x16x32_bf16 v[24:27], v[192:195], v[116:119], v[24:27]
    s_waitcnt vmcnt(9)
    v_cvt_pk_bf16_f32 v68, v64, v65
    v_cvt_pk_bf16_f32 v69, v66, v67
    v_mfma_f32_16x16x32_bf16 v[24:27], v[208:211], v[120:123], v[24:27]
    v_min_u32 v68, -2, v68
    v_min_u32 v69, -2, v69
    v_mfma_f32_16x16x32_bf16 v[28:31], v[212:215], v[120:123], v[28:31]
    s_mov_b32 s72, 0
    buffer_store_dwordx2 v[68:69], v5, s[60:63], s72 offen sc1
    v_mfma_f32_16x16x32_bf16 v[32:35], v[216:219], v[120:123], v[32:35]
    buffer_load_dwordx4 v[116:119], v13, s[60:63], s34 offen sc1
    v_mfma_f32_16x16x32_bf16 v[36:39], v[220:223], v[120:123], v[36:39]
    s_waitcnt vmcnt(10)
    v_mfma_f32_16x16x32_bf16 v[36:39], v[236:239], v[124:127], v[36:39]
    v_mfma_f32_16x16x32_bf16 v[32:35], v[232:235], v[124:127], v[32:35]
    v_mfma_f32_16x16x32_bf16 v[28:31], v[228:231], v[124:127], v[28:31]
    buffer_load_dwordx4 v[120:123], v13, s[60:63], s35 offen sc1
    v_mfma_f32_16x16x32_bf16 v[24:27], v[224:227], v[124:127], v[24:27]
    s_waitcnt vmcnt(10)
    v_mfma_f32_16x16x32_bf16 v[24:27], v[240:243], v[128:131], v[24:27]
    v_mfma_f32_16x16x32_bf16 v[28:31], v[244:247], v[128:131], v[28:31]
    v_mfma_f32_16x16x32_bf16 v[32:35], v[248:251], v[128:131], v[32:35]
    buffer_load_dwordx4 v[124:127], v13, s[60:63], s36 offen sc1
    v_mfma_f32_16x16x32_bf16 v[36:39], v[252:255], v[128:131], v[36:39]
    s_waitcnt vmcnt(10)
    v_mfma_f32_16x16x32_bf16 v[76:79], a[140:143], v[132:135], 0
    v_lshlrev_b32 v40, 16, v144
    v_and_b32 v41, 0xffff0000, v144
    v_mfma_f32_16x16x32_bf16 v[72:75], a[136:139], v[132:135], 0
    v_lshlrev_b32 v42, 16, v145
    v_and_b32 v43, 0xffff0000, v145
    v_mfma_f32_16x16x32_bf16 v[68:71], a[132:135], v[132:135], 0
    buffer_load_dwordx4 v[128:131], v13, s[60:63], s37 offen sc1
    v_mfma_f32_16x16x32_bf16 v[64:67], a[128:131], v[132:135], 0
    s_waitcnt vmcnt(10)
    v_lshlrev_b32 v44, 16, v146
    v_and_b32 v45, 0xffff0000, v146
    v_mfma_f32_16x16x32_bf16 v[64:67], a[144:147], v[136:139], v[64:67]
    v_lshlrev_b32 v46, 16, v147
    v_and_b32 v47, 0xffff0000, v147
    v_mfma_f32_16x16x32_bf16 v[68:71], a[148:151], v[136:139], v[68:71]
    v_lshlrev_b32 v48, 16, v152
    v_and_b32 v49, 0xffff0000, v152
    v_mfma_f32_16x16x32_bf16 v[72:75], a[152:155], v[136:139], v[72:75]
    buffer_load_dwordx4 v[132:135], v13, s[60:63], s38 offen sc1
    v_mfma_f32_16x16x32_bf16 v[76:79], a[156:159], v[136:139], v[76:79]
    s_waitcnt vmcnt(10)
    ds_write_b128 v11, v[24:27] offset:16384
    v_mfma_f32_16x16x32_bf16 v[76:79], a[172:175], v[100:103], v[76:79]
    v_lshlrev_b32 v50, 16, v153
    v_and_b32 v51, 0xffff0000, v153
    v_mfma_f32_16x16x32_bf16 v[72:75], a[168:171], v[100:103], v[72:75]
    v_lshlrev_b32 v52, 16, v154
    v_and_b32 v53, 0xffff0000, v154
    v_mfma_f32_16x16x32_bf16 v[68:71], a[164:167], v[100:103], v[68:71]
    buffer_load_dwordx4 v[136:139], v13, s[60:63], s39 offen sc1
    v_mfma_f32_16x16x32_bf16 v[64:67], a[160:163], v[100:103], v[64:67]
    s_waitcnt vmcnt(10)
    ds_write_b128 v14, v[28:31] offset:16384
    v_mfma_f32_16x16x32_bf16 v[64:67], a[176:179], v[104:107], v[64:67]
    v_lshlrev_b32 v54, 16, v155
    v_and_b32 v55, 0xffff0000, v155
    v_mfma_f32_16x16x32_bf16 v[68:71], a[180:183], v[104:107], v[68:71]
    v_mfma_f32_16x16x32_bf16 v[72:75], a[184:187], v[104:107], v[72:75]
    buffer_load_dwordx4 v[100:103], v13, s[60:63], s40 offen sc1
    v_mfma_f32_16x16x32_bf16 v[76:79], a[188:191], v[104:107], v[76:79]
    s_waitcnt vmcnt(10)
    ds_write_b128 v11, v[32:35] offset:16512
    v_mfma_f32_16x16x32_bf16 v[76:79], a[204:207], v[108:111], v[76:79]
    v_mfma_f32_16x16x32_bf16 v[72:75], a[200:203], v[108:111], v[72:75]
    v_mfma_f32_16x16x32_bf16 v[68:71], a[196:199], v[108:111], v[68:71]
    buffer_load_dwordx4 v[104:107], v13, s[60:63], s41 offen sc1
    v_add_u32 v13, 114688, v13
    v_mfma_f32_16x16x32_bf16 v[64:67], a[192:195], v[108:111], v[64:67]
    s_waitcnt vmcnt(9)
    ds_write_b128 v14, v[36:39] offset:16512
    v_mfma_f32_16x16x32_bf16 v[64:67], a[208:211], v[112:115], v[64:67]
    v_subrev_u32 v2, s70, v2
    v_cmp_le_u32 vcc, 16, v2
    v_mfma_f32_16x16x32_bf16 v[68:71], a[212:215], v[112:115], v[68:71]
    s_cbranch_vccnz L_slow_106
L_back_107:
    v_mfma_f32_16x16x32_bf16 v[72:75], a[216:219], v[112:115], v[72:75]
    buffer_load_dwordx4 v[108:111], v13, s[60:63], s28 offen sc1
    v_mfma_f32_16x16x32_bf16 v[76:79], a[220:223], v[112:115], v[76:79]
    s_waitcnt vmcnt(8)
    v_mfma_f32_16x16x32_bf16 v[76:79], a[236:239], v[116:119], v[76:79]
    s_waitcnt lgkmcnt(0)
    s_barrier
    v_mfma_f32_16x16x32_bf16 v[72:75], a[232:235], v[116:119], v[72:75]
    ds_read_b128 v[24:27], v12 offset:16384
    ds_read_b128 v[28:31], v12 offset:20480
    v_mfma_f32_16x16x32_bf16 v[68:71], a[228:231], v[116:119], v[68:71]
    buffer_load_dwordx4 v[112:115], v13, s[60:63], s29 offen sc1
    v_mfma_f32_16x16x32_bf16 v[64:67], a[224:227], v[116:119], v[64:67]
    s_waitcnt vmcnt(8)
    ds_read_b128 v[32:35], v12 offset:24576
    ds_read_b128 v[36:39], v12 offset:28672
    v_mfma_f32_16x16x32_bf16 v[64:67], a[240:243], v[120:123], v[64:67]
    v_mfma_f32_16x16x32_bf16 v[68:71], a[244:247], v[120:123], v[68:71]
    v_mfma_f32_16x16x32_bf16 v[72:75], a[248:251], v[120:123], v[72:75]
    buffer_load_dwordx4 v[116:119], v13, s[60:63], s30 offen sc1
    v_mfma_f32_16x16x32_bf16 v[76:79], a[252:255], v[120:123], v[76:79]
    s_waitcnt vmcnt(8)
    v_mfma_f32_16x16x32_bf16 v[76:79], v[172:175], v[124:127], v[76:79]
    v_mfma_f32_16x16x32_bf16 v[72:75], v[168:171], v[124:127], v[72:75]
    s_waitcnt lgkmcnt(0)
    v_add_f32 v24, v24, v28
    v_add_f32 v25, v25, v29
    v_mfma_f32_16x16x32_bf16 v[68:71], v[164:167], v[124:127], v[68:71]
    buffer_load_dwordx4 v[120:123], v13, s[60:63], s31 offen sc1
    v_mfma_f32_16x16x32_bf16 v[64:67], v[160:163], v[124:127], v[64:67]
    s_waitcnt vmcnt(8)
    v_add_f32 v26, v26, v30
    v_add_f32 v27, v27, v31
    v_mfma_f32_16x16x32_bf16 v[64:67], v[176:179], v[128:131], v[64:67]
    v_add_f32 v24, v24, v32
    v_add_f32 v25, v25, v33
    v_mfma_f32_16x16x32_bf16 v[68:71], v[180:183], v[128:131], v[68:71]
    v_add_f32 v26, v26, v34
    v_add_f32 v27, v27, v35
    v_mfma_f32_16x16x32_bf16 v[72:75], v[184:187], v[128:131], v[72:75]
    buffer_load_dwordx4 v[124:127], v13, s[60:63], s32 offen sc1
    v_mfma_f32_16x16x32_bf16 v[76:79], v[188:191], v[128:131], v[76:79]
    s_waitcnt vmcnt(8)
    v_add_f32 v24, v24, v36
    v_add_f32 v25, v25, v37
    v_mfma_f32_16x16x32_bf16 v[76:79], v[204:207], v[132:135], v[76:79]
    v_add_f32 v26, v26, v38
    v_add_f32 v27, v27, v39
    v_mfma_f32_16x16x32_bf16 v[72:75], v[200:203], v[132:135], v[72:75]
    v_cvt_pk_bf16_f32 v28, v24, v25
    v_cvt_pk_bf16_f32 v29, v26, v27
    v_mfma_f32_16x16x32_bf16 v[68:71], v[196:199], v[132:135], v[68:71]
    buffer_load_dwordx4 v[128:131], v13, s[60:63], s33 offen sc1
    v_mfma_f32_16x16x32_bf16 v[64:67], v[192:195], v[132:135], v[64:67]
    s_waitcnt vmcnt(8)
    v_min_u32 v28, -2, v28
    v_min_u32 v29, -2, v29
    v_mfma_f32_16x16x32_bf16 v[64:67], v[208:211], v[136:139], v[64:67]
    s_mov_b32 s72, 32768
    buffer_store_dwordx2 v[28:29], v5, s[60:63], s72 offen sc1
    v_mfma_f32_16x16x32_bf16 v[68:71], v[212:215], v[136:139], v[68:71]
    v_mfma_f32_16x16x32_bf16 v[72:75], v[216:219], v[136:139], v[72:75]
    buffer_load_dwordx4 v[132:135], v13, s[60:63], s34 offen sc1
    v_mfma_f32_16x16x32_bf16 v[76:79], v[220:223], v[136:139], v[76:79]
    s_waitcnt vmcnt(9)
    v_mfma_f32_16x16x32_bf16 v[76:79], v[236:239], v[100:103], v[76:79]
    v_mfma_f32_16x16x32_bf16 v[72:75], v[232:235], v[100:103], v[72:75]
    v_mfma_f32_16x16x32_bf16 v[68:71], v[228:231], v[100:103], v[68:71]
    buffer_load_dwordx4 v[136:139], v13, s[60:63], s35 offen sc1
    v_mfma_f32_16x16x32_bf16 v[64:67], v[224:227], v[100:103], v[64:67]
    s_waitcnt vmcnt(9)
    v_mfma_f32_16x16x32_bf16 v[64:67], v[240:243], v[104:107], v[64:67]
    v_mfma_f32_16x16x32_bf16 v[68:71], v[244:247], v[104:107], v[68:71]
    v_mfma_f32_16x16x32_bf16 v[72:75], v[248:251], v[104:107], v[72:75]
    buffer_load_dwordx4 v[100:103], v13, s[60:63], s36 offen sc1
    v_mfma_f32_16x16x32_bf16 v[76:79], v[252:255], v[104:107], v[76:79]
    s_waitcnt vmcnt(9)
    v_mfma_f32_16x16x32_bf16 v[36:39], a[140:143], v[108:111], 0
    v_mfma_f32_16x16x32_bf16 v[32:35], a[136:139], v[108:111], 0
    v_mfma_f32_16x16x32_bf16 v[28:31], a[132:135], v[108:111], 0
    buffer_load_dwordx4 v[104:107], v13, s[60:63], s37 offen sc1
    v_mfma_f32_16x16x32_bf16 v[24:27], a[128:131], v[108:111], 0
    s_waitcnt vmcnt(9)
    v_mfma_f32_16x16x32_bf16 v[24:27], a[144:147], v[112:115], v[24:27]
    v_mfma_f32_16x16x32_bf16 v[28:31], a[148:151], v[112:115], v[28:31]
    v_mfma_f32_16x16x32_bf16 v[32:35], a[152:155], v[112:115], v[32:35]
    buffer_load_dwordx4 v[108:111], v13, s[60:63], s38 offen sc1
    v_mfma_f32_16x16x32_bf16 v[36:39], a[156:159], v[112:115], v[36:39]
    s_waitcnt vmcnt(9)
    ds_write_b128 v11, v[64:67] offset:0
    v_mfma_f32_16x16x32_bf16 v[36:39], a[172:175], v[116:119], v[36:39]
    v_mfma_f32_16x16x32_bf16 v[32:35], a[168:171], v[116:119], v[32:35]
    v_mfma_f32_16x16x32_bf16 v[28:31], a[164:167], v[116:119], v[28:31]
    buffer_load_dwordx4 v[112:115], v13, s[60:63], s39 offen sc1
    v_mfma_f32_16x16x32_bf16 v[24:27], a[160:163], v[116:119], v[24:27]
    s_waitcnt vmcnt(9)
    ds_write_b128 v14, v[68:71] offset:0
    v_mfma_f32_16x16x32_bf16 v[24:27], a[176:179], v[120:123], v[24:27]
    v_mfma_f32_16x16x32_bf16 v[28:31], a[180:183], v[120:123], v[28:31]
    v_mfma_f32_16x16x32_bf16 v[32:35], a[184:187], v[120:123], v[32:35]
    buffer_load_dwordx4 v[116:119], v13, s[60:63], s40 offen sc1
    v_mfma_f32_16x16x32_bf16 v[36:39], a[188:191], v[120:123], v[36:39]
    s_waitcnt vmcnt(9)
    ds_write_b128 v11, v[72:75] offset:128
    v_mfma_f32_16x16x32_bf16 v[36:39], a[204:207], v[124:127], v[36:39]
    v_mfma_f32_16x16x32_bf16 v[32:35], a[200:203], v[124:127], v[32:35]
    v_mfma_f32_16x16x32_bf16 v[28:31], a[196:199], v[124:127], v[28:31]
    buffer_load_dwordx4 v[120:123], v13, s[60:63], s41 offen sc1
    v_add_u32 v13, 573440, v13
    v_mfma_f32_16x16x32_bf16 v[24:27], a[192:195], v[124:127], v[24:27]
    s_waitcnt vmcnt(9)
    ds_write_b128 v14, v[76:79] offset:128
    v_mfma_f32_16x16x32_bf16 v[24:27], a[208:211], v[128:131], v[24:27]
    v_mfma_f32_16x16x32_bf16 v[28:31], a[212:215], v[128:131], v[28:31]
    v_mfma_f32_16x16x32_bf16 v[32:35], a[216:219], v[128:131], v[32:35]
    v_mfma_f32_16x16x32_bf16 v[36:39], a[220:223], v[128:131], v[36:39]
    s_waitcnt vmcnt(7)
    v_mfma_f32_16x16x32_bf16 v[36:39], a[236:239], v[132:135], v[36:39]
    s_waitcnt lgkmcnt(0)
    s_barrier
    v_mfma_f32_16x16x32_bf16 v[32:35], a[232:235], v[132:135], v[32:35]
    ds_read_b128 v[64:67], v12 offset:0
    ds_read_b128 v[68:71], v12 offset:4096
    v_mfma_f32_16x16x32_bf16 v[28:31], a[228:231], v[132:135], v[28:31]
    ds_read_b128 v[72:75], v12 offset:8192
    ds_read_b128 v[76:79], v12 offset:12288
    v_mfma_f32_16x16x32_bf16 v[24:27], a[224:227], v[132:135], v[24:27]
    s_waitcnt vmcnt(6)
    v_mfma_f32_16x16x32_bf16 v[24:27], a[240:243], v[136:139], v[24:27]
    buffer_load_dwordx4 v[80:83], v7, s[60:63], 0 offen sc1
    v_mfma_f32_16x16x32_bf16 v[28:31], a[244:247], v[136:139], v[28:31]
    v_mfma_f32_16x16x32_bf16 v[32:35], a[248:251], v[136:139], v[32:35]
    v_mfma_f32_16x16x32_bf16 v[36:39], a[252:255], v[136:139], v[36:39]
    s_waitcnt vmcnt(6)
    v_mfma_f32_16x16x32_bf16 v[36:39], v[172:175], v[100:103], v[36:39]
    s_waitcnt lgkmcnt(0)
    v_add_f32 v64, v64, v68
    v_add_f32 v65, v65, v69
    v_mfma_f32_16x16x32_bf16 v[32:35], v[168:171], v[100:103], v[32:35]
    v_add_f32 v66, v66, v70
    v_add_f32 v67, v67, v71
    v_mfma_f32_16x16x32_bf16 v[28:31], v[164:167], v[100:103], v[28:31]
    v_add_f32 v64, v64, v72
    v_add_f32 v65, v65, v73
    v_mfma_f32_16x16x32_bf16 v[24:27], v[160:163], v[100:103], v[24:27]
    s_waitcnt vmcnt(5)
    v_add_f32 v66, v66, v74
    v_add_f32 v67, v67, v75
    v_mfma_f32_16x16x32_bf16 v[24:27], v[176:179], v[104:107], v[24:27]
    v_add_f32 v64, v64, v76
    v_add_f32 v65, v65, v77
    v_mfma_f32_16x16x32_bf16 v[28:31], v[180:183], v[104:107], v[28:31]
    v_add_f32 v66, v66, v78
    v_add_f32 v67, v67, v79
    v_mfma_f32_16x16x32_bf16 v[32:35], v[184:187], v[104:107], v[32:35]
    v_cvt_pk_bf16_f32 v68, v64, v65
    v_cvt_pk_bf16_f32 v69, v66, v67
    v_mfma_f32_16x16x32_bf16 v[36:39], v[188:191], v[104:107], v[36:39]
    s_waitcnt vmcnt(4)
    v_min_u32 v68, -2, v68
    v_min_u32 v69, -2, v69
    v_mfma_f32_16x16x32_bf16 v[36:39], v[204:207], v[108:111], v[36:39]
    s_mov_b32 s72, 65536
    buffer_store_dwordx2 v[68:69], v5, s[60:63], s72 offen sc1
    v_mfma_f32_16x16x32_bf16 v[32:35], v[200:203], v[108:111], v[32:35]
    v_mfma_f32_16x16x32_bf16 v[28:31], v[196:199], v[108:111], v[28:31]
    v_mfma_f32_16x16x32_bf16 v[24:27], v[192:195], v[108:111], v[24:27]
    s_waitcnt vmcnt(4)
    v_mfma_f32_16x16x32_bf16 v[24:27], v[208:211], v[112:115], v[24:27]
    v_mfma_f32_16x16x32_bf16 v[28:31], v[212:215], v[112:115], v[28:31]
    v_mfma_f32_16x16x32_bf16 v[32:35], v[216:219], v[112:115], v[32:35]
    v_mfma_f32_16x16x32_bf16 v[36:39], v[220:223], v[112:115], v[36:39]
    s_waitcnt vmcnt(3)
    v_mfma_f32_16x16x32_bf16 v[36:39], v[236:239], v[116:119], v[36:39]
    v_mfma_f32_16x16x32_bf16 v[32:35], v[232:235], v[116:119], v[32:35]
    v_mfma_f32_16x16x32_bf16 v[28:31], v[228:231], v[116:119], v[28:31]
    v_mfma_f32_16x16x32_bf16 v[24:27], v[224:227], v[116:119], v[24:27]
    s_waitcnt vmcnt(2)
    v_mfma_f32_16x16x32_bf16 v[24:27], v[240:243], v[120:123], v[24:27]
    v_mfma_f32_16x16x32_bf16 v[28:31], v[244:247], v[120:123], v[28:31]
    v_mfma_f32_16x16x32_bf16 v[32:35], v[248:251], v[120:123], v[32:35]
    v_mfma_f32_16x16x32_bf16 v[36:39], v[252:255], v[120:123], v[36:39]
    s_waitcnt vmcnt(1)
    v_max3_u32 v23, v80, v81, v82
    v_max_u32 v23, v23, v83
    v_cmp_eq_u32 vcc, -1, v23
    s_nop 0
    s_cbranch_vccz L_ret_112
L_spin_111:
    buffer_load_dwordx4 v[80:83], v7, s[60:63], 0 offen sc1
    s_sub_u32 s71, s71, 1
    s_cbranch_scc1 L_bail_113
    s_waitcnt vmcnt(0)
    v_max3_u32 v23, v80, v81, v82
    v_max_u32 v23, v23, v83
    v_cmp_eq_u32 vcc, -1, v23
    s_nop 0
    s_cbranch_vccnz L_spin_111
L_ret_112:
    v_lshlrev_b32 v56, 16, v80
    v_and_b32 v57, 0xffff0000, v80
    v_lshlrev_b32 v58, 16, v81
    v_and_b32 v59, 0xffff0000, v81
    ds_write_b128 v11, v[24:27] offset:16384
    v_lshlrev_b32 v60, 16, v82
    v_and_b32 v61, 0xffff0000, v82
    v_lshlrev_b32 v62, 16, v83
    v_and_b32 v63, 0xffff0000, v83
    v_pk_fma_f32 v[40:41], v[56:57], s[42:43], v[40:41] op_sel_hi:[1,0,1]
    v_pk_fma_f32 v[42:43], v[58:59], s[42:43], v[42:43] op_sel_hi:[1,0,1]
    v_pk_fma_f32 v[44:45], v[60:61], s[42:43], v[44:45] op_sel_hi:[1,0,1]
    v_pk_fma_f32 v[46:47], v[62:63], s[42:43], v[46:47] op_sel_hi:[1,0,1]
    ds_write_b128 v14, v[28:31] offset:16384
    v_pk_mul_f32 v[86:87], v[40:41], v[40:41]
    v_pk_add_f32 v[84:85], v[40:41], v[42:43]
    v_pk_fma_f32 v[86:87], v[42:43], v[42:43], v[86:87]
    v_pk_add_f32 v[84:85], v[84:85], v[44:45]
    v_pk_fma_f32 v[86:87], v[44:45], v[44:45], v[86:87]
    v_pk_add_f32 v[84:85], v[84:85], v[46:47]
    v_pk_fma_f32 v[86:87], v[46:47], v[46:47], v[86:87]
    s_nop 1
    v_permlane32_swap_b32 v84, v86
    ds_write_b128 v11, v[32:35] offset:16512
    v_permlane32_swap_b32 v85, v87
    v_pk_add_f32 v[84:85], v[84:85], v[86:87]
    v_add_f32 v86, v84, v85
    v_add_f32 v84, v84, v85
    s_nop 1
    v_permlane16_swap_b32 v84, v86
    v_add_f32 v84, v84, v86
    s_nop 1
    v_add_f32_dpp v84, v84, v84 row_ror:8 row_mask:0xf bank_mask:0xf
    s_nop 1
    v_add_f32_dpp v84, v84, v84 row_ror:4 row_mask:0xf bank_mask:0xf
    ds_write_b128 v14, v[36:39] offset:16512
    s_nop 0
    v_add_f32_dpp v84, v84, v84 row_ror:2 row_mask:0xf bank_mask:0xf
    s_nop 1
    v_add_f32_dpp v84, v84, v84 row_ror:1 row_mask:0xf bank_mask:0xf
    v_mul_f32 v85, 0x3b000000, v84
    v_mul_f32 v84, 0x3b000000, v84
    s_nop 1
    v_permlane32_swap_b32 v84, v85
    v_fma_f32 v85, -v84, v84, v85
    v_max_f32 v85, 0, v85
    v_add_f32 v85, 0x3727c5ac, v85
    v_rsq_f32 v86, v85
    s_nop 0
    v_mul_f32 v87, -v84, v86
    v_pk_fma_f32 v[56:57], v[40:41], v[86:87], v[86:87] op_sel:[0,0,1] op_sel_hi:[1,0,1]
    v_pk_fma_f32 v[58:59], v[42:43], v[86:87], v[86:87] op_sel:[0,0,1] op_sel_hi:[1,0,1]
    s_waitcnt lgkmcnt(0)
    s_barrier
    ds_read_b128 v[24:27], v12 offset:16384
    ds_read_b128 v[28:31], v12 offset:20480
    ds_read_b128 v[32:35], v12 offset:24576
    ds_read_b128 v[36:39], v12 offset:28672
    v_pk_fma_f32 v[60:61], v[44:45], v[86:87], v[86:87] op_sel:[0,0,1] op_sel_hi:[1,0,1]
    v_pk_fma_f32 v[62:63], v[46:47], v[86:87], v[86:87] op_sel:[0,0,1] op_sel_hi:[1,0,1]
    v_pk_fma_f32 v[40:41], v[56:57], v[48:49], v[40:41]
    v_pk_fma_f32 v[42:43], v[58:59], v[50:51], v[42:43]
    v_pk_fma_f32 v[44:45], v[60:61], v[52:53], v[44:45]
    v_pk_fma_f32 v[46:47], v[62:63], v[54:55], v[46:47]
    v_pk_mul_f32 v[86:87], v[40:41], v[40:41]
    v_pk_add_f32 v[84:85], v[40:41], v[42:43]
    v_pk_fma_f32 v[86:87], v[42:43], v[42:43], v[86:87]
    v_pk_add_f32 v[84:85], v[84:85], v[44:45]
    v_pk_fma_f32 v[86:87], v[44:45], v[44:45], v[86:87]
    v_pk_add_f32 v[84:85], v[84:85], v[46:47]
    v_pk_fma_f32 v[86:87], v[46:47], v[46:47], v[86:87]
    s_nop 1
    v_permlane32_swap_b32 v84, v86
    v_permlane32_swap_b32 v85, v87
    v_pk_add_f32 v[84:85], v[84:85], v[86:87]
    s_waitcnt lgkmcnt(2)
    v_pk_add_f32 v[24:25], v[24:25], v[28:29]
    v_pk_add_f32 v[26:27], v[26:27], v[30:31]
    s_waitcnt lgkmcnt(1)
    v_pk_add_f32 v[24:25], v[24:25], v[32:33]
    v_pk_add_f32 v[26:27], v[26:27], v[34:35]
    s_waitcnt lgkmcnt(0)
    v_pk_add_f32 v[24:25], v[24:25], v[36:37]
    v_pk_add_f32 v[26:27], v[26:27], v[38:39]
    v_cvt_pk_bf16_f32 v28, v24, v25
    v_cvt_pk_bf16_f32 v29, v26, v27
    v_min_u32 v28, -2, v28
    v_min_u32 v29, -2, v29
    s_mov_b32 s72, 98304
    buffer_store_dwordx2 v[28:29], v5, s[60:63], s72 offen sc1
    v_add_f32 v86, v84, v85
    v_add_f32 v84, v84, v85
    s_nop 1
    v_permlane16_swap_b32 v84, v86
    v_add_f32 v84, v84, v86
    s_nop 1
    v_add_f32_dpp v84, v84, v84 row_ror:8 row_mask:0xf bank_mask:0xf
    s_nop 1
    v_add_f32_dpp v84, v84, v84 row_ror:4 row_mask:0xf bank_mask:0xf
    s_nop 1
    v_add_f32_dpp v84, v84, v84 row_ror:2 row_mask:0xf bank_mask:0xf
    s_nop 1
    v_add_f32_dpp v84, v84, v84 row_ror:1 row_mask:0xf bank_mask:0xf
    v_mul_f32 v85, 0x3b000000, v84
    v_mul_f32 v84, 0x3b000000, v84
    s_nop 1
    v_permlane32_swap_b32 v84, v85
    v_fma_f32 v85, -v84, v84, v85
    v_max_f32 v85, 0, v85
    v_add_f32 v85, 0x3727c5ac, v85
    v_mul_f32 v85, 0x3ef5fdf0, v85
    v_rsq_f32 v86, v85
    s_nop 0
    v_mul_f32 v87, -v84, v86
    v_pk_fma_f32 v[56:57], v[40:41], v[86:87], v[86:87] op_sel:[0,0,1] op_sel_hi:[1,0,1]
    v_pk_fma_f32 v[58:59], v[42:43], v[86:87], v[86:87] op_sel:[0,0,1] op_sel_hi:[1,0,1]
    v_pk_fma_f32 v[60:61], v[44:45], v[86:87], v[86:87] op_sel:[0,0,1] op_sel_hi:[1,0,1]
    v_pk_fma_f32 v[62:63], v[46:47], v[86:87], v[86:87] op_sel:[0,0,1] op_sel_hi:[1,0,1]
    v_cvt_pk_bf16_f32 v88, v56, v57
    buffer_load_dwordx4 v[128:131], v7, s[60:63], s86 offen sc1
    v_cvt_pk_bf16_f32 v89, v58, v59
    v_cvt_pk_bf16_f32 v90, v60, v61
    v_cvt_pk_bf16_f32 v91, v62, v63
    buffer_store_dwordx4 v[88:91], v7, s[60:63], 0 offen sc1
    buffer_store_dwordx2 v[86:87], v19, s[60:63], 0 offen offset:0 sc1
    v_lshlrev_b32 v104, 16, v148
    v_and_b32 v105, 0xffff0000, v148
    v_lshlrev_b32 v106, 16, v149
    v_and_b32 v107, 0xffff0000, v149
    v_lshlrev_b32 v108, 16, v150
    v_and_b32 v109, 0xffff0000, v150
    v_lshlrev_b32 v110, 16, v151
    v_and_b32 v111, 0xffff0000, v151
    v_lshlrev_b32 v112, 16, v156
    v_and_b32 v113, 0xffff0000, v156
    v_lshlrev_b32 v114, 16, v157
    v_and_b32 v115, 0xffff0000, v157
    v_lshlrev_b32 v116, 16, v158
    v_and_b32 v117, 0xffff0000, v158
    v_lshlrev_b32 v118, 16, v159
    v_and_b32 v119, 0xffff0000, v159
    s_waitcnt vmcnt(2)
    v_max3_u32 v23, v128, v129, v130
    v_max_u32 v23, v23, v131
    v_cmp_eq_u32 vcc, -1, v23
    s_nop 0
    s_cbranch_vccz L_ret_115
L_spin_114:
    buffer_load_dwordx4 v[128:131], v7, s[60:63], s86 offen sc1
    s_sub_u32 s71, s71, 1
    s_cbranch_scc1 L_bail_116
    s_waitcnt vmcnt(0)
    v_max3_u32 v23, v128, v129, v130
    v_max_u32 v23, v23, v131
    v_cmp_eq_u32 vcc, -1, v23
    s_nop 0
    s_cbranch_vccnz L_spin_114
L_ret_115:
    v_lshlrev_b32 v120, 16, v128
    v_and_b32 v121, 0xffff0000, v128
    v_lshlrev_b32 v122, 16, v129
    v_and_b32 v123, 0xffff0000, v129
    v_lshlrev_b32 v124, 16, v130
    v_and_b32 v125, 0xffff0000, v130
    v_lshlrev_b32 v126, 16, v131
    v_and_b32 v127, 0xffff0000, v131
    v_pk_fma_f32 v[104:105], v[120:121], s[42:43], v[104:105] op_sel_hi:[1,0,1]
    v_pk_fma_f32 v[106:107], v[122:123], s[42:43], v[106:107] op_sel_hi:[1,0,1]
    v_pk_fma_f32 v[108:109], v[124:125], s[42:43], v[108:109] op_sel_hi:[1,0,1]
    v_pk_fma_f32 v[110:111], v[126:127], s[42:43], v[110:111] op_sel_hi:[1,0,1]
    s_add_u32 s70, s69, 8
    v_mov_b32 v2, s70
    s_waitcnt vmcnt(0)
    buffer_store_dword v2, v3, s[60:63], 0 offen sc1
    v_pk_mul_f32 v[134:135], v[104:105], v[104:105]
    v_pk_add_f32 v[132:133], v[104:105], v[106:107]
    v_pk_fma_f32 v[134:135], v[106:107], v[106:107], v[134:135]
    v_pk_add_f32 v[132:133], v[132:133], v[108:109]
    v_pk_fma_f32 v[134:135], v[108:109], v[108:109], v[134:135]
    v_pk_add_f32 v[132:133], v[132:133], v[110:111]
    v_pk_fma_f32 v[134:135], v[110:111], v[110:111], v[134:135]
    s_nop 1
    v_permlane32_swap_b32 v132, v134
    v_permlane32_swap_b32 v133, v135
    v_pk_add_f32 v[132:133], v[132:133], v[134:135]
    v_add_f32 v134, v132, v133
    v_add_f32 v132, v132, v133
    s_nop 1
    v_permlane16_swap_b32 v132, v134
    v_add_f32 v132, v132, v134
    s_nop 1
    v_add_f32_dpp v132, v132, v132 row_ror:8 row_mask:0xf bank_mask:0xf
    s_nop 1
    v_add_f32_dpp v132, v132, v132 row_ror:4 row_mask:0xf bank_mask:0xf
    s_nop 1
    v_add_f32_dpp v132, v132, v132 row_ror:2 row_mask:0xf bank_mask:0xf
    s_nop 1
    v_add_f32_dpp v132, v132, v132 row_ror:1 row_mask:0xf bank_mask:0xf
    v_mul_f32 v133, 0x3b000000, v132
    v_mul_f32 v132, 0x3b000000, v132
    s_nop 1
    v_permlane32_swap_b32 v132, v133
    v_fma_f32 v133, -v132, v132, v133
    v_max_f32 v133, 0, v133
    v_add_f32 v133, 0x3727c5ac, v133
    v_rsq_f32 v134, v133
    s_nop 0
    v_mul_f32 v135, -v132, v134
    v_pk_fma_f32 v[120:121], v[104:105], v[134:135], v[134:135] op_sel:[0,0,1] op_sel_hi:[1,0,1]
    v_pk_fma_f32 v[122:123], v[106:107], v[134:135], v[134:135] op_sel:[0,0,1] op_sel_hi:[1,0,1]
    v_pk_fma_f32 v[124:125], v[108:109], v[134:135], v[134:135] op_sel:[0,0,1] op_sel_hi:[1,0,1]
    v_pk_fma_f32 v[126:127], v[110:111], v[134:135], v[134:135] op_sel:[0,0,1] op_sel_hi:[1,0,1]
    v_pk_fma_f32 v[104:105], v[120:121], v[112:113], v[104:105]
    v_pk_fma_f32 v[106:107], v[122:123], v[114:115], v[106:107]
    v_pk_fma_f32 v[108:109], v[124:125], v[116:117], v[108:109]
    v_pk_fma_f32 v[110:111], v[126:127], v[118:119], v[110:111]
    v_pk_mul_f32 v[134:135], v[104:105], v[104:105]
    v_pk_add_f32 v[132:133], v[104:105], v[106:107]
    v_pk_fma_f32 v[134:135], v[106:107], v[106:107], v[134:135]
    v_pk_add_f32 v[132:133], v[132:133], v[108:109]
    v_pk_fma_f32 v[134:135], v[108:109], v[108:109], v[134:135]
    v_pk_add_f32 v[132:133], v[132:133], v[110:111]
    v_pk_fma_f32 v[134:135], v[110:111], v[110:111], v[134:135]
    s_nop 1
    v_permlane32_swap_b32 v132, v134
    v_permlane32_swap_b32 v133, v135
    v_pk_add_f32 v[132:133], v[132:133], v[134:135]
    v_add_f32 v134, v132, v133
    v_add_f32 v132, v132, v133
    s_nop 1
    v_permlane16_swap_b32 v132, v134
    v_add_f32 v132, v132, v134
    buffer_load_dword v2, v4, s[60:63], 0 offen sc1
    s_nop 0
    v_add_f32_dpp v132, v132, v132 row_ror:8 row_mask:0xf bank_mask:0xf
    s_nop 1
    v_add_f32_dpp v132, v132, v132 row_ror:4 row_mask:0xf bank_mask:0xf
    s_nop 1
    v_add_f32_dpp v132, v132, v132 row_ror:2 row_mask:0xf bank_mask:0xf
    s_nop 1
    v_add_f32_dpp v132, v132, v132 row_ror:1 row_mask:0xf bank_mask:0xf
    v_mul_f32 v133, 0x3b000000, v132
    v_mul_f32 v132, 0x3b000000, v132
    s_nop 1
    v_permlane32_swap_b32 v132, v133
    v_fma_f32 v133, -v132, v132, v133
    v_max_f32 v133, 0, v133
    v_add_f32 v133, 0x3727c5ac, v133
    v_mul_f32 v133, 0x3ef5fdf0, v133
    v_rsq_f32 v134, v133
    s_nop 0
    v_mul_f32 v135, -v132, v134
    v_pk_fma_f32 v[120:121], v[104:105], v[134:135], v[134:135] op_sel:[0,0,1] op_sel_hi:[1,0,1]
    v_pk_fma_f32 v[122:123], v[106:107], v[134:135], v[134:135] op_sel:[0,0,1] op_sel_hi:[1,0,1]
    v_pk_fma_f32 v[124:125], v[108:109], v[134:135], v[134:135] op_sel:[0,0,1] op_sel_hi:[1,0,1]
    v_pk_fma_f32 v[126:127], v[110:111], v[134:135], v[134:135] op_sel:[0,0,1] op_sel_hi:[1,0,1]
    v_cvt_pk_bf16_f32 v136, v120, v121
    v_cvt_pk_bf16_f32 v137, v122, v123
    v_cvt_pk_bf16_f32 v138, v124, v125
    v_cvt_pk_bf16_f32 v139, v126, v127
    buffer_store_dwordx4 v[136:139], v7, s[60:63], s86 offen sc1
    buffer_store_dwordx2 v[134:135], v19, s[60:63], 0 offen offset:512 sc1
    s_waitcnt vmcnt(2)
    v_subrev_u32 v2, s70, v2
    v_cmp_le_u32 vcc, 16, v2
    s_nop 0
    s_cbranch_vccz L_ret_118
L_spin_117:
    buffer_load_dword v2, v4, s[60:63], 0 offen sc1
    s_sub_u32 s71, s71, 1
    s_cbranch_scc1 L_bail_119
    s_waitcnt vmcnt(0)
    v_subrev_u32 v2, s70, v2
    v_cmp_le_u32 vcc, 16, v2
    s_nop 0
    s_cbranch_vccnz L_spin_117
L_ret_118:
    s_cmp_ge_u32 s67, 14
    s_cbranch_scc1 L_g1skip_120
    s_add_u32 m0, s43, 0
    s_mov_b32 s72, 0
    buffer_load_dwordx4 v8, s[60:63], s72 offen offset:0 sc1 lds
    s_add_u32 m0, s43, 7936
    s_nop 0
    buffer_load_dwordx4 v8, s[60:63], s72 offen offset:256 sc1 lds
    s_add_u32 m0, s43, 15872
    s_nop 0
    buffer_load_dwordx4 v8, s[60:63], s72 offen offset:512 sc1 lds
    s_add_u32 m0, s43, 23808
    s_nop 0
    buffer_load_dwordx4 v8, s[60:63], s72 offen offset:768 sc1 lds
    v_or_b32 v16, 9, v17
    s_waitcnt vmcnt(4)
    buffer_store_dword v16, v3, s[60:63], 0 offen sc1
    s_add_u32 m0, s43, 4096
    s_mov_b32 s72, 16384
    buffer_load_dwordx4 v8, s[60:63], s72 offen offset:0 sc1 lds
    s_add_u32 m0, s43, 12032
    s_nop 0
    buffer_load_dwordx4 v8, s[60:63], s72 offen offset:256 sc1 lds
    s_add_u32 m0, s43, 19968
    s_nop 0
    buffer_load_dwordx4 v8, s[60:63], s72 offen offset:512 sc1 lds
    s_add_u32 m0, s43, 27904
    s_nop 0
    buffer_load_dwordx4 v8, s[60:63], s72 offen offset:768 sc1 lds
    s_waitcnt vmcnt(7)
    s_barrier
    ds_read_b128 v[56:59], v96 offset:0
    ds_read_b128 v[60:63], v97 offset:0
    ds_read_b128 v[64:67], v98 offset:0
    ds_read_b128 v[68:71], v99 offset:0
    s_waitcnt lgkmcnt(3)
    v_mfma_f32_16x16x32_bf16 v[28:31], a[4:7], v[56:59], 0
    s_add_u32 m0, s43, 32768
    ds_read_b128 v[72:75], v96 offset:8192
    ds_read_b128 v[76:79], v97 offset:8192
    v_mfma_f32_16x16x32_bf16 v[24:27], a[0:3], v[56:59], 0
    s_mov_b32 s72, 32768
    s_waitcnt lgkmcnt(4)
    v_mfma_f32_16x16x32_bf16 v[24:27], a[8:11], v[60:63], v[24:27]
    buffer_load_dwordx4 v8, s[60:63], s72 offen offset:0 sc1 lds
    v_mfma_f32_16x16x32_bf16 v[28:31], a[12:15], v[60:63], v[28:31]
    s_waitcnt lgkmcnt(2)
    v_mfma_f32_16x16x32_bf16 v[28:31], a[20:23], v[64:67], v[28:31]
    s_add_u32 m0, s43, 40704
    ds_read_b128 v[56:59], v98 offset:8192
    ds_read_b128 v[60:63], v99 offset:8192
    v_mfma_f32_16x16x32_bf16 v[24:27], a[16:19], v[64:67], v[24:27]
    buffer_load_dwordx4 v8, s[60:63], s72 offen offset:256 sc1 lds
    v_mfma_f32_16x16x32_bf16 v[24:27], a[24:27], v[68:71], v[24:27]
    s_waitcnt vmcnt(7)
    s_barrier
    v_mfma_f32_16x16x32_bf16 v[28:31], a[28:31], v[68:71], v[28:31]
    s_waitcnt lgkmcnt(2)
    v_mfma_f32_16x16x32_bf16 v[28:31], a[36:39], v[72:75], v[28:31]
    s_add_u32 m0, s43, 48640
    ds_read_b128 v[64:67], v96 offset:16384
    ds_read_b128 v[68:71], v97 offset:16384
    v_mfma_f32_16x16x32_bf16 v[24:27], a[32:35], v[72:75], v[24:27]
    buffer_load_dwordx4 v8, s[60:63], s72 offen offset:512 sc1 lds
    v_mfma_f32_16x16x32_bf16 v[24:27], a[40:43], v[76:79], v[24:27]
    v_mfma_f32_16x16x32_bf16 v[28:31], a[44:47], v[76:79], v[28:31]
    s_waitcnt lgkmcnt(2)
    v_mfma_f32_16x16x32_bf16 v[28:31], a[52:55], v[56:59], v[28:31]
    s_add_u32 m0, s43, 56576
    ds_read_b128 v[72:75], v98 offset:16384
    ds_read_b128 v[76:79], v99 offset:16384
    v_mfma_f32_16x16x32_bf16 v[24:27], a[48:51], v[56:59], v[24:27]
    buffer_load_dwordx4 v8, s[60:63], s72 offen offset:768 sc1 lds
    v_mfma_f32_16x16x32_bf16 v[24:27], a[56:59], v[60:63], v[24:27]
    v_mfma_f32_16x16x32_bf16 v[28:31], a[60:63], v[60:63], v[28:31]
    s_waitcnt lgkmcnt(2)
    v_mfma_f32_16x16x32_bf16 v[28:31], a[68:71], v[64:67], v[28:31]
    s_add_u32 m0, s43, 36864
    ds_read_b128 v[56:59], v96 offset:24576
    ds_read_b128 v[60:63], v97 offset:24576
    v_mfma_f32_16x16x32_bf16 v[24:27], a[64:67], v[64:67], v[24:27]
    s_mov_b32 s72, 49152
    v_mfma_f32_16x16x32_bf16 v[24:27], a[72:75], v[68:71], v[24:27]
    buffer_load_dwordx4 v8, s[60:63], s72 offen offset:0 sc1 lds
    v_mfma_f32_16x16x32_bf16 v[28:31], a[76:79], v[68:71], v[28:31]
    s_waitcnt lgkmcnt(2)
    v_mfma_f32_16x16x32_bf16 v[28:31], a[84:87], v[72:75], v[28:31]
    s_add_u32 m0, s43, 44800
    ds_read_b128 v[64:67], v98 offset:24576
    ds_read_b128 v[68:71], v99 offset:24576
    v_mfma_f32_16x16x32_bf16 v[24:27], a[80:83], v[72:75], v[24:27]
    s_add_u32 s70, s69, 9
    buffer_load_dword v2, v4, s[60:63], 0 offen sc1
    v_mfma_f32_16x16x32_bf16 v[24:27], a[88:91], v[76:79], v[24:27]
    s_waitcnt vmcnt(6)
    s_barrier
    v_mfma_f32_16x16x32_bf16 v[28:31], a[92:95], v[76:79], v[28:31]
    s_waitcnt lgkmcnt(2)
    buffer_load_dwordx4 v8, s[60:63], s72 offen offset:256 sc1 lds
    v_mfma_f32_16x16x32_bf16 v[28:31], a[100:103], v[56:59], v[28:31]
    s_add_u32 m0, s43, 52736
    ds_read_b128 v[72:75], v96 offset:4096
    ds_read_b128 v[76:79], v97 offset:4096
    v_mfma_f32_16x16x32_bf16 v[24:27], a[96:99], v[56:59], v[24:27]
    buffer_load_dwordx4 v8, s[60:63], s72 offen offset:512 sc1 lds
    v_mfma_f32_16x16x32_bf16 v[24:27], a[104:107], v[60:63], v[24:27]
    v_mfma_f32_16x16x32_bf16 v[28:31], a[108:111], v[60:63], v[28:31]
    s_waitcnt lgkmcnt(2)
    v_mfma_f32_16x16x32_bf16 v[28:31], a[116:119], v[64:67], v[28:31]
    s_add_u32 m0, s43, 60672
    ds_read_b128 v[56:59], v98 offset:4096
    ds_read_b128 v[60:63], v99 offset:4096
    v_mfma_f32_16x16x32_bf16 v[24:27], a[112:115], v[64:67], v[24:27]
    buffer_load_dwordx4 v8, s[60:63], s72 offen offset:768 sc1 lds
    v_mfma_f32_16x16x32_bf16 v[24:27], a[120:123], v[68:71], v[24:27]
    v_mfma_f32_16x16x32_bf16 v[28:31], a[124:127], v[68:71], v[28:31]
    s_waitcnt lgkmcnt(2)
    v_mfma_f32_16x16x32_bf16 v[36:39], a[4:7], v[72:75], 0
    ds_read_b128 v[64:67], v96 offset:12288
    ds_read_b128 v[68:71], v97 offset:12288
    v_mfma_f32_16x16x32_bf16 v[32:35], a[0:3], v[72:75], 0
    v_mfma_f32_16x16x32_bf16 v[32:35], a[8:11], v[76:79], v[32:35]
    v_mfma_f32_16x16x32_bf16 v[36:39], a[12:15], v[76:79], v[36:39]
    s_waitcnt lgkmcnt(2)
    v_mfma_f32_16x16x32_bf16 v[36:39], a[20:23], v[56:59], v[36:39]
    ds_read_b128 v[72:75], v98 offset:12288
    ds_read_b128 v[76:79], v99 offset:12288
    v_mfma_f32_16x16x32_bf16 v[32:35], a[16:19], v[56:59], v[32:35]
    v_mfma_f32_16x16x32_bf16 v[32:35], a[24:27], v[60:63], v[32:35]
    v_exp_f32 v80, -v24
    v_mfma_f32_16x16x32_bf16 v[36:39], a[28:31], v[60:63], v[36:39]
    s_waitcnt lgkmcnt(2)
    v_exp_f32 v81, -v25
    v_mfma_f32_16x16x32_bf16 v[36:39], a[36:39], v[64:67], v[36:39]
    ds_read_b128 v[56:59], v96 offset:20480
    ds_read_b128 v[60:63], v97 offset:20480
    v_add_f32 v80, 1.0, v80
    v_mfma_f32_16x16x32_bf16 v[32:35], a[32:35], v[64:67], v[32:35]
    v_rcp_f32 v80, v80
    v_mfma_f32_16x16x32_bf16 v[32:35], a[40:43], v[68:71], v[32:35]
    v_exp_f32 v82, -v26
    v_mfma_f32_16x16x32_bf16 v[36:39], a[44:47], v[68:71], v[36:39]
    s_waitcnt lgkmcnt(2)
    v_exp_f32 v83, -v27
    v_mul_f32 v80, v80, v24
    v_mfma_f32_16x16x32_bf16 v[36:39], a[52:55], v[72:75], v[36:39]
    ds_read_b128 v[64:67], v98 offset:20480
    ds_read_b128 v[68:71], v99 offset:20480
    v_mfma_f32_16x16x32_bf16 v[32:35], a[48:51], v[72:75], v[32:35]
    s_waitcnt vmcnt(3)
    v_subrev_u32 v2, s70, v2
    v_cmp_le_u32 vcc, 16, v2
    v_add_f32 v81, 1.0, v81
    v_mfma_f32_16x16x32_bf16 v[32:35], a[56:59], v[76:79], v[32:35]
    s_cbranch_vccnz L_slow_122
L_back_123:
    v_mfma_f32_16x16x32_bf16 v[36:39], a[60:63], v[76:79], v[36:39]
    s_waitcnt lgkmcnt(2)
    v_rcp_f32 v81, v81
    v_mfma_f32_16x16x32_bf16 v[36:39], a[68:71], v[56:59], v[36:39]
    s_add_u32 m0, s43, 65536
    ds_read_b128 v[72:75], v96 offset:28672
    ds_read_b128 v[76:79], v97 offset:28672
    v_mul_f32 v81, v81, v25
    v_mfma_f32_16x16x32_bf16 v[32:35], a[64:67], v[56:59], v[32:35]
    s_mov_b32 s72, 65536
    v_exp_f32 v84, -v28
    v_mfma_f32_16x16x32_bf16 v[32:35], a[72:75], v[60:63], v[32:35]
    buffer_load_dwordx4 v8, s[60:63], s72 offen offset:0 sc1 lds
    v_mfma_f32_16x16x32_bf16 v[36:39], a[76:79], v[60:63], v[36:39]
    s_waitcnt lgkmcnt(2)
    v_exp_f32 v85, -v29
    v_cvt_pk_bf16_f32 v88, v80, v81
    v_mfma_f32_16x16x32_bf16 v[36:39], a[84:87], v[64:67], v[36:39]
    s_add_u32 m0, s43, 73472
    ds_read_b128 v[56:59], v98 offset:28672
    ds_read_b128 v[60:63], v99 offset:28672
    v_mfma_f32_16x16x32_bf16 v[32:35], a[80:83], v[64:67], v[32:35]
    buffer_load_dwordx4 v8, s[60:63], s72 offen offset:256 sc1 lds
    v_add_f32 v82, 1.0, v82
    v_mfma_f32_16x16x32_bf16 v[32:35], a[88:91], v[68:71], v[32:35]
    s_barrier
    v_mfma_f32_16x16x32_bf16 v[36:39], a[92:95], v[68:71], v[36:39]
    s_waitcnt lgkmcnt(2)
    v_rcp_f32 v82, v82
    v_mfma_f32_16x16x32_bf16 v[36:39], a[100:103], v[72:75], v[36:39]
    s_add_u32 m0, s43, 81408
    ds_read_b128 v[64:67], v96 offset:32768
    ds_read_b128 v[68:71], v97 offset:32768
    v_mul_f32 v82, v82, v26
    v_mfma_f32_16x16x32_bf16 v[32:35], a[96:99], v[72:75], v[32:35]
    buffer_load_dwordx4 v8, s[60:63], s72 offen offset:512 sc1 lds
    v_mfma_f32_16x16x32_bf16 v[32:35], a[104:107], v[76:79], v[32:35]
    v_exp_f32 v86, -v30
    v_mfma_f32_16x16x32_bf16 v[36:39], a[108:111], v[76:79], v[36:39]
    s_waitcnt lgkmcnt(2)
    v_exp_f32 v87, -v31
    v_add_f32 v83, 1.0, v83
    v_mfma_f32_16x16x32_bf16 v[36:39], a[116:119], v[56:59], v[36:39]
    s_add_u32 m0, s43, 89344
    ds_read_b128 v[72:75], v98 offset:32768
    ds_read_b128 v[76:79], v99 offset:32768
    v_mfma_f32_16x16x32_bf16 v[32:35], a[112:115], v[56:59], v[32:35]
    buffer_load_dwordx4 v8, s[60:63], s72 offen offset:768 sc1 lds
    v_add_f32 v84, 1.0, v84
    v_mfma_f32_16x16x32_bf16 v[32:35], a[120:123], v[60:63], v[32:35]
    v_rcp_f32 v83, v83
    v_mfma_f32_16x16x32_bf16 v[36:39], a[124:127], v[60:63], v[36:39]
    s_waitcnt lgkmcnt(2)
    v_rcp_f32 v84, v84
    v_mfma_f32_16x16x32_bf16 v[44:47], a[4:7], v[64:67], 0
    s_add_u32 m0, s43, 69632
    ds_read_b128 v[56:59], v96 offset:40960
    ds_read_b128 v[60:63], v97 offset:40960
    v_mul_f32 v83, v83, v27
    v_mfma_f32_16x16x32_bf16 v[40:43], a[0:3], v[64:67], 0
    s_mov_b32 s72, 81920
    v_cvt_pk_bf16_f32 v89, v82, v83
    v_mul_f32 v84, v84, v28
    v_mfma_f32_16x16x32_bf16 v[40:43], a[8:11], v[68:71], v[40:43]
    buffer_load_dwordx4 v8, s[60:63], s72 offen offset:0 sc1 lds
    v_mfma_f32_16x16x32_bf16 v[44:47], a[12:15], v[68:71], v[44:47]
    s_waitcnt lgkmcnt(2)
    v_add_f32 v85, 1.0, v85
    v_add_f32 v86, 1.0, v86
    v_add_f32 v87, 1.0, v87
    v_mfma_f32_16x16x32_bf16 v[44:47], a[20:23], v[72:75], v[44:47]
    s_add_u32 m0, s43, 77568
    ds_read_b128 v[64:67], v98 offset:40960
    ds_read_b128 v[68:71], v99 offset:40960
    v_mfma_f32_16x16x32_bf16 v[40:43], a[16:19], v[72:75], v[40:43]
    buffer_load_dwordx4 v8, s[60:63], s72 offen offset:256 sc1 lds
    v_mfma_f32_16x16x32_bf16 v[40:43], a[24:27], v[76:79], v[40:43]
    v_rcp_f32 v85, v85
    v_mfma_f32_16x16x32_bf16 v[44:47], a[28:31], v[76:79], v[44:47]
    s_waitcnt lgkmcnt(2)
    v_rcp_f32 v86, v86
    v_mfma_f32_16x16x32_bf16 v[44:47], a[36:39], v[56:59], v[44:47]
    s_add_u32 m0, s43, 85504
    ds_read_b128 v[72:75], v96 offset:49152
    ds_read_b128 v[76:79], v97 offset:49152
    v_mul_f32 v85, v85, v29
    v_mfma_f32_16x16x32_bf16 v[40:43], a[32:35], v[56:59], v[40:43]
    buffer_load_dwordx4 v8, s[60:63], s72 offen offset:512 sc1 lds
    v_mfma_f32_16x16x32_bf16 v[40:43], a[40:43], v[60:63], v[40:43]
    v_rcp_f32 v87, v87
    v_mfma_f32_16x16x32_bf16 v[44:47], a[44:47], v[60:63], v[44:47]
    s_waitcnt lgkmcnt(2)
    v_cvt_pk_bf16_f32 v90, v84, v85
    v_mul_f32 v86, v86, v30
    v_mul_f32 v87, v87, v31
    v_mfma_f32_16x16x32_bf16 v[44:47], a[52:55], v[64:67], v[44:47]
    s_add_u32 m0, s43, 93440
    ds_read_b128 v[56:59], v98 offset:49152
    ds_read_b128 v[60:63], v99 offset:49152
    v_mfma_f32_16x16x32_bf16 v[40:43], a[48:51], v[64:67], v[40:43]
    buffer_load_dwordx4 v8, s[60:63], s72 offen offset:768 sc1 lds
    v_cvt_pk_bf16_f32 v91, v86, v87
    v_mfma_f32_16x16x32_bf16 v[40:43], a[56:59], v[68:71], v[40:43]
    s_mov_b32 s75, 917504
    buffer_store_dwordx4 v[88:91], v6, s[60:63], s75 offen sc1
    v_mfma_f32_16x16x32_bf16 v[44:47], a[60:63], v[68:71], v[44:47]
    s_waitcnt lgkmcnt(2)
    v_exp_f32 v80, -v32
    v_mfma_f32_16x16x32_bf16 v[44:47], a[68:71], v[72:75], v[44:47]
    s_add_u32 m0, s43, 98304
    ds_read_b128 v[64:67], v96 offset:57344
    ds_read_b128 v[68:71], v97 offset:57344
    v_mfma_f32_16x16x32_bf16 v[40:43], a[64:67], v[72:75], v[40:43]
    s_mov_b32 s72, 98304
    v_exp_f32 v81, -v33
    v_add_f32 v80, 1.0, v80
    v_mfma_f32_16x16x32_bf16 v[40:43], a[72:75], v[76:79], v[40:43]
    buffer_load_dwordx4 v8, s[60:63], s72 offen offset:0 sc1 lds
    v_add_f32 v81, 1.0, v81
    v_mfma_f32_16x16x32_bf16 v[44:47], a[76:79], v[76:79], v[44:47]
    s_waitcnt lgkmcnt(2)
    v_rcp_f32 v80, v80
    v_mfma_f32_16x16x32_bf16 v[44:47], a[84:87], v[56:59], v[44:47]
    s_add_u32 m0, s43, 106240
    ds_read_b128 v[72:75], v98 offset:57344
    ds_read_b128 v[76:79], v99 offset:57344
    v_mul_f32 v80, v80, v32
    v_mfma_f32_16x16x32_bf16 v[40:43], a[80:83], v[56:59], v[40:43]
    buffer_load_dwordx4 v8, s[60:63], s72 offen offset:256 sc1 lds
    v_mfma_f32_16x16x32_bf16 v[40:43], a[88:91], v[60:63], v[40:43]
    s_waitcnt vmcnt(11)
    s_barrier
    v_mfma_f32_16x16x32_bf16 v[44:47], a[92:95], v[60:63], v[44:47]
    s_waitcnt lgkmcnt(2)
    v_rcp_f32 v81, v81
    v_mfma_f32_16x16x32_bf16 v[44:47], a[100:103], v[64:67], v[44:47]
    s_add_u32 m0, s43, 114176
    ds_read_b128 v[56:59], v96 offset:36864
    ds_read_b128 v[60:63], v97 offset:36864
    v_mfma_f32_16x16x32_bf16 v[40:43], a[96:99], v[64:67], v[40:43]
    buffer_load_dwordx4 v8, s[60:63], s72 offen offset:512 sc1 lds
    v_mul_f32 v81, v81, v33
    v_mfma_f32_16x16x32_bf16 v[40:43], a[104:107], v[68:71], v[40:43]
    v_exp_f32 v82, -v34
    v_cvt_pk_bf16_f32 v92, v80, v81
    v_mfma_f32_16x16x32_bf16 v[44:47], a[108:111], v[68:71], v[44:47]
    s_waitcnt lgkmcnt(2)
    v_exp_f32 v83, -v35
    v_mfma_f32_16x16x32_bf16 v[44:47], a[116:119], v[72:75], v[44:47]
    s_add_u32 m0, s43, 122112
    ds_read_b128 v[64:67], v98 offset:36864
    ds_read_b128 v[68:71], v99 offset:36864
    v_add_f32 v82, 1.0, v82
    v_mfma_f32_16x16x32_bf16 v[40:43], a[112:115], v[72:75], v[40:43]
    buffer_load_dwordx4 v8, s[60:63], s72 offen offset:768 sc1 lds
    v_add_f32 v83, 1.0, v83
    v_mfma_f32_16x16x32_bf16 v[40:43], a[120:123], v[76:79], v[40:43]
    v_rcp_f32 v82, v82
    v_mfma_f32_16x16x32_bf16 v[44:47], a[124:127], v[76:79], v[44:47]
    s_waitcnt lgkmcnt(2)
    v_rcp_f32 v83, v83
    v_mul_f32 v82, v82, v34
    v_mfma_f32_16x16x32_bf16 v[52:55], a[4:7], v[56:59], 0
    s_add_u32 m0, s43, 102400
    ds_read_b128 v[72:75], v96 offset:45056
    ds_read_b128 v[76:79], v97 offset:45056
    v_mfma_f32_16x16x32_bf16 v[48:51], a[0:3], v[56:59], 0
    s_mov_b32 s72, 114688
    v_exp_f32 v84, -v36
    v_mul_f32 v83, v83, v35
    v_mfma_f32_16x16x32_bf16 v[48:51], a[8:11], v[60:63], v[48:51]
    buffer_load_dwordx4 v8, s[60:63], s72 offen offset:0 sc1 lds
    v_cvt_pk_bf16_f32 v93, v82, v83
    v_mfma_f32_16x16x32_bf16 v[52:55], a[12:15], v[60:63], v[52:55]
    s_waitcnt lgkmcnt(2)
    v_exp_f32 v85, -v37
    v_mfma_f32_16x16x32_bf16 v[52:55], a[20:23], v[64:67], v[52:55]
    s_add_u32 m0, s43, 110336
    ds_read_b128 v[56:59], v98 offset:45056
    ds_read_b128 v[60:63], v99 offset:45056
    v_add_f32 v84, 1.0, v84
    v_mfma_f32_16x16x32_bf16 v[48:51], a[16:19], v[64:67], v[48:51]
    buffer_load_dwordx4 v8, s[60:63], s72 offen offset:256 sc1 lds
    v_add_f32 v85, 1.0, v85
    v_mfma_f32_16x16x32_bf16 v[48:51], a[24:27], v[68:71], v[48:51]
    v_rcp_f32 v84, v84
    v_mfma_f32_16x16x32_bf16 v[52:55], a[28:31], v[68:71], v[52:55]
    s_waitcnt lgkmcnt(2)
    v_rcp_f32 v85, v85
    v_mul_f32 v84, v84, v36
    v_mfma_f32_16x16x32_bf16 v[52:55], a[36:39], v[72:75], v[52:55]
    s_add_u32 m0, s43, 118272
    ds_read_b128 v[64:67], v96 offset:53248
    ds_read_b128 v[68:71], v97 offset:53248
    v_mfma_f32_16x16x32_bf16 v[48:51], a[32:35], v[72:75], v[48:51]
    buffer_load_dwordx4 v8, s[60:63], s72 offen offset:512 sc1 lds
    v_mul_f32 v85, v85, v37
    v_mfma_f32_16x16x32_bf16 v[48:51], a[40:43], v[76:79], v[48:51]
    v_exp_f32 v86, -v38
    v_cvt_pk_bf16_f32 v94, v84, v85
    v_mfma_f32_16x16x32_bf16 v[52:55], a[44:47], v[76:79], v[52:55]
    s_waitcnt lgkmcnt(2)
    v_exp_f32 v87, -v39
    v_mfma_f32_16x16x32_bf16 v[52:55], a[52:55], v[56:59], v[52:55]
    s_add_u32 m0, s43, 126208
    ds_read_b128 v[72:75], v98 offset:53248
    ds_read_b128 v[76:79], v99 offset:53248
    v_add_f32 v86, 1.0, v86
    v_mfma_f32_16x16x32_bf16 v[48:51], a[48:51], v[56:59], v[48:51]
    buffer_load_dwordx4 v8, s[60:63], s72 offen offset:768 sc1 lds
    v_add_f32 v87, 1.0, v87
    v_mfma_f32_16x16x32_bf16 v[48:51], a[56:59], v[60:63], v[48:51]
    v_rcp_f32 v86, v86
    v_mfma_f32_16x16x32_bf16 v[52:55], a[60:63], v[60:63], v[52:55]
    s_waitcnt lgkmcnt(2)
    v_rcp_f32 v87, v87
    v_mul_f32 v86, v86, v38
    v_mfma_f32_16x16x32_bf16 v[52:55], a[68:71], v[64:67], v[52:55]
    ds_read_b128 v[56:59], v96 offset:61440
    ds_read_b128 v[60:63], v97 offset:61440
    v_mfma_f32_16x16x32_bf16 v[48:51], a[64:67], v[64:67], v[48:51]
    v_xor_b32 v96, 0x10000, v96
    v_xor_b32 v97, 0x10000, v97
    v_mul_f32 v87, v87, v39
    v_mfma_f32_16x16x32_bf16 v[48:51], a[72:75], v[68:71], v[48:51]
    v_cvt_pk_bf16_f32 v95, v86, v87
    v_mfma_f32_16x16x32_bf16 v[52:55], a[76:79], v[68:71], v[52:55]
    s_waitcnt lgkmcnt(2)
    s_mov_b32 s75, 974848
    buffer_store_dwordx4 v[92:95], v6, s[60:63], s75 offen sc1
    v_mfma_f32_16x16x32_bf16 v[52:55], a[84:87], v[72:75], v[52:55]
    ds_read_b128 v[64:67], v98 offset:61440
    ds_read_b128 v[68:71], v99 offset:61440
    v_mfma_f32_16x16x32_bf16 v[48:51], a[80:83], v[72:75], v[48:51]
    v_xor_b32 v98, 0x10000, v98
    v_xor_b32 v99, 0x10000, v99
    v_mfma_f32_16x16x32_bf16 v[48:51], a[88:91], v[76:79], v[48:51]
    s_waitcnt vmcnt(10)
    s_barrier
    v_mfma_f32_16x16x32_bf16 v[52:55], a[92:95], v[76:79], v[52:55]
    s_waitcnt lgkmcnt(2)
    v_or_b32 v16, 10, v17
    v_mfma_f32_16x16x32_bf16 v[52:55], a[100:103], v[56:59], v[52:55]
    ds_read_b128 v[72:75], v96 offset:0
    ds_read_b128 v[76:79], v97 offset:0
    v_mfma_f32_16x16x32_bf16 v[48:51], a[96:99], v[56:59], v[48:51]
    v_exp_f32 v80, -v40
    v_mfma_f32_16x16x32_bf16 v[48:51], a[104:107], v[60:63], v[48:51]
    v_exp_f32 v81, -v41
    v_add_f32 v80, 1.0, v80
    v_mfma_f32_16x16x32_bf16 v[52:55], a[108:111], v[60:63], v[52:55]
    s_waitcnt lgkmcnt(2)
    v_rcp_f32 v80, v80
    v_mfma_f32_16x16x32_bf16 v[52:55], a[116:119], v[64:67], v[52:55]
    ds_read_b128 v[56:59], v98 offset:0
    ds_read_b128 v[60:63], v99 offset:0
    v_mul_f32 v80, v80, v40
    v_mfma_f32_16x16x32_bf16 v[48:51], a[112:115], v[64:67], v[48:51]
    v_exp_f32 v82, -v42
    v_mfma_f32_16x16x32_bf16 v[48:51], a[120:123], v[68:71], v[48:51]
    v_exp_f32 v83, -v43
    v_add_f32 v81, 1.0, v81
    v_mfma_f32_16x16x32_bf16 v[52:55], a[124:127], v[68:71], v[52:55]
    s_waitcnt lgkmcnt(2)
    v_rcp_f32 v81, v81
    v_mfma_f32_16x16x32_bf16 v[28:31], a[4:7], v[72:75], 0
    ds_read_b128 v[64:67], v96 offset:8192
    ds_read_b128 v[68:71], v97 offset:8192
    v_mul_f32 v81, v81, v41
    v_mfma_f32_16x16x32_bf16 v[24:27], a[0:3], v[72:75], 0
    v_exp_f32 v84, -v44
    v_mfma_f32_16x16x32_bf16 v[24:27], a[8:11], v[76:79], v[24:27]
    v_exp_f32 v85, -v45
    v_cvt_pk_bf16_f32 v88, v80, v81
    v_mfma_f32_16x16x32_bf16 v[28:31], a[12:15], v[76:79], v[28:31]
    s_waitcnt lgkmcnt(2)
    v_exp_f32 v86, -v46
    v_mfma_f32_16x16x32_bf16 v[28:31], a[20:23], v[56:59], v[28:31]
    ds_read_b128 v[72:75], v98 offset:8192
    ds_read_b128 v[76:79], v99 offset:8192
    v_add_f32 v82, 1.0, v82
    v_mfma_f32_16x16x32_bf16 v[24:27], a[16:19], v[56:59], v[24:27]
    v_rcp_f32 v82, v82
    v_mfma_f32_16x16x32_bf16 v[24:27], a[24:27], v[60:63], v[24:27]
    v_exp_f32 v87, -v47
    v_mul_f32 v82, v82, v42
    v_mfma_f32_16x16x32_bf16 v[28:31], a[28:31], v[60:63], v[28:31]
    s_waitcnt lgkmcnt(2)
    v_add_f32 v83, 1.0, v83
    v_add_f32 v84, 1.0, v84
    v_mfma_f32_16x16x32_bf16 v[28:31], a[36:39], v[64:67], v[28:31]
    ds_read_b128 v[56:59], v96 offset:16384
    ds_read_b128 v[60:63], v97 offset:16384
    v_add_f32 v85, 1.0, v85
    v_mfma_f32_16x16x32_bf16 v[24:27], a[32:35], v[64:67], v[24:27]
    v_rcp_f32 v83, v83
    v_mfma_f32_16x16x32_bf16 v[24:27], a[40:43], v[68:71], v[24:27]
    v_rcp_f32 v84, v84
    v_mul_f32 v83, v83, v43
    v_mfma_f32_16x16x32_bf16 v[28:31], a[44:47], v[68:71], v[28:31]
    s_waitcnt lgkmcnt(2)
    v_rcp_f32 v85, v85
    v_mfma_f32_16x16x32_bf16 v[28:31], a[52:55], v[72:75], v[28:31]
    ds_read_b128 v[64:67], v98 offset:16384
    ds_read_b128 v[68:71], v99 offset:16384
    v_cvt_pk_bf16_f32 v89, v82, v83
    v_mfma_f32_16x16x32_bf16 v[24:27], a[48:51], v[72:75], v[24:27]
    v_mul_f32 v84, v84, v44
    v_mul_f32 v85, v85, v45
    v_mfma_f32_16x16x32_bf16 v[24:27], a[56:59], v[76:79], v[24:27]
    v_cvt_pk_bf16_f32 v90, v84, v85
    v_add_f32 v86, 1.0, v86
    v_add_f32 v87, 1.0, v87
    v_mfma_f32_16x16x32_bf16 v[28:31], a[60:63], v[76:79], v[28:31]
    s_waitcnt lgkmcnt(2)
    v_rcp_f32 v86, v86
    v_mfma_f32_16x16x32_bf16 v[28:31], a[68:71], v[56:59], v[28:31]
    ds_read_b128 v[72:75], v96 offset:24576
    ds_read_b128 v[76:79], v97 offset:24576
    v_mul_f32 v86, v86, v46
    v_mfma_f32_16x16x32_bf16 v[24:27], a[64:67], v[56:59], v[24:27]
    v_rcp_f32 v87, v87
    v_mfma_f32_16x16x32_bf16 v[24:27], a[72:75], v[60:63], v[24:27]
    v_mul_f32 v87, v87, v47
    v_mfma_f32_16x16x32_bf16 v[28:31], a[76:79], v[60:63], v[28:31]
    s_waitcnt lgkmcnt(2)
    v_cvt_pk_bf16_f32 v91, v86, v87
    v_mfma_f32_16x16x32_bf16 v[28:31], a[84:87], v[64:67], v[28:31]
    ds_read_b128 v[56:59], v98 offset:24576
    ds_read_b128 v[60:63], v99 offset:24576
    v_mfma_f32_16x16x32_bf16 v[24:27], a[80:83], v[64:67], v[24:27]
    s_mov_b32 s75, 1032192
    buffer_store_dwordx4 v[88:91], v6, s[60:63], s75 offen sc1
    v_mfma_f32_16x16x32_bf16 v[24:27], a[88:91], v[68:71], v[24:27]
    v_exp_f32 v80, -v48
    v_mfma_f32_16x16x32_bf16 v[28:31], a[92:95], v[68:71], v[28:31]
    s_waitcnt lgkmcnt(2)
    v_exp_f32 v81, -v49
    v_add_f32 v80, 1.0, v80
    v_mfma_f32_16x16x32_bf16 v[28:31], a[100:103], v[72:75], v[28:31]
    ds_read_b128 v[64:67], v96 offset:4096
    ds_read_b128 v[68:71], v97 offset:4096
    v_rcp_f32 v80, v80
    v_mfma_f32_16x16x32_bf16 v[24:27], a[96:99], v[72:75], v[24:27]
    v_exp_f32 v82, -v50
    v_mul_f32 v80, v80, v48
    v_mfma_f32_16x16x32_bf16 v[24:27], a[104:107], v[76:79], v[24:27]
    v_lshrrev_b32 v20, 10, v5
    v_lshlrev_b32 v20, 3, v20
    v_add_f32 v81, 1.0, v81
    v_mfma_f32_16x16x32_bf16 v[28:31], a[108:111], v[76:79], v[28:31]
    s_waitcnt lgkmcnt(2)
    s_mov_b32 s74, 2098176
    buffer_load_dwordx2 v[146:147], v20, s[60:63], s74 offen offset:0 sc1
    v_mfma_f32_16x16x32_bf16 v[28:31], a[116:119], v[56:59], v[28:31]
    ds_read_b128 v[72:75], v98 offset:4096
    ds_read_b128 v[76:79], v99 offset:4096
    v_rcp_f32 v81, v81
    v_mfma_f32_16x16x32_bf16 v[24:27], a[112:115], v[56:59], v[24:27]
    buffer_load_dwordx2 v[150:151], v20, s[60:63], s74 offen offset:256 sc1
    v_mul_f32 v81, v81, v49
    v_mfma_f32_16x16x32_bf16 v[24:27], a[120:123], v[60:63], v[24:27]
    buffer_load_dwordx2 v[154:155], v20, s[60:63], s74 offen offset:512 sc1
    v_cvt_pk_bf16_f32 v92, v80, v81
    v_mfma_f32_16x16x32_bf16 v[28:31], a[124:127], v[60:63], v[28:31]
    s_waitcnt lgkmcnt(2)
    buffer_load_dwordx2 v[158:159], v20, s[60:63], s74 offen offset:768 sc1
    v_add_f32 v82, 1.0, v82
    v_mfma_f32_16x16x32_bf16 v[36:39], a[4:7], v[64:67], 0
    ds_read_b128 v[56:59], v96 offset:12288
    ds_read_b128 v[60:63], v97 offset:12288
    v_rcp_f32 v82, v82
    v_mfma_f32_16x16x32_bf16 v[32:35], a[0:3], v[64:67], 0
    s_mov_b32 s74, 0
    buffer_load_dwordx2 v[144:145], v5, s[60:63], s74 offen sc1
    v_mul_f32 v82, v82, v50
    v_mfma_f32_16x16x32_bf16 v[32:35], a[8:11], v[68:71], v[32:35]
    s_mov_b32 s74, 32768
    buffer_load_dwordx2 v[148:149], v5, s[60:63], s74 offen sc1
    v_mfma_f32_16x16x32_bf16 v[36:39], a[12:15], v[68:71], v[36:39]
    s_waitcnt lgkmcnt(2)
    s_mov_b32 s74, 65536
    buffer_load_dwordx2 v[152:153], v5, s[60:63], s74 offen sc1
    v_mfma_f32_16x16x32_bf16 v[36:39], a[20:23], v[72:75], v[36:39]
    ds_read_b128 v[64:67], v98 offset:12288
    ds_read_b128 v[68:71], v99 offset:12288
    v_exp_f32 v83, -v51
    v_mfma_f32_16x16x32_bf16 v[32:35], a[16:19], v[72:75], v[32:35]
    s_mov_b32 s74, 98304
    buffer_load_dwordx2 v[156:157], v5, s[60:63], s74 offen sc1
    v_add_f32 v83, 1.0, v83
    v_mfma_f32_16x16x32_bf16 v[32:35], a[24:27], v[76:79], v[32:35]
    s_or_b32 s74, s2, s66
    v_or_b32 v21, s74, v1
    v_cmp_eq_u32 s[84:85], 0, v21
    v_mfma_f32_16x16x32_bf16 v[36:39], a[28:31], v[76:79], v[36:39]
    s_waitcnt lgkmcnt(2)
    v_mov_b32 v20, s69
    v_rcp_f32 v83, v83
    v_mfma_f32_16x16x32_bf16 v[36:39], a[36:39], v[56:59], v[36:39]
    ds_read_b128 v[72:75], v96 offset:20480
    ds_read_b128 v[76:79], v97 offset:20480
    v_exp_f32 v84, -v52
    v_mfma_f32_16x16x32_bf16 v[32:35], a[32:35], v[56:59], v[32:35]
    v_cndmask_b32 v21, -1, v21, s[84:85]
    v_exp_f32 v85, -v53
    v_mfma_f32_16x16x32_bf16 v[32:35], a[40:43], v[60:63], v[32:35]
    buffer_store_dword v20, v21, s[52:55], 0 offen sc1
    v_mfma_f32_16x16x32_bf16 v[36:39], a[44:47], v[60:63], v[36:39]
    s_waitcnt lgkmcnt(2)
    v_exp_f32 v86, -v54
    v_mul_f32 v83, v83, v51
    v_mfma_f32_16x16x32_bf16 v[36:39], a[52:55], v[64:67], v[36:39]
    ds_read_b128 v[56:59], v98 offset:20480
    ds_read_b128 v[60:63], v99 offset:20480
    v_exp_f32 v87, -v55
    v_mfma_f32_16x16x32_bf16 v[32:35], a[48:51], v[64:67], v[32:35]
    v_cvt_pk_bf16_f32 v93, v82, v83
    v_add_f32 v84, 1.0, v84
    v_add_f32 v85, 1.0, v85
    v_mfma_f32_16x16x32_bf16 v[32:35], a[56:59], v[68:71], v[32:35]
    v_rcp_f32 v84, v84
    v_add_f32 v86, 1.0, v86
    v_mfma_f32_16x16x32_bf16 v[36:39], a[60:63], v[68:71], v[36:39]
    s_waitcnt lgkmcnt(2)
    v_rcp_f32 v85, v85
    v_mul_f32 v84, v84, v52
    v_mfma_f32_16x16x32_bf16 v[36:39], a[68:71], v[72:75], v[36:39]
    ds_read_b128 v[64:67], v96 offset:28672
    ds_read_b128 v[68:71], v97 offset:28672
    v_rcp_f32 v86, v86
    v_mfma_f32_16x16x32_bf16 v[32:35], a[64:67], v[72:75], v[32:35]
    v_mul_f32 v85, v85, v53
    v_mul_f32 v86, v86, v54
    v_add_f32 v87, 1.0, v87
    v_mfma_f32_16x16x32_bf16 v[32:35], a[72:75], v[76:79], v[32:35]
    s_waitcnt vmcnt(10)
    buffer_store_dword v16, v3, s[60:63], 0 offen sc1
    v_mfma_f32_16x16x32_bf16 v[36:39], a[76:79], v[76:79], v[36:39]
    s_waitcnt lgkmcnt(2)
    v_rcp_f32 v87, v87
    v_cvt_pk_bf16_f32 v94, v84, v85
    v_mfma_f32_16x16x32_bf16 v[36:39], a[84:87], v[56:59], v[36:39]
    ds_read_b128 v[72:75], v98 offset:28672
    ds_read_b128 v[76:79], v99 offset:28672
    v_mul_f32 v87, v87, v55
    v_mfma_f32_16x16x32_bf16 v[32:35], a[80:83], v[56:59], v[32:35]
    v_cvt_pk_bf16_f32 v95, v86, v87
    v_mfma_f32_16x16x32_bf16 v[32:35], a[88:91], v[60:63], v[32:35]
    s_barrier
    v_mfma_f32_16x16x32_bf16 v[36:39], a[92:95], v[60:63], v[36:39]
    s_waitcnt lgkmcnt(2)
    s_mov_b32 s75, 1089536
    buffer_store_dwordx4 v[92:95], v6, s[60:63], s75 offen sc1
    v_mfma_f32_16x16x32_bf16 v[36:39], a[100:103], v[64:67], v[36:39]
    ds_read_b128 v[56:59], v96 offset:32768
    ds_read_b128 v[60:63], v97 offset:32768
    v_mfma_f32_16x16x32_bf16 v[32:35], a[96:99], v[64:67], v[32:35]
    v_or_b32 v16, 11, v17
    v_exp_f32 v80, -v24
    v_mfma_f32_16x16x32_bf16 v[32:35], a[104:107], v[68:71], v[32:35]
    v_exp_f32 v81, -v25
    v_mfma_f32_16x16x32_bf16 v[36:39], a[108:111], v[68:71], v[36:39]
    s_waitcnt lgkmcnt(2)
    v_exp_f32 v82, -v26
    v_mfma_f32_16x16x32_bf16 v[36:39], a[116:119], v[72:75], v[36:39]
    ds_read_b128 v[64:67], v98 offset:32768
    ds_read_b128 v[68:71], v99 offset:32768
    v_add_f32 v80, 1.0, v80
    v_mfma_f32_16x16x32_bf16 v[32:35], a[112:115], v[72:75], v[32:35]
    v_rcp_f32 v80, v80
    v_mfma_f32_16x16x32_bf16 v[32:35], a[120:123], v[76:79], v[32:35]
    v_exp_f32 v83, -v27
    v_mul_f32 v80, v80, v24
    v_mfma_f32_16x16x32_bf16 v[36:39], a[124:127], v[76:79], v[36:39]
    s_waitcnt lgkmcnt(2)
    v_exp_f32 v84, -v28
    v_mfma_f32_16x16x32_bf16 v[44:47], a[4:7], v[56:59], 0
    ds_read_b128 v[72:75], v96 offset:40960
    ds_read_b128 v[76:79], v97 offset:40960
    v_mfma_f32_16x16x32_bf16 v[40:43], a[0:3], v[56:59], 0
    v_exp_f32 v85, -v29
    v_add_f32 v81, 1.0, v81
    v_mfma_f32_16x16x32_bf16 v[40:43], a[8:11], v[60:63], v[40:43]
    v_rcp_f32 v81, v81
    v_mfma_f32_16x16x32_bf16 v[44:47], a[12:15], v[60:63], v[44:47]
    s_waitcnt lgkmcnt(2)
    v_exp_f32 v86, -v30
    v_mfma_f32_16x16x32_bf16 v[44:47], a[20:23], v[64:67], v[44:47]
    ds_read_b128 v[56:59], v98 offset:40960
    ds_read_b128 v[60:63], v99 offset:40960
    v_mul_f32 v81, v81, v25
    v_mfma_f32_16x16x32_bf16 v[40:43], a[16:19], v[64:67], v[40:43]
    v_exp_f32 v87, -v31
    v_mfma_f32_16x16x32_bf16 v[40:43], a[24:27], v[68:71], v[40:43]
    v_cvt_pk_bf16_f32 v88, v80, v81
    v_add_f32 v82, 1.0, v82
    v_add_f32 v83, 1.0, v83
    v_mfma_f32_16x16x32_bf16 v[44:47], a[28:31], v[68:71], v[44:47]
    s_waitcnt lgkmcnt(2)
    v_rcp_f32 v82, v82
    v_mfma_f32_16x16x32_bf16 v[44:47], a[36:39], v[72:75], v[44:47]
    ds_read_b128 v[64:67], v96 offset:49152
    ds_read_b128 v[68:71], v97 offset:49152
    v_mfma_f32_16x16x32_bf16 v[40:43], a[32:35], v[72:75], v[40:43]
    v_rcp_f32 v83, v83
    v_mul_f32 v82, v82, v26
    v_mfma_f32_16x16x32_bf16 v[40:43], a[40:43], v[76:79], v[40:43]
    v_mul_f32 v83, v83, v27
    v_add_f32 v84, 1.0, v84
    v_mfma_f32_16x16x32_bf16 v[44:47], a[44:47], v[76:79], v[44:47]
    s_waitcnt lgkmcnt(2)
    v_rcp_f32 v84, v84
    v_mfma_f32_16x16x32_bf16 v[44:47], a[52:55], v[56:59], v[44:47]
    ds_read_b128 v[72:75], v98 offset:49152
    ds_read_b128 v[76:79], v99 offset:49152
    v_cvt_pk_bf16_f32 v89, v82, v83
    v_mfma_f32_16x16x32_bf16 v[40:43], a[48:51], v[56:59], v[40:43]
    v_mul_f32 v84, v84, v28
    v_add_f32 v85, 1.0, v85
    v_mfma_f32_16x16x32_bf16 v[40:43], a[56:59], v[60:63], v[40:43]
    v_rcp_f32 v85, v85
    v_add_f32 v86, 1.0, v86
    v_mfma_f32_16x16x32_bf16 v[44:47], a[60:63], v[60:63], v[44:47]
    s_waitcnt lgkmcnt(2)
    s_add_u32 s70, s69, 10
    buffer_load_dword v2, v4, s[60:63], 0 offen sc1
    v_mfma_f32_16x16x32_bf16 v[44:47], a[68:71], v[64:67], v[44:47]
    ds_read_b128 v[56:59], v96 offset:57344
    ds_read_b128 v[60:63], v97 offset:57344
    v_mfma_f32_16x16x32_bf16 v[40:43], a[64:67], v[64:67], v[40:43]
    v_rcp_f32 v86, v86
    v_mul_f32 v85, v85, v29
    v_mfma_f32_16x16x32_bf16 v[40:43], a[72:75], v[68:71], v[40:43]
    v_cvt_pk_bf16_f32 v90, v84, v85
    v_mul_f32 v86, v86, v30
    v_mfma_f32_16x16x32_bf16 v[44:47], a[76:79], v[68:71], v[44:47]
    s_waitcnt lgkmcnt(2)
    v_add_f32 v87, 1.0, v87
    v_mfma_f32_16x16x32_bf16 v[44:47], a[84:87], v[72:75], v[44:47]
    ds_read_b128 v[64:67], v98 offset:57344
    ds_read_b128 v[68:71], v99 offset:57344
    v_mfma_f32_16x16x32_bf16 v[40:43], a[80:83], v[72:75], v[40:43]
    v_rcp_f32 v87, v87
    v_mfma_f32_16x16x32_bf16 v[40:43], a[88:91], v[76:79], v[40:43]
    v_mul_f32 v87, v87, v31
    v_mfma_f32_16x16x32_bf16 v[44:47], a[92:95], v[76:79], v[44:47]
    s_waitcnt lgkmcnt(2)
    v_cvt_pk_bf16_f32 v91, v86, v87
    v_mfma_f32_16x16x32_bf16 v[44:47], a[100:103], v[56:59], v[44:47]
    ds_read_b128 v[72:75], v96 offset:36864
    ds_read_b128 v[76:79], v97 offset:36864
    v_mfma_f32_16x16x32_bf16 v[40:43], a[96:99], v[56:59], v[40:43]
    s_mov_b32 s75, 1146880
    buffer_store_dwordx4 v[88:91], v6, s[60:63], s75 offen sc1
    v_mfma_f32_16x16x32_bf16 v[40:43], a[104:107], v[60:63], v[40:43]
    v_exp_f32 v80, -v32
    v_mfma_f32_16x16x32_bf16 v[44:47], a[108:111], v[60:63], v[44:47]
    s_waitcnt lgkmcnt(2)
    v_exp_f32 v81, -v33
    v_add_f32 v80, 1.0, v80
    v_mfma_f32_16x16x32_bf16 v[44:47], a[116:119], v[64:67], v[44:47]
    ds_read_b128 v[56:59], v98 offset:36864
    ds_read_b128 v[60:63], v99 offset:36864
    v_add_f32 v81, 1.0, v81
    v_mfma_f32_16x16x32_bf16 v[40:43], a[112:115], v[64:67], v[40:43]
    v_rcp_f32 v80, v80
    v_mfma_f32_16x16x32_bf16 v[40:43], a[120:123], v[68:71], v[40:43]
    v_rcp_f32 v81, v81
    v_mul_f32 v80, v80, v32
    v_mfma_f32_16x16x32_bf16 v[44:47], a[124:127], v[68:71], v[44:47]
    s_waitcnt lgkmcnt(2)
    v_exp_f32 v82, -v34
    v_mul_f32 v81, v81, v33
    v_mfma_f32_16x16x32_bf16 v[52:55], a[4:7], v[72:75], 0
    ds_read_b128 v[64:67], v96 offset:45056
    ds_read_b128 v[68:71], v97 offset:45056
    v_exp_f32 v83, -v35
    v_mfma_f32_16x16x32_bf16 v[48:51], a[0:3], v[72:75], 0
    s_waitcnt vmcnt(1)
    v_subrev_u32 v2, s70, v2
    v_cmp_le_u32 vcc, 16, v2
    v_cvt_pk_bf16_f32 v92, v80, v81
    v_mfma_f32_16x16x32_bf16 v[48:51], a[8:11], v[76:79], v[48:51]
    s_cbranch_vccnz L_slow_127
L_back_128:
    v_mfma_f32_16x16x32_bf16 v[52:55], a[12:15], v[76:79], v[52:55]
    s_waitcnt lgkmcnt(2)
    buffer_load_dwordx4 v[100:103], v13, s[60:63], s28 offen sc1
    v_add_f32 v82, 1.0, v82
    v_mfma_f32_16x16x32_bf16 v[52:55], a[20:23], v[56:59], v[52:55]
    ds_read_b128 v[72:75], v98 offset:45056
    ds_read_b128 v[76:79], v99 offset:45056
    v_add_f32 v83, 1.0, v83
    v_mfma_f32_16x16x32_bf16 v[48:51], a[16:19], v[56:59], v[48:51]
    buffer_store_dword v16, v3, s[60:63], 0 offen sc1
    v_mfma_f32_16x16x32_bf16 v[48:51], a[24:27], v[60:63], v[48:51]
    v_rcp_f32 v82, v82
    v_mfma_f32_16x16x32_bf16 v[52:55], a[28:31], v[60:63], v[52:55]
    s_waitcnt lgkmcnt(2)
    buffer_load_dwordx4 v[104:107], v13, s[60:63], s29 offen sc1
    v_mul_f32 v82, v82, v34
    v_mfma_f32_16x16x32_bf16 v[52:55], a[36:39], v[64:67], v[52:55]
    ds_read_b128 v[56:59], v96 offset:53248
    ds_read_b128 v[60:63], v97 offset:53248
    v_rcp_f32 v83, v83
    v_mfma_f32_16x16x32_bf16 v[48:51], a[32:35], v[64:67], v[48:51]
    v_exp_f32 v84, -v36
    v_mul_f32 v83, v83, v35
    v_mfma_f32_16x16x32_bf16 v[48:51], a[40:43], v[68:71], v[48:51]
    v_exp_f32 v85, -v37
    v_cvt_pk_bf16_f32 v93, v82, v83
    v_mfma_f32_16x16x32_bf16 v[52:55], a[44:47], v[68:71], v[52:55]
    s_waitcnt lgkmcnt(2)
    buffer_load_dwordx4 v[108:111], v13, s[60:63], s30 offen sc1
    v_add_f32 v84, 1.0, v84
    v_mfma_f32_16x16x32_bf16 v[52:55], a[52:55], v[72:75], v[52:55]
    ds_read_b128 v[64:67], v98 offset:53248
    ds_read_b128 v[68:71], v99 offset:53248
    v_add_f32 v85, 1.0, v85
    v_mfma_f32_16x16x32_bf16 v[48:51], a[48:51], v[72:75], v[48:51]
    v_rcp_f32 v84, v84
    v_mfma_f32_16x16x32_bf16 v[48:51], a[56:59], v[76:79], v[48:51]
    v_rcp_f32 v85, v85
    v_mul_f32 v84, v84, v36
    v_mfma_f32_16x16x32_bf16 v[52:55], a[60:63], v[76:79], v[52:55]
    s_waitcnt lgkmcnt(2)
    buffer_load_dwordx4 v[112:115], v13, s[60:63], s31 offen sc1
    v_mul_f32 v85, v85, v37
    v_mfma_f32_16x16x32_bf16 v[52:55], a[68:71], v[56:59], v[52:55]
    ds_read_b128 v[72:75], v96 offset:61440
    ds_read_b128 v[76:79], v97 offset:61440
    v_exp_f32 v86, -v38
    v_mfma_f32_16x16x32_bf16 v[48:51], a[64:67], v[56:59], v[48:51]
    v_xor_b32 v96, 0x10000, v96
    v_xor_b32 v97, 0x10000, v97
    v_cvt_pk_bf16_f32 v94, v84, v85
    v_mfma_f32_16x16x32_bf16 v[48:51], a[72:75], v[60:63], v[48:51]
    v_exp_f32 v87, -v39
    v_add_f32 v86, 1.0, v86
    v_mfma_f32_16x16x32_bf16 v[52:55], a[76:79], v[60:63], v[52:55]
    s_waitcnt lgkmcnt(2)
    buffer_load_dwordx4 v[116:119], v13, s[60:63], s32 offen sc1
    v_add_f32 v87, 1.0, v87
    v_mfma_f32_16x16x32_bf16 v[52:55], a[84:87], v[64:67], v[52:55]
    ds_read_b128 v[56:59], v98 offset:61440
    ds_read_b128 v[60:63], v99 offset:61440
    v_mfma_f32_16x16x32_bf16 v[48:51], a[80:83], v[64:67], v[48:51]
    v_xor_b32 v98, 0x10000, v98
    v_xor_b32 v99, 0x10000, v99
    v_mfma_f32_16x16x32_bf16 v[48:51], a[88:91], v[68:71], v[48:51]
    v_rcp_f32 v86, v86
    v_mfma_f32_16x16x32_bf16 v[52:55], a[92:95], v[68:71], v[52:55]
    s_waitcnt lgkmcnt(2)
    buffer_load_dwordx4 v[120:123], v13, s[60:63], s33 offen sc1
    v_mul_f32 v86, v86, v38
    v_mfma_f32_16x16x32_bf16 v[52:55], a[100:103], v[72:75], v[52:55]
    v_rcp_f32 v87, v87
    v_mfma_f32_16x16x32_bf16 v[48:51], a[96:99], v[72:75], v[48:51]
    v_mul_f32 v87, v87, v39
    v_mfma_f32_16x16x32_bf16 v[48:51], a[104:107], v[76:79], v[48:51]
    v_cvt_pk_bf16_f32 v95, v86, v87
    v_mfma_f32_16x16x32_bf16 v[52:55], a[108:111], v[76:79], v[52:55]
    s_waitcnt lgkmcnt(0)
    buffer_load_dwordx4 v[124:127], v13, s[60:63], s34 offen sc1
    v_mfma_f32_16x16x32_bf16 v[52:55], a[116:119], v[56:59], v[52:55]
    s_mov_b32 s75, 1204224
    buffer_store_dwordx4 v[92:95], v6, s[60:63], s75 offen sc1
    v_mfma_f32_16x16x32_bf16 v[48:51], a[112:115], v[56:59], v[48:51]
    v_or_b32 v16, 12, v17
    v_mfma_f32_16x16x32_bf16 v[48:51], a[120:123], v[60:63], v[48:51]
    v_exp_f32 v80, -v40
    v_mfma_f32_16x16x32_bf16 v[52:55], a[124:127], v[60:63], v[52:55]
    buffer_load_dwordx4 v[128:131], v13, s[60:63], s35 offen sc1
    v_exp_f32 v81, -v41
    v_exp_f32 v82, -v42
    v_exp_f32 v83, -v43
    v_add_f32 v80, 1.0, v80
    v_add_f32 v81, 1.0, v81
    v_rcp_f32 v80, v80
    v_rcp_f32 v81, v81
    v_exp_f32 v84, -v44
    v_mul_f32 v80, v80, v40
    v_mul_f32 v81, v81, v41
    buffer_load_dwordx4 v[132:135], v13, s[60:63], s36 offen sc1
    v_exp_f32 v85, -v45
    v_cvt_pk_bf16_f32 v88, v80, v81
    v_add_f32 v82, 1.0, v82
    v_add_f32 v83, 1.0, v83
    v_add_f32 v84, 1.0, v84
    v_rcp_f32 v82, v82
    v_rcp_f32 v83, v83
    v_rcp_f32 v84, v84
    v_mul_f32 v82, v82, v42
    v_mul_f32 v83, v83, v43
    s_add_u32 s70, s69, 11
    buffer_load_dwordx4 v[136:139], v13, s[60:63], s37 offen sc1
    buffer_load_dword v2, v4, s[60:63], 0 offen sc1
    v_exp_f32 v86, -v46
    v_cvt_pk_bf16_f32 v89, v82, v83
    v_mul_f32 v84, v84, v44
    v_exp_f32 v87, -v47
    v_add_f32 v85, 1.0, v85
    v_add_f32 v86, 1.0, v86
    v_add_f32 v87, 1.0, v87
    v_rcp_f32 v85, v85
    v_rcp_f32 v86, v86
    v_rcp_f32 v87, v87
    v_mul_f32 v85, v85, v45
    v_mul_f32 v86, v86, v46
    v_mul_f32 v87, v87, v47
    v_cvt_pk_bf16_f32 v90, v84, v85
    v_cvt_pk_bf16_f32 v91, v86, v87
    s_mov_b32 s75, 1261568
    buffer_store_dwordx4 v[88:91], v6, s[60:63], s75 offen sc1
    v_exp_f32 v80, -v48
    v_exp_f32 v81, -v49
    v_exp_f32 v82, -v50
    v_exp_f32 v83, -v51
    v_exp_f32 v84, -v52
    v_exp_f32 v85, -v53
    v_add_f32 v80, 1.0, v80
    v_add_f32 v81, 1.0, v81
    v_add_f32 v82, 1.0, v82
    v_add_f32 v83, 1.0, v83
    s_waitcnt vmcnt(13)
    v_rcp_f32 v80, v80
    v_rcp_f32 v81, v81
    v_rcp_f32 v82, v82
    v_mul_f32 v80, v80, v48
    v_mul_f32 v81, v81, v49
L_g2_121:
    v_mfma_f32_16x16x32_bf16 v[76:79], a[140:143], v[100:103], 0
    v_rcp_f32 v83, v83
    v_mfma_f32_16x16x32_bf16 v[72:75], a[136:139], v[100:103], 0
    v_exp_f32 v86, -v54
    v_mfma_f32_16x16x32_bf16 v[68:71], a[132:135], v[100:103], 0
    v_exp_f32 v87, -v55
    v_mfma_f32_16x16x32_bf16 v[64:67], a[128:131], v[100:103], 0
    s_waitcnt vmcnt(11)
    buffer_load_dwordx4 v[100:103], v13, s[60:63], s38 offen sc1
    v_mfma_f32_16x16x32_bf16 v[64:67], a[144:147], v[104:107], v[64:67]
    v_cvt_pk_bf16_f32 v92, v80, v81
    v_mul_f32 v82, v82, v50
    v_mfma_f32_16x16x32_bf16 v[68:71], a[148:151], v[104:107], v[68:71]
    v_mul_f32 v83, v83, v51
    v_add_f32 v84, 1.0, v84
    v_mfma_f32_16x16x32_bf16 v[72:75], a[152:155], v[104:107], v[72:75]
    v_rcp_f32 v84, v84
    v_mfma_f32_16x16x32_bf16 v[76:79], a[156:159], v[104:107], v[76:79]
    s_waitcnt vmcnt(11)
    buffer_load_dwordx4 v[104:107], v13, s[60:63], s39 offen sc1
    v_mfma_f32_16x16x32_bf16 v[76:79], a[172:175], v[108:111], v[76:79]
    v_cvt_pk_bf16_f32 v93, v82, v83
    v_mul_f32 v84, v84, v52
    v_mfma_f32_16x16x32_bf16 v[72:75], a[168:171], v[108:111], v[72:75]
    v_add_f32 v85, 1.0, v85
    v_add_f32 v86, 1.0, v86
    v_mfma_f32_16x16x32_bf16 v[68:71], a[164:167], v[108:111], v[68:71]
    v_rcp_f32 v85, v85
    v_mfma_f32_16x16x32_bf16 v[64:67], a[160:163], v[108:111], v[64:67]
    s_waitcnt vmcnt(11)
    buffer_load_dwordx4 v[108:111], v13, s[60:63], s40 offen sc1
    v_mfma_f32_16x16x32_bf16 v[64:67], a[176:179], v[112:115], v[64:67]
    v_rcp_f32 v86, v86
    v_mfma_f32_16x16x32_bf16 v[68:71], a[180:183], v[112:115], v[68:71]
    v_mul_f32 v85, v85, v53
    v_mul_f32 v86, v86, v54
    v_mfma_f32_16x16x32_bf16 v[72:75], a[184:187], v[112:115], v[72:75]
    v_cvt_pk_bf16_f32 v94, v84, v85
    v_add_f32 v87, 1.0, v87
    v_mfma_f32_16x16x32_bf16 v[76:79], a[188:191], v[112:115], v[76:79]
    s_waitcnt vmcnt(11)
    buffer_load_dwordx4 v[112:115], v13, s[60:63], s41 offen sc1
    v_add_u32 v13, 114688, v13
    v_mfma_f32_16x16x32_bf16 v[76:79], a[204:207], v[116:119], v[76:79]
    s_waitcnt vmcnt(9)
    buffer_store_dword v16, v3, s[60:63], 0 offen sc1
    v_mfma_f32_16x16x32_bf16 v[72:75], a[200:203], v[116:119], v[72:75]
    v_rcp_f32 v87, v87
    v_mfma_f32_16x16x32_bf16 v[68:71], a[196:199], v[116:119], v[68:71]
    v_mul_f32 v87, v87, v55
    v_mfma_f32_16x16x32_bf16 v[64:67], a[192:195], v[116:119], v[64:67]
    v_cvt_pk_bf16_f32 v95, v86, v87
    v_mfma_f32_16x16x32_bf16 v[64:67], a[208:211], v[120:123], v[64:67]
    s_waitcnt vmcnt(6)
    v_subrev_u32 v2, s70, v2
    v_cmp_le_u32 vcc, 16, v2
    v_mfma_f32_16x16x32_bf16 v[68:71], a[212:215], v[120:123], v[68:71]
    s_cbranch_vccnz L_slow_135
L_back_136:
    v_mfma_f32_16x16x32_bf16 v[72:75], a[216:219], v[120:123], v[72:75]
    buffer_load_dwordx4 v[116:119], v13, s[60:63], s28 offen sc1
    v_mfma_f32_16x16x32_bf16 v[76:79], a[220:223], v[120:123], v[76:79]
    s_mov_b32 s75, 1318912
    buffer_store_dwordx4 v[92:95], v6, s[60:63], s75 offen sc1
    v_mfma_f32_16x16x32_bf16 v[76:79], a[236:239], v[124:127], v[76:79]
    v_or_b32 v16, 13, v17
    v_mfma_f32_16x16x32_bf16 v[72:75], a[232:235], v[124:127], v[72:75]
    v_mfma_f32_16x16x32_bf16 v[68:71], a[228:231], v[124:127], v[68:71]
    buffer_load_dwordx4 v[120:123], v13, s[60:63], s29 offen sc1
    v_mfma_f32_16x16x32_bf16 v[64:67], a[224:227], v[124:127], v[64:67]
    v_mfma_f32_16x16x32_bf16 v[64:67], a[240:243], v[128:131], v[64:67]
    v_mfma_f32_16x16x32_bf16 v[68:71], a[244:247], v[128:131], v[68:71]
    v_mfma_f32_16x16x32_bf16 v[72:75], a[248:251], v[128:131], v[72:75]
    buffer_load_dwordx4 v[124:127], v13, s[60:63], s30 offen sc1
    v_mfma_f32_16x16x32_bf16 v[76:79], a[252:255], v[128:131], v[76:79]
    v_mfma_f32_16x16x32_bf16 v[76:79], v[172:175], v[132:135], v[76:79]
    v_mfma_f32_16x16x32_bf16 v[72:75], v[168:171], v[132:135], v[72:75]
    v_mfma_f32_16x16x32_bf16 v[68:71], v[164:167], v[132:135], v[68:71]
    buffer_load_dwordx4 v[128:131], v13, s[60:63], s31 offen sc1
    v_mfma_f32_16x16x32_bf16 v[64:67], v[160:163], v[132:135], v[64:67]
    v_mfma_f32_16x16x32_bf16 v[64:67], v[176:179], v[136:139], v[64:67]
    v_mfma_f32_16x16x32_bf16 v[68:71], v[180:183], v[136:139], v[68:71]
    v_mfma_f32_16x16x32_bf16 v[72:75], v[184:187], v[136:139], v[72:75]
    buffer_load_dwordx4 v[132:135], v13, s[60:63], s32 offen sc1
    v_mfma_f32_16x16x32_bf16 v[76:79], v[188:191], v[136:139], v[76:79]
    s_waitcnt vmcnt(10)
    s_add_u32 s70, s69, 12
    buffer_load_dword v2, v4, s[60:63], 0 offen sc1
    v_mfma_f32_16x16x32_bf16 v[76:79], v[204:207], v[100:103], v[76:79]
    v_mfma_f32_16x16x32_bf16 v[72:75], v[200:203], v[100:103], v[72:75]
    v_mfma_f32_16x16x32_bf16 v[68:71], v[196:199], v[100:103], v[68:71]
    buffer_load_dwordx4 v[136:139], v13, s[60:63], s33 offen sc1
    v_mfma_f32_16x16x32_bf16 v[64:67], v[192:195], v[100:103], v[64:67]
    s_waitcnt vmcnt(11)
    v_mfma_f32_16x16x32_bf16 v[64:67], v[208:211], v[104:107], v[64:67]
    v_rcp_f32 v22, v146
    v_mfma_f32_16x16x32_bf16 v[68:71], v[212:215], v[104:107], v[68:71]
    v_lshlrev_b32 v146, 16, v145
    v_mul_f32 v23, -v147, v22
    v_mfma_f32_16x16x32_bf16 v[72:75], v[216:219], v[104:107], v[72:75]
    buffer_load_dwordx4 v[100:103], v13, s[60:63], s34 offen sc1
    v_mfma_f32_16x16x32_bf16 v[76:79], v[220:223], v[104:107], v[76:79]
    s_waitcnt vmcnt(11)
    v_and_b32 v147, 0xffff0000, v145
    v_and_b32 v145, 0xffff0000, v144
    v_mfma_f32_16x16x32_bf16 v[76:79], v[236:239], v[108:111], v[76:79]
    v_lshlrev_b32 v144, 16, v144
    v_fma_f32 v146, v146, v22, v23
    v_mfma_f32_16x16x32_bf16 v[72:75], v[232:235], v[108:111], v[72:75]
    v_fma_f32 v147, v147, v22, v23
    v_fma_f32 v145, v145, v22, v23
    v_mfma_f32_16x16x32_bf16 v[68:71], v[228:231], v[108:111], v[68:71]
    buffer_load_dwordx4 v[104:107], v13, s[60:63], s35 offen sc1
    v_mfma_f32_16x16x32_bf16 v[64:67], v[224:227], v[108:111], v[64:67]
    s_waitcnt vmcnt(11)
    v_fma_f32 v144, v144, v22, v23
    v_mfma_f32_16x16x32_bf16 v[64:67], v[240:243], v[112:115], v[64:67]
    v_mfma_f32_16x16x32_bf16 v[68:71], v[244:247], v[112:115], v[68:71]
    v_mfma_f32_16x16x32_bf16 v[72:75], v[248:251], v[112:115], v[72:75]
    buffer_load_dwordx4 v[108:111], v13, s[60:63], s36 offen sc1
    v_mfma_f32_16x16x32_bf16 v[76:79], v[252:255], v[112:115], v[76:79]
    s_waitcnt vmcnt(10)
    v_mfma_f32_16x16x32_bf16 v[36:39], a[140:143], v[116:119], 0
    v_mfma_f32_16x16x32_bf16 v[32:35], a[136:139], v[116:119], 0
    v_mfma_f32_16x16x32_bf16 v[28:31], a[132:135], v[116:119], 0
    buffer_load_dwordx4 v[112:115], v13, s[60:63], s37 offen sc1
    v_mfma_f32_16x16x32_bf16 v[24:27], a[128:131], v[116:119], 0
    s_waitcnt vmcnt(9)
    v_mfma_f32_16x16x32_bf16 v[24:27], a[144:147], v[120:123], v[24:27]
    v_mfma_f32_16x16x32_bf16 v[28:31], a[148:151], v[120:123], v[28:31]
    v_mfma_f32_16x16x32_bf16 v[32:35], a[152:155], v[120:123], v[32:35]
    buffer_load_dwordx4 v[116:119], v13, s[60:63], s38 offen sc1
    v_mfma_f32_16x16x32_bf16 v[36:39], a[156:159], v[120:123], v[36:39]
    s_waitcnt vmcnt(9)
    ds_write_b128 v11, v[64:67] offset:0
    v_mfma_f32_16x16x32_bf16 v[36:39], a[172:175], v[124:127], v[36:39]
    v_mfma_f32_16x16x32_bf16 v[32:35], a[168:171], v[124:127], v[32:35]
    v_mfma_f32_16x16x32_bf16 v[28:31], a[164:167], v[124:127], v[28:31]
    buffer_load_dwordx4 v[120:123], v13, s[60:63], s39 offen sc1
    v_mfma_f32_16x16x32_bf16 v[24:27], a[160:163], v[124:127], v[24:27]
    s_waitcnt vmcnt(9)
    buffer_store_dword v16, v3, s[60:63], 0 offen sc1
    v_mfma_f32_16x16x32_bf16 v[24:27], a[176:179], v[128:131], v[24:27]
    ds_write_b128 v14, v[68:71] offset:0
    v_mfma_f32_16x16x32_bf16 v[28:31], a[180:183], v[128:131], v[28:31]
    v_mfma_f32_16x16x32_bf16 v[32:35], a[184:187], v[128:131], v[32:35]
    buffer_load_dwordx4 v[124:127], v13, s[60:63], s40 offen sc1
    v_mfma_f32_16x16x32_bf16 v[36:39], a[188:191], v[128:131], v[36:39]
    s_waitcnt vmcnt(10)
    ds_write_b128 v11, v[72:75] offset:128
    v_mfma_f32_16x16x32_bf16 v[36:39], a[204:207], v[132:135], v[36:39]
    v_mfma_f32_16x16x32_bf16 v[32:35], a[200:203], v[132:135], v[32:35]
    v_mfma_f32_16x16x32_bf16 v[28:31], a[196:199], v[132:135], v[28:31]
    buffer_load_dwordx4 v[128:131], v13, s[60:63], s41 offen sc1
    v_add_u32 v13, 114688, v13
    v_mfma_f32_16x16x32_bf16 v[24:27], a[192:195], v[132:135], v[24:27]
    s_waitcnt vmcnt(9)
    ds_write_b128 v14, v[76:79] offset:128
    v_mfma_f32_16x16x32_bf16 v[24:27], a[208:211], v[136:139], v[24:27]
    v_subrev_u32 v2, s70, v2
    v_cmp_le_u32 vcc, 16, v2
    v_mfma_f32_16x16x32_bf16 v[28:31], a[212:215], v[136:139], v[28:31]
    s_cbranch_vccnz L_slow_140
L_back_141:
    v_mfma_f32_16x16x32_bf16 v[32:35], a[216:219], v[136:139], v[32:35]
    buffer_load_dwordx4 v[132:135], v13, s[60:63], s28 offen sc1
    v_mfma_f32_16x16x32_bf16 v[36:39], a[220:223], v[136:139], v[36:39]
    s_waitcnt vmcnt(9)
    v_mfma_f32_16x16x32_bf16 v[36:39], a[236:239], v[100:103], v[36:39]
    s_waitcnt lgkmcnt(0)
    s_barrier
    v_mfma_f32_16x16x32_bf16 v[32:35], a[232:235], v[100:103], v[32:35]
    ds_read_b128 v[64:67], v12 offset:0
    ds_read_b128 v[68:71], v12 offset:4096
    v_mfma_f32_16x16x32_bf16 v[28:31], a[228:231], v[100:103], v[28:31]
    buffer_load_dwordx4 v[136:139], v13, s[60:63], s29 offen sc1
    v_mfma_f32_16x16x32_bf16 v[24:27], a[224:227], v[100:103], v[24:27]
    s_waitcnt vmcnt(9)
    ds_read_b128 v[72:75], v12 offset:8192
    ds_read_b128 v[76:79], v12 offset:12288
    v_mfma_f32_16x16x32_bf16 v[24:27], a[240:243], v[104:107], v[24:27]
    v_mfma_f32_16x16x32_bf16 v[28:31], a[244:247], v[104:107], v[28:31]
    v_mfma_f32_16x16x32_bf16 v[32:35], a[248:251], v[104:107], v[32:35]
    buffer_load_dwordx4 v[100:103], v13, s[60:63], s30 offen sc1
    v_mfma_f32_16x16x32_bf16 v[36:39], a[252:255], v[104:107], v[36:39]
    s_waitcnt vmcnt(9)
    v_mfma_f32_16x16x32_bf16 v[36:39], v[172:175], v[108:111], v[36:39]
    v_mfma_f32_16x16x32_bf16 v[32:35], v[168:171], v[108:111], v[32:35]
    s_waitcnt lgkmcnt(0)
    v_add_f32 v64, v64, v68
    v_add_f32 v65, v65, v69
    v_mfma_f32_16x16x32_bf16 v[28:31], v[164:167], v[108:111], v[28:31]
    buffer_load_dwordx4 v[104:107], v13, s[60:63], s31 offen sc1
    v_mfma_f32_16x16x32_bf16 v[24:27], v[160:163], v[108:111], v[24:27]
    s_waitcnt vmcnt(9)
    v_add_f32 v66, v66, v70
    v_add_f32 v67, v67, v71
    v_mfma_f32_16x16x32_bf16 v[24:27], v[176:179], v[112:115], v[24:27]
    v_add_f32 v64, v64, v72
    v_add_f32 v65, v65, v73
    v_mfma_f32_16x16x32_bf16 v[28:31], v[180:183], v[112:115], v[28:31]
    v_add_f32 v66, v66, v74
    v_add_f32 v67, v67, v75
    v_mfma_f32_16x16x32_bf16 v[32:35], v[184:187], v[112:115], v[32:35]
    buffer_load_dwordx4 v[108:111], v13, s[60:63], s32 offen sc1
    v_mfma_f32_16x16x32_bf16 v[36:39], v[188:191], v[112:115], v[36:39]
    s_waitcnt vmcnt(9)
    s_add_u32 s70, s69, 13
    buffer_load_dword v2, v4, s[60:63], 0 offen sc1
    v_mfma_f32_16x16x32_bf16 v[36:39], v[204:207], v[116:119], v[36:39]
    v_add_f32 v64, v64, v76
    v_add_f32 v65, v65, v77
    v_mfma_f32_16x16x32_bf16 v[32:35], v[200:203], v[116:119], v[32:35]
    v_add_f32 v66, v66, v78
    v_add_f32 v67, v67, v79
    v_mfma_f32_16x16x32_bf16 v[28:31], v[196:199], v[116:119], v[28:31]
    buffer_load_dwordx4 v[112:115], v13, s[60:63], s33 offen sc1
    v_mfma_f32_16x16x32_bf16 v[24:27], v[192:195], v[116:119], v[24:27]
    s_waitcnt vmcnt(10)
    v_fma_f32 v64, v64, s42, v144
    v_fma_f32 v65, v65, s42, v145
    v_mfma_f32_16x16x32_bf16 v[24:27], v[208:211], v[120:123], v[24:27]
    v_rcp_f32 v22, v150
    v_mfma_f32_16x16x32_bf16 v[28:31], v[212:215], v[120:123], v[28:31]
    v_lshlrev_b32 v150, 16, v149
    v_mul_f32 v23, -v151, v22
    v_mfma_f32_16x16x32_bf16 v[32:35], v[216:219], v[120:123], v[32:35]
    buffer_load_dwordx4 v[116:119], v13, s[60:63], s34 offen sc1
    v_mfma_f32_16x16x32_bf16 v[36:39], v[220:223], v[120:123], v[36:39]
    s_waitcnt vmcnt(9)
    v_and_b32 v151, 0xffff0000, v149
    v_and_b32 v149, 0xffff0000, v148
    v_mfma_f32_16x16x32_bf16 v[36:39], v[236:239], v[124:127], v[36:39]
    v_lshlrev_b32 v148, 16, v148
    v_fma_f32 v150, v150, v22, v23
    v_mfma_f32_16x16x32_bf16 v[32:35], v[232:235], v[124:127], v[32:35]
    v_fma_f32 v151, v151, v22, v23
    v_fma_f32 v149, v149, v22, v23
    v_mfma_f32_16x16x32_bf16 v[28:31], v[228:231], v[124:127], v[28:31]
    buffer_load_dwordx4 v[120:123], v13, s[60:63], s35 offen sc1
    v_mfma_f32_16x16x32_bf16 v[24:27], v[224:227], v[124:127], v[24:27]
    s_waitcnt vmcnt(9)
    v_fma_f32 v148, v148, v22, v23
    v_fma_f32 v66, v66, s42, v146
    v_mfma_f32_16x16x32_bf16 v[24:27], v[240:243], v[128:131], v[24:27]
    v_fma_f32 v67, v67, s42, v147
    v_cvt_pk_bf16_f32 v144, v64, v65
    v_mfma_f32_16x16x32_bf16 v[28:31], v[244:247], v[128:131], v[28:31]
    v_cvt_pk_bf16_f32 v145, v66, v67
    v_mfma_f32_16x16x32_bf16 v[32:35], v[248:251], v[128:131], v[32:35]
    buffer_load_dwordx4 v[124:127], v13, s[60:63], s36 offen sc1
    v_mfma_f32_16x16x32_bf16 v[36:39], v[252:255], v[128:131], v[36:39]
    s_waitcnt vmcnt(9)
    v_mfma_f32_16x16x32_bf16 v[76:79], a[140:143], v[132:135], 0
    v_mfma_f32_16x16x32_bf16 v[72:75], a[136:139], v[132:135], 0
    v_mfma_f32_16x16x32_bf16 v[68:71], a[132:135], v[132:135], 0
    buffer_load_dwordx4 v[128:131], v13, s[60:63], s37 offen sc1
    v_mfma_f32_16x16x32_bf16 v[64:67], a[128:131], v[132:135], 0
    s_waitcnt vmcnt(9)
    v_mfma_f32_16x16x32_bf16 v[64:67], a[144:147], v[136:139], v[64:67]
    v_mfma_f32_16x16x32_bf16 v[68:71], a[148:151], v[136:139], v[68:71]
    v_mfma_f32_16x16x32_bf16 v[72:75], a[152:155], v[136:139], v[72:75]
    buffer_load_dwordx4 v[132:135], v13, s[60:63], s38 offen sc1
    v_mfma_f32_16x16x32_bf16 v[76:79], a[156:159], v[136:139], v[76:79]
    s_waitcnt vmcnt(9)
    ds_write_b128 v11, v[24:27] offset:16384
    v_mfma_f32_16x16x32_bf16 v[76:79], a[172:175], v[100:103], v[76:79]
    v_mfma_f32_16x16x32_bf16 v[72:75], a[168:171], v[100:103], v[72:75]
    v_mfma_f32_16x16x32_bf16 v[68:71], a[164:167], v[100:103], v[68:71]
    buffer_load_dwordx4 v[136:139], v13, s[60:63], s39 offen sc1
    v_mfma_f32_16x16x32_bf16 v[64:67], a[160:163], v[100:103], v[64:67]
    s_waitcnt vmcnt(9)
    ds_write_b128 v14, v[28:31] offset:16384
    v_mfma_f32_16x16x32_bf16 v[64:67], a[176:179], v[104:107], v[64:67]
    v_mfma_f32_16x16x32_bf16 v[68:71], a[180:183], v[104:107], v[68:71]
    v_mfma_f32_16x16x32_bf16 v[72:75], a[184:187], v[104:107], v[72:75]
    buffer_load_dwordx4 v[100:103], v13, s[60:63], s40 offen sc1
    v_mfma_f32_16x16x32_bf16 v[76:79], a[188:191], v[104:107], v[76:79]
    s_waitcnt vmcnt(9)
    ds_write_b128 v11, v[32:35] offset:16512
    v_mfma_f32_16x16x32_bf16 v[76:79], a[204:207], v[108:111], v[76:79]
    v_mfma_f32_16x16x32_bf16 v[72:75], a[200:203], v[108:111], v[72:75]
    v_mfma_f32_16x16x32_bf16 v[68:71], a[196:199], v[108:111], v[68:71]
    buffer_load_dwordx4 v[104:107], v13, s[60:63], s41 offen sc1
    v_add_u32 v13, 114688, v13
    v_mfma_f32_16x16x32_bf16 v[64:67], a[192:195], v[108:111], v[64:67]
    s_waitcnt vmcnt(8)
    ds_write_b128 v14, v[36:39] offset:16512
    v_mfma_f32_16x16x32_bf16 v[64:67], a[208:211], v[112:115], v[64:67]
    v_subrev_u32 v2, s70, v2
    v_cmp_le_u32 vcc, 16, v2
    v_mfma_f32_16x16x32_bf16 v[68:71], a[212:215], v[112:115], v[68:71]
    s_cbranch_vccnz L_slow_145
L_back_146:
    v_mfma_f32_16x16x32_bf16 v[72:75], a[216:219], v[112:115], v[72:75]
    buffer_load_dwordx4 v[108:111], v13, s[60:63], s28 offen sc1
    v_mfma_f32_16x16x32_bf16 v[76:79], a[220:223], v[112:115], v[76:79]
    s_waitcnt vmcnt(8)
    v_mfma_f32_16x16x32_bf16 v[76:79], a[236:239], v[116:119], v[76:79]
    s_waitcnt lgkmcnt(0)
    s_barrier
    v_mfma_f32_16x16x32_bf16 v[72:75], a[232:235], v[116:119], v[72:75]
    ds_read_b128 v[24:27], v12 offset:16384
    ds_read_b128 v[28:31], v12 offset:20480
    v_mfma_f32_16x16x32_bf16 v[68:71], a[228:231], v[116:119], v[68:71]
    buffer_load_dwordx4 v[112:115], v13, s[60:63], s29 offen sc1
    v_mfma_f32_16x16x32_bf16 v[64:67], a[224:227], v[116:119], v[64:67]
    s_waitcnt vmcnt(8)
    ds_read_b128 v[32:35], v12 offset:24576
    ds_read_b128 v[36:39], v12 offset:28672
    v_mfma_f32_16x16x32_bf16 v[64:67], a[240:243], v[120:123], v[64:67]
    v_mfma_f32_16x16x32_bf16 v[68:71], a[244:247], v[120:123], v[68:71]
    v_mfma_f32_16x16x32_bf16 v[72:75], a[248:251], v[120:123], v[72:75]
    buffer_load_dwordx4 v[116:119], v13, s[60:63], s30 offen sc1
    v_mfma_f32_16x16x32_bf16 v[76:79], a[252:255], v[120:123], v[76:79]
    s_waitcnt vmcnt(8)
    v_mfma_f32_16x16x32_bf16 v[76:79], v[172:175], v[124:127], v[76:79]
    v_mfma_f32_16x16x32_bf16 v[72:75], v[168:171], v[124:127], v[72:75]
    s_waitcnt lgkmcnt(0)
    v_add_f32 v24, v24, v28
    v_add_f32 v25, v25, v29
    v_mfma_f32_16x16x32_bf16 v[68:71], v[164:167], v[124:127], v[68:71]
    buffer_load_dwordx4 v[120:123], v13, s[60:63], s31 offen sc1
    v_mfma_f32_16x16x32_bf16 v[64:67], v[160:163], v[124:127], v[64:67]
    s_waitcnt vmcnt(8)
    v_add_f32 v26, v26, v30
    v_add_f32 v27, v27, v31
    v_mfma_f32_16x16x32_bf16 v[64:67], v[176:179], v[128:131], v[64:67]
    v_add_f32 v24, v24, v32
    v_add_f32 v25, v25, v33
    v_mfma_f32_16x16x32_bf16 v[68:71], v[180:183], v[128:131], v[68:71]
    v_add_f32 v26, v26, v34
    v_add_f32 v27, v27, v35
    v_mfma_f32_16x16x32_bf16 v[72:75], v[184:187], v[128:131], v[72:75]
    buffer_load_dwordx4 v[124:127], v13, s[60:63], s32 offen sc1
    v_mfma_f32_16x16x32_bf16 v[76:79], v[188:191], v[128:131], v[76:79]
    s_waitcnt vmcnt(8)
    v_add_f32 v24, v24, v36
    v_add_f32 v25, v25, v37
    v_mfma_f32_16x16x32_bf16 v[76:79], v[204:207], v[132:135], v[76:79]
    v_add_f32 v26, v26, v38
    v_add_f32 v27, v27, v39
    v_mfma_f32_16x16x32_bf16 v[72:75], v[200:203], v[132:135], v[72:75]
    v_fma_f32 v24, v24, s42, v148
    v_fma_f32 v25, v25, s42, v149
    v_mfma_f32_16x16x32_bf16 v[68:71], v[196:199], v[132:135], v[68:71]
    buffer_load_dwordx4 v[128:131], v13, s[60:63], s33 offen sc1
    v_mfma_f32_16x16x32_bf16 v[64:67], v[192:195], v[132:135], v[64:67]
    s_waitcnt vmcnt(8)
    v_fma_f32 v26, v26, s42, v150
    v_fma_f32 v27, v27, s42, v151
    v_mfma_f32_16x16x32_bf16 v[64:67], v[208:211], v[136:139], v[64:67]
    v_rcp_f32 v22, v154
    v_mfma_f32_16x16x32_bf16 v[68:71], v[212:215], v[136:139], v[68:71]
    v_lshlrev_b32 v154, 16, v153
    v_mul_f32 v23, -v155, v22
    v_mfma_f32_16x16x32_bf16 v[72:75], v[216:219], v[136:139], v[72:75]
    buffer_load_dwordx4 v[132:135], v13, s[60:63], s34 offen sc1
    v_mfma_f32_16x16x32_bf16 v[76:79], v[220:223], v[136:139], v[76:79]
    s_waitcnt vmcnt(8)
    v_and_b32 v155, 0xffff0000, v153
    v_and_b32 v153, 0xffff0000, v152
    v_mfma_f32_16x16x32_bf16 v[76:79], v[236:239], v[100:103], v[76:79]
    v_lshlrev_b32 v152, 16, v152
    v_fma_f32 v154, v154, v22, v23
    v_mfma_f32_16x16x32_bf16 v[72:75], v[232:235], v[100:103], v[72:75]
    v_fma_f32 v155, v155, v22, v23
    v_fma_f32 v153, v153, v22, v23
    v_mfma_f32_16x16x32_bf16 v[68:71], v[228:231], v[100:103], v[68:71]
    buffer_load_dwordx4 v[136:139], v13, s[60:63], s35 offen sc1
    v_mfma_f32_16x16x32_bf16 v[64:67], v[224:227], v[100:103], v[64:67]
    s_waitcnt vmcnt(8)
    v_fma_f32 v152, v152, v22, v23
    v_cvt_pk_bf16_f32 v148, v24, v25
    v_mfma_f32_16x16x32_bf16 v[64:67], v[240:243], v[104:107], v[64:67]
    v_cvt_pk_bf16_f32 v149, v26, v27
    v_mfma_f32_16x16x32_bf16 v[68:71], v[244:247], v[104:107], v[68:71]
    v_mfma_f32_16x16x32_bf16 v[72:75], v[248:251], v[104:107], v[72:75]
    buffer_load_dwordx4 v[100:103], v13, s[60:63], s36 offen sc1
    v_mfma_f32_16x16x32_bf16 v[76:79], v[252:255], v[104:107], v[76:79]
    s_waitcnt vmcnt(8)
    v_mfma_f32_16x16x32_bf16 v[36:39], a[140:143], v[108:111], 0
    v_mfma_f32_16x16x32_bf16 v[32:35], a[136:139], v[108:111], 0
    v_mfma_f32_16x16x32_bf16 v[28:31], a[132:135], v[108:111], 0
    buffer_load_dwordx4 v[104:107], v13, s[60:63], s37 offen sc1
    v_mfma_f32_16x16x32_bf16 v[24:27], a[128:131], v[108:111], 0
    s_waitcnt vmcnt(8)
    v_mfma_f32_16x16x32_bf16 v[24:27], a[144:147], v[112:115], v[24:27]
    v_mfma_f32_16x16x32_bf16 v[28:31], a[148:151], v[112:115], v[28:31]
    v_mfma_f32_16x16x32_bf16 v[32:35], a[152:155], v[112:115], v[32:35]
    buffer_load_dwordx4 v[108:111], v13, s[60:63], s38 offen sc1
    v_mfma_f32_16x16x32_bf16 v[36:39], a[156:159], v[112:115], v[36:39]
    s_waitcnt vmcnt(8)
    ds_write_b128 v11, v[64:67] offset:0
    v_mfma_f32_16x16x32_bf16 v[36:39], a[172:175], v[116:119], v[36:39]
    v_mfma_f32_16x16x32_bf16 v[32:35], a[168:171], v[116:119], v[32:35]
    v_mfma_f32_16x16x32_bf16 v[28:31], a[164:167], v[116:119], v[28:31]
    buffer_load_dwordx4 v[112:115], v13, s[60:63], s39 offen sc1
    v_mfma_f32_16x16x32_bf16 v[24:27], a[160:163], v[116:119], v[24:27]
    s_waitcnt vmcnt(8)
    ds_write_b128 v14, v[68:71] offset:0
    v_mfma_f32_16x16x32_bf16 v[24:27], a[176:179], v[120:123], v[24:27]
    v_mfma_f32_16x16x32_bf16 v[28:31], a[180:183], v[120:123], v[28:31]
    v_mfma_f32_16x16x32_bf16 v[32:35], a[184:187], v[120:123], v[32:35]
    buffer_load_dwordx4 v[116:119], v13, s[60:63], s40 offen sc1
    v_mfma_f32_16x16x32_bf16 v[36:39], a[188:191], v[120:123], v[36:39]
    s_waitcnt vmcnt(8)
    ds_write_b128 v11, v[72:75] offset:128
    v_mfma_f32_16x16x32_bf16 v[36:39], a[204:207], v[124:127], v[36:39]
    v_mfma_f32_16x16x32_bf16 v[32:35], a[200:203], v[124:127], v[32:35]
    v_mfma_f32_16x16x32_bf16 v[28:31], a[196:199], v[124:127], v[28:31]
    buffer_load_dwordx4 v[120:123], v13, s[60:63], s41 offen sc1
    v_add_u32 v13, 573440, v13
    v_mfma_f32_16x16x32_bf16 v[24:27], a[192:195], v[124:127], v[24:27]
    s_waitcnt vmcnt(8)
    s_mov_b32 s72, 0
    buffer_store_dwordx2 v[144:145], v5, s[56:59], s72 offen sc1
    v_mfma_f32_16x16x32_bf16 v[24:27], a[208:211], v[128:131], v[24:27]
    s_mov_b32 s72, 32768
    buffer_store_dwordx2 v[148:149], v5, s[56:59], s72 offen sc1
    v_mfma_f32_16x16x32_bf16 v[28:31], a[212:215], v[128:131], v[28:31]
    ds_write_b128 v14, v[76:79] offset:128
    v_mfma_f32_16x16x32_bf16 v[32:35], a[216:219], v[128:131], v[32:35]
    v_mfma_f32_16x16x32_bf16 v[36:39], a[220:223], v[128:131], v[36:39]
    s_waitcnt vmcnt(9)
    v_mfma_f32_16x16x32_bf16 v[36:39], a[236:239], v[132:135], v[36:39]
    v_mfma_f32_16x16x32_bf16 v[32:35], a[232:235], v[132:135], v[32:35]
    v_mfma_f32_16x16x32_bf16 v[28:31], a[228:231], v[132:135], v[28:31]
    s_waitcnt lgkmcnt(0)
    s_barrier
    v_mfma_f32_16x16x32_bf16 v[24:27], a[224:227], v[132:135], v[24:27]
    s_waitcnt vmcnt(8)
    ds_read_b128 v[64:67], v12 offset:0
    ds_read_b128 v[68:71], v12 offset:4096
    v_mfma_f32_16x16x32_bf16 v[24:27], a[240:243], v[136:139], v[24:27]
    ds_read_b128 v[72:75], v12 offset:8192
    ds_read_b128 v[76:79], v12 offset:12288
    v_mfma_f32_16x16x32_bf16 v[28:31], a[244:247], v[136:139], v[28:31]
    v_mfma_f32_16x16x32_bf16 v[32:35], a[248:251], v[136:139], v[32:35]
    v_mfma_f32_16x16x32_bf16 v[36:39], a[252:255], v[136:139], v[36:39]
    s_waitcnt vmcnt(7)
    v_mfma_f32_16x16x32_bf16 v[36:39], v[172:175], v[100:103], v[36:39]
    v_mfma_f32_16x16x32_bf16 v[32:35], v[168:171], v[100:103], v[32:35]
    v_mfma_f32_16x16x32_bf16 v[28:31], v[164:167], v[100:103], v[28:31]
    s_waitcnt lgkmcnt(0)
    v_add_f32 v64, v64, v68
    v_add_f32 v65, v65, v69
    v_mfma_f32_16x16x32_bf16 v[24:27], v[160:163], v[100:103], v[24:27]
    s_waitcnt vmcnt(6)
    v_add_f32 v66, v66, v70
    v_add_f32 v67, v67, v71
    v_mfma_f32_16x16x32_bf16 v[24:27], v[176:179], v[104:107], v[24:27]
    v_add_f32 v64, v64, v72
    v_add_f32 v65, v65, v73
    v_mfma_f32_16x16x32_bf16 v[28:31], v[180:183], v[104:107], v[28:31]
    v_add_f32 v66, v66, v74
    v_add_f32 v67, v67, v75
    v_mfma_f32_16x16x32_bf16 v[32:35], v[184:187], v[104:107], v[32:35]
    v_add_f32 v64, v64, v76
    v_add_f32 v65, v65, v77
    v_mfma_f32_16x16x32_bf16 v[36:39], v[188:191], v[104:107], v[36:39]
    s_waitcnt vmcnt(5)
    v_add_f32 v66, v66, v78
    v_add_f32 v67, v67, v79
    v_mfma_f32_16x16x32_bf16 v[36:39], v[204:207], v[108:111], v[36:39]
    v_fma_f32 v64, v64, s42, v152
    v_fma_f32 v65, v65, s42, v153
    v_mfma_f32_16x16x32_bf16 v[32:35], v[200:203], v[108:111], v[32:35]
    v_fma_f32 v66, v66, s42, v154
    v_fma_f32 v67, v67, s42, v155
    v_mfma_f32_16x16x32_bf16 v[28:31], v[196:199], v[108:111], v[28:31]
    v_cvt_pk_bf16_f32 v152, v64, v65
    v_cvt_pk_bf16_f32 v153, v66, v67
    v_mfma_f32_16x16x32_bf16 v[24:27], v[192:195], v[108:111], v[24:27]
    s_waitcnt vmcnt(4)
    s_mov_b32 s72, 65536
    buffer_store_dwordx2 v[152:153], v5, s[56:59], s72 offen sc1
    v_mfma_f32_16x16x32_bf16 v[24:27], v[208:211], v[112:115], v[24:27]
    v_rcp_f32 v22, v158
    v_mfma_f32_16x16x32_bf16 v[28:31], v[212:215], v[112:115], v[28:31]
    v_lshlrev_b32 v158, 16, v157
    v_mul_f32 v23, -v159, v22
    v_mfma_f32_16x16x32_bf16 v[32:35], v[216:219], v[112:115], v[32:35]
    v_and_b32 v159, 0xffff0000, v157
    v_and_b32 v157, 0xffff0000, v156
    v_mfma_f32_16x16x32_bf16 v[36:39], v[220:223], v[112:115], v[36:39]
    s_waitcnt vmcnt(4)
    v_lshlrev_b32 v156, 16, v156
    v_fma_f32 v158, v158, v22, v23
    v_mfma_f32_16x16x32_bf16 v[36:39], v[236:239], v[116:119], v[36:39]
    v_fma_f32 v159, v159, v22, v23
    v_fma_f32 v157, v157, v22, v23
    v_mfma_f32_16x16x32_bf16 v[32:35], v[232:235], v[116:119], v[32:35]
    v_fma_f32 v156, v156, v22, v23
    v_mfma_f32_16x16x32_bf16 v[28:31], v[228:231], v[116:119], v[28:31]
    v_mfma_f32_16x16x32_bf16 v[24:27], v[224:227], v[116:119], v[24:27]
    s_waitcnt vmcnt(3)
    v_mfma_f32_16x16x32_bf16 v[24:27], v[240:243], v[120:123], v[24:27]
    v_mfma_f32_16x16x32_bf16 v[28:31], v[244:247], v[120:123], v[28:31]
    v_mfma_f32_16x16x32_bf16 v[32:35], v[248:251], v[120:123], v[32:35]
    v_mfma_f32_16x16x32_bf16 v[36:39], v[252:255], v[120:123], v[36:39]
    s_mov_b32 s72, 98304
    s_nop 3
    ds_write_b128 v11, v[24:27] offset:16384
    ds_write_b128 v14, v[28:31] offset:16384
    ds_write_b128 v11, v[32:35] offset:16512
    ds_write_b128 v14, v[36:39] offset:16512
    s_waitcnt lgkmcnt(0)
    s_barrier
    ds_read_b128 v[24:27], v12 offset:16384
    ds_read_b128 v[28:31], v12 offset:20480
    ds_read_b128 v[32:35], v12 offset:24576
    ds_read_b128 v[36:39], v12 offset:28672
    s_waitcnt lgkmcnt(2)
    v_pk_add_f32 v[24:25], v[24:25], v[28:29]
    v_pk_add_f32 v[26:27], v[26:27], v[30:31]
    s_waitcnt lgkmcnt(1)
    v_pk_add_f32 v[24:25], v[24:25], v[32:33]
    v_pk_add_f32 v[26:27], v[26:27], v[34:35]
    s_waitcnt lgkmcnt(0)
    v_pk_add_f32 v[24:25], v[24:25], v[36:37]
    v_pk_add_f32 v[26:27], v[26:27], v[38:39]
    v_pk_fma_f32 v[24:25], v[24:25], s[42:43], v[156:157] op_sel_hi:[1,0,1]
    v_pk_fma_f32 v[26:27], v[26:27], s[42:43], v[158:159] op_sel_hi:[1,0,1]
    v_cvt_pk_bf16_f32 v28, v24, v25
    v_cvt_pk_bf16_f32 v29, v26, v27
    buffer_store_dwordx2 v[28:29], v5, s[56:59], s72 offen sc1
    s_branch L_fin
L_bail_86:
    s_mov_b32 s71, 0
    s_waitcnt vmcnt(0)
    s_branch L_ret_85
L_bail_92:
    s_mov_b32 s71, 0
    s_waitcnt vmcnt(0)
    s_branch L_ret_91
L_slow_88:
L_spin_90:
    buffer_load_dword v2, v4, s[60:63], 0 offen sc1
    s_sub_u32 s71, s71, 1
    s_cbranch_scc1 L_bail_92
    s_waitcnt vmcnt(0)
    v_subrev_u32 v2, s70, v2
    v_cmp_le_u32 vcc, 16, v2
    s_nop 0
    s_cbranch_vccnz L_spin_90
L_ret_91:
    s_branch L_back_89
L_bail_95:
    s_mov_b32 s71, 0
    s_waitcnt vmcnt(0)
    s_branch L_ret_94
L_bail_100:
    s_mov_b32 s71, 0
    s_waitcnt vmcnt(0)
    s_branch L_ret_99
L_slow_96:
L_spin_98:
    buffer_load_dword v2, v4, s[60:63], 0 offen sc1
    s_sub_u32 s71, s71, 1
    s_cbranch_scc1 L_bail_100
    s_waitcnt vmcnt(0)
    v_subrev_u32 v2, s70, v2
    v_cmp_le_u32 vcc, 16, v2
    s_nop 0
    s_cbranch_vccnz L_spin_98
L_ret_99:
    s_branch L_back_97
L_bail_105:
    s_mov_b32 s71, 0
    s_waitcnt vmcnt(0)
    s_branch L_ret_104
L_slow_101:
L_spin_103:
    buffer_load_dword v2, v4, s[60:63], 0 offen sc1
    s_sub_u32 s71, s71, 1
    s_cbranch_scc1 L_bail_105
    s_waitcnt vmcnt(0)
    v_subrev_u32 v2, s70, v2
    v_cmp_le_u32 vcc, 16, v2
    s_nop 0
    s_cbranch_vccnz L_spin_103
L_ret_104:
    s_branch L_back_102
L_bail_110:
    s_mov_b32 s71, 0
    s_waitcnt vmcnt(0)
    s_branch L_ret_109
L_slow_106:
L_spin_108:
    buffer_load_dword v2, v4, s[60:63], 0 offen sc1
    s_sub_u32 s71, s71, 1
    s_cbranch_scc1 L_bail_110
    s_waitcnt vmcnt(0)
    v_subrev_u32 v2, s70, v2
    v_cmp_le_u32 vcc, 16, v2
    s_nop 0
    s_cbranch_vccnz L_spin_108
L_ret_109:
    s_branch L_back_107
L_bail_113:
    s_mov_b32 s71, 0
    s_waitcnt vmcnt(0)
    s_branch L_ret_112
L_bail_116:
    s_mov_b32 s71, 0
    s_waitcnt vmcnt(0)
    s_branch L_ret_115
L_bail_119:
    s_mov_b32 s71, 0
    s_waitcnt vmcnt(0)
    s_branch L_ret_118
L_g1skip_83:
    s_add_u32 s70, s69, 5
    v_mov_b32 v2, s70
    s_waitcnt vmcnt(0) lgkmcnt(0)
    buffer_store_dword v2, v3, s[60:63], 0 offen sc1
    s_mov_b32 s50, 0x1c0000
    ds_read_b64_tr_b16 a[144:145], v9 offset:8192
    ds_read_b64_tr_b16 a[146:147], v9 offset:10240
    ds_read_b64_tr_b16 a[148:149], v10 offset:8192
    ds_read_b64_tr_b16 a[150:151], v10 offset:10240
    ds_read_b64_tr_b16 a[152:153], v9 offset:8256
    ds_read_b64_tr_b16 a[154:155], v9 offset:10304
    ds_read_b64_tr_b16 a[156:157], v10 offset:8256
    ds_read_b64_tr_b16 a[158:159], v10 offset:10304
    ds_read_b64_tr_b16 a[160:161], v9 offset:12288
    ds_read_b64_tr_b16 a[162:163], v9 offset:14336
    ds_read_b64_tr_b16 a[164:165], v10 offset:12288
    ds_read_b64_tr_b16 a[166:167], v10 offset:14336
    ds_read_b64_tr_b16 a[168:169], v9 offset:12352
    ds_read_b64_tr_b16 a[170:171], v9 offset:14400
    ds_read_b64_tr_b16 a[172:173], v10 offset:12352
    ds_read_b64_tr_b16 a[174:175], v10 offset:14400
    ds_read_b64_tr_b16 a[176:177], v9 offset:16384
    ds_read_b64_tr_b16 a[178:179], v9 offset:18432
    ds_read_b64_tr_b16 a[180:181], v10 offset:16384
    ds_read_b64_tr_b16 a[182:183], v10 offset:18432
    ds_read_b64_tr_b16 a[184:185], v9 offset:16448
    ds_read_b64_tr_b16 a[186:187], v9 offset:18496
    ds_read_b64_tr_b16 a[188:189], v10 offset:16448
    ds_read_b64_tr_b16 a[190:191], v10 offset:18496
    ds_read_b64_tr_b16 a[192:193], v9 offset:20480
    ds_read_b64_tr_b16 a[194:195], v9 offset:22528
    ds_read_b64_tr_b16 a[196:197], v10 offset:20480
    ds_read_b64_tr_b16 a[198:199], v10 offset:22528
    ds_read_b64_tr_b16 a[200:201], v9 offset:20544
    ds_read_b64_tr_b16 a[202:203], v9 offset:22592
    ds_read_b64_tr_b16 a[204:205], v10 offset:20544
    ds_read_b64_tr_b16 a[206:207], v10 offset:22592
    ds_read_b64_tr_b16 a[208:209], v9 offset:24576
    ds_read_b64_tr_b16 a[210:211], v9 offset:26624
    ds_read_b64_tr_b16 a[212:213], v10 offset:24576
    ds_read_b64_tr_b16 a[214:215], v10 offset:26624
    ds_read_b64_tr_b16 a[216:217], v9 offset:24640
    ds_read_b64_tr_b16 a[218:219], v9 offset:26688
    ds_read_b64_tr_b16 a[220:221], v10 offset:24640
    ds_read_b64_tr_b16 a[222:223], v10 offset:26688
    ds_read_b64_tr_b16 a[224:225], v9 offset:28672
    ds_read_b64_tr_b16 a[226:227], v9 offset:30720
    ds_read_b64_tr_b16 a[228:229], v10 offset:28672
    ds_read_b64_tr_b16 a[230:231], v10 offset:30720
    ds_read_b64_tr_b16 a[232:233], v9 offset:28736
    ds_read_b64_tr_b16 a[234:235], v9 offset:30784
    ds_read_b64_tr_b16 a[236:237], v10 offset:28736
    ds_read_b64_tr_b16 a[238:239], v10 offset:30784
    ds_read_b64_tr_b16 a[240:241], v9 offset:0
    ds_read_b64_tr_b16 a[242:243], v9 offset:2048
    ds_read_b64_tr_b16 a[244:245], v10 offset:0
    ds_read_b64_tr_b16 a[246:247], v10 offset:2048
    ds_read_b64_tr_b16 a[248:249], v9 offset:64
    ds_read_b64_tr_b16 a[250:251], v9 offset:2112
    ds_read_b64_tr_b16 a[252:253], v10 offset:64
    ds_read_b64_tr_b16 a[254:255], v10 offset:2112
    s_lshl_b32 s77, s28, 5
    s_add_u32 m0, s3, 4096
    s_nop 0
    buffer_load_dwordx4 v15, s[48:51], s77 offen lds
    s_add_u32 m0, s3, 5120
    s_add_u32 s77, s77, 8192
    buffer_load_dwordx4 v15, s[48:51], s77 offen lds
    s_add_u32 m0, s3, 6144
    s_add_u32 s77, s77, 8192
    buffer_load_dwordx4 v15, s[48:51], s77 offen lds
    s_add_u32 m0, s3, 7168
    s_add_u32 s77, s77, 8192
    buffer_load_dwordx4 v15, s[48:51], s77 offen lds
    s_waitcnt lgkmcnt(15)
    s_lshl_b32 s77, s36, 5
    s_add_u32 m0, s3, 8192
    s_nop 0
    buffer_load_dwordx4 v15, s[48:51], s77 offen lds
    s_add_u32 m0, s3, 9216
    s_add_u32 s77, s77, 8192
    buffer_load_dwordx4 v15, s[48:51], s77 offen lds
    s_add_u32 m0, s3, 10240
    s_add_u32 s77, s77, 8192
    buffer_load_dwordx4 v15, s[48:51], s77 offen lds
    s_add_u32 m0, s3, 11264
    s_add_u32 s77, s77, 8192
    buffer_load_dwordx4 v15, s[48:51], s77 offen lds
    s_lshl_b32 s77, s37, 5
    s_add_u32 m0, s3, 12288
    s_nop 0
    buffer_load_dwordx4 v15, s[48:51], s77 offen lds
    s_add_u32 m0, s3, 13312
    s_add_u32 s77, s77, 8192
    buffer_load_dwordx4 v15, s[48:51], s77 offen lds
    s_add_u32 m0, s3, 14336
    s_add_u32 s77, s77, 8192
    buffer_load_dwordx4 v15, s[48:51], s77 offen lds
    s_add_u32 m0, s3, 15360
    s_add_u32 s77, s77, 8192
    buffer_load_dwordx4 v15, s[48:51], s77 offen lds
    s_lshl_b32 s77, s38, 5
    s_add_u32 m0, s3, 16384
    s_nop 0
    buffer_load_dwordx4 v15, s[48:51], s77 offen lds
    s_add_u32 m0, s3, 17408
    s_add_u32 s77, s77, 8192
    buffer_load_dwordx4 v15, s[48:51], s77 offen lds
    s_add_u32 m0, s3, 18432
    s_add_u32 s77, s77, 8192
    buffer_load_dwordx4 v15, s[48:51], s77 offen lds
    s_add_u32 m0, s3, 19456
    s_add_u32 s77, s77, 8192
    buffer_load_dwordx4 v15, s[48:51], s77 offen lds
    s_lshl_b32 s77, s39, 5
    s_add_u32 m0, s3, 20480
    s_nop 0
    buffer_load_dwordx4 v15, s[48:51], s77 offen lds
    s_add_u32 m0, s3, 21504
    s_add_u32 s77, s77, 8192
    buffer_load_dwordx4 v15, s[48:51], s77 offen lds
    s_add_u32 m0, s3, 22528
    s_add_u32 s77, s77, 8192
    buffer_load_dwordx4 v15, s[48:51], s77 offen lds
    s_add_u32 m0, s3, 23552
    s_add_u32 s77, s77, 8192
    buffer_load_dwordx4 v15, s[48:51], s77 offen lds
    s_lshl_b32 s77, s40, 5
    s_add_u32 m0, s3, 24576
    s_nop 0
    buffer_load_dwordx4 v15, s[48:51], s77 offen lds
    s_add_u32 m0, s3, 25600
    s_add_u32 s77, s77, 8192
    buffer_load_dwordx4 v15, s[48:51], s77 offen lds
    s_add_u32 m0, s3, 26624
    s_add_u32 s77, s77, 8192
    buffer_load_dwordx4 v15, s[48:51], s77 offen lds
    s_add_u32 m0, s3, 27648
    s_add_u32 s77, s77, 8192
    buffer_load_dwordx4 v15, s[48:51], s77 offen lds
    s_waitcnt lgkmcnt(8)
    s_lshl_b32 s77, s41, 5
    s_add_u32 m0, s3, 28672
    s_nop 0
    buffer_load_dwordx4 v15, s[48:51], s77 offen lds
    s_add_u32 m0, s3, 29696
    s_add_u32 s77, s77, 8192
    buffer_load_dwordx4 v15, s[48:51], s77 offen lds
    s_add_u32 m0, s3, 30720
    s_add_u32 s77, s77, 8192
    buffer_load_dwordx4 v15, s[48:51], s77 offen lds
    s_add_u32 m0, s3, 31744
    s_add_u32 s77, s77, 8192
    buffer_load_dwordx4 v15, s[48:51], s77 offen lds
    s_waitcnt vmcnt(24)
    ds_read_b64_tr_b16 a[128:129], v9 offset:4096
    ds_read_b64_tr_b16 a[130:131], v9 offset:6144
    ds_read_b64_tr_b16 a[132:133], v10 offset:4096
    ds_read_b64_tr_b16 a[134:135], v10 offset:6144
    ds_read_b64_tr_b16 a[136:137], v9 offset:4160
    ds_read_b64_tr_b16 a[138:139], v9 offset:6208
    ds_read_b64_tr_b16 a[140:141], v10 offset:4160
    ds_read_b64_tr_b16 a[142:143], v10 offset:6208
    s_waitcnt vmcnt(20)
    ds_read_b64_tr_b16 v[160:161], v9 offset:8192
    ds_read_b64_tr_b16 v[162:163], v9 offset:10240
    ds_read_b64_tr_b16 v[164:165], v10 offset:8192
    ds_read_b64_tr_b16 v[166:167], v10 offset:10240
    ds_read_b64_tr_b16 v[168:169], v9 offset:8256
    ds_read_b64_tr_b16 v[170:171], v9 offset:10304
    ds_read_b64_tr_b16 v[172:173], v10 offset:8256
    ds_read_b64_tr_b16 v[174:175], v10 offset:10304
    s_waitcnt vmcnt(16)
    ds_read_b64_tr_b16 v[176:177], v9 offset:12288
    ds_read_b64_tr_b16 v[178:179], v9 offset:14336
    ds_read_b64_tr_b16 v[180:181], v10 offset:12288
    ds_read_b64_tr_b16 v[182:183], v10 offset:14336
    ds_read_b64_tr_b16 v[184:185], v9 offset:12352
    ds_read_b64_tr_b16 v[186:187], v9 offset:14400
    ds_read_b64_tr_b16 v[188:189], v10 offset:12352
    ds_read_b64_tr_b16 v[190:191], v10 offset:14400
    s_waitcnt vmcnt(12)
    ds_read_b64_tr_b16 v[192:193], v9 offset:16384
    ds_read_b64_tr_b16 v[194:195], v9 offset:18432
    ds_read_b64_tr_b16 v[196:197], v10 offset:16384
    ds_read_b64_tr_b16 v[198:199], v10 offset:18432
    ds_read_b64_tr_b16 v[200:201], v9 offset:16448
    ds_read_b64_tr_b16 v[202:203], v9 offset:18496
    ds_read_b64_tr_b16 v[204:205], v10 offset:16448
    ds_read_b64_tr_b16 v[206:207], v10 offset:18496
    s_waitcnt vmcnt(8)
    ds_read_b64_tr_b16 v[208:209], v9 offset:20480
    ds_read_b64_tr_b16 v[210:211], v9 offset:22528
    ds_read_b64_tr_b16 v[212:213], v10 offset:20480
    ds_read_b64_tr_b16 v[214:215], v10 offset:22528
    ds_read_b64_tr_b16 v[216:217], v9 offset:20544
    ds_read_b64_tr_b16 v[218:219], v9 offset:22592
    ds_read_b64_tr_b16 v[220:221], v10 offset:20544
    ds_read_b64_tr_b16 v[222:223], v10 offset:22592
    s_waitcnt vmcnt(4)
    ds_read_b64_tr_b16 v[224:225], v9 offset:24576
    ds_read_b64_tr_b16 v[226:227], v9 offset:26624
    ds_read_b64_tr_b16 v[228:229], v10 offset:24576
    ds_read_b64_tr_b16 v[230:231], v10 offset:26624
    ds_read_b64_tr_b16 v[232:233], v9 offset:24640
    ds_read_b64_tr_b16 v[234:235], v9 offset:26688
    ds_read_b64_tr_b16 v[236:237], v10 offset:24640
    ds_read_b64_tr_b16 v[238:239], v10 offset:26688
    s_waitcnt vmcnt(0)
    ds_read_b64_tr_b16 v[240:241], v9 offset:28672
    ds_read_b64_tr_b16 v[242:243], v9 offset:30720
    ds_read_b64_tr_b16 v[244:245], v10 offset:28672
    ds_read_b64_tr_b16 v[246:247], v10 offset:30720
    ds_read_b64_tr_b16 v[248:249], v9 offset:28736
    ds_read_b64_tr_b16 v[250:251], v9 offset:30784
    ds_read_b64_tr_b16 v[252:253], v10 offset:28736
    ds_read_b64_tr_b16 v[254:255], v10 offset:30784
    s_waitcnt lgkmcnt(0)
    s_barrier
    v_or_b32 v16, 4, v17
    v_or_b32 v16, 5, v17
    s_add_u32 s70, s69, 4
L_spin_93:
    buffer_load_dword v2, v4, s[60:63], 0 offen sc1
    s_sub_u32 s71, s71, 1
    s_cbranch_scc1 L_bail_95
    s_waitcnt vmcnt(0)
    v_subrev_u32 v2, s70, v2
    v_cmp_le_u32 vcc, 16, v2
    s_nop 0
    s_cbranch_vccnz L_spin_93
L_ret_94:
    v_mov_b32 v20, -1
    v_mov_b32 v21, -1
    v_mov_b32 v22, -1
    v_mov_b32 v23, -1
    buffer_store_dwordx4 v[20:23], v7, s[60:63], 0 offen sc1
    buffer_store_dwordx4 v[20:23], v7, s[60:63], s86 offen sc1
    buffer_load_dwordx4 v[100:103], v13, s[60:63], s28 offen sc1
    buffer_load_dwordx4 v[104:107], v13, s[60:63], s29 offen sc1
    buffer_load_dwordx4 v[108:111], v13, s[60:63], s30 offen sc1
    buffer_load_dwordx4 v[112:115], v13, s[60:63], s31 offen sc1
    buffer_load_dwordx4 v[116:119], v13, s[60:63], s32 offen sc1
    v_or_b32 v16, 6, v17
    buffer_load_dwordx4 v[120:123], v13, s[60:63], s33 offen sc1
    buffer_load_dwordx4 v[124:127], v13, s[60:63], s34 offen sc1
    buffer_load_dwordx4 v[128:131], v13, s[60:63], s35 offen sc1
    s_add_u32 s70, s69, 5
    buffer_load_dword v2, v4, s[60:63], 0 offen sc1
    buffer_load_dwordx4 v[132:135], v13, s[60:63], s36 offen sc1
    buffer_load_dwordx4 v[136:139], v13, s[60:63], s37 offen sc1
    s_waitcnt vmcnt(0) lgkmcnt(0)
    s_branch L_g2_87
L_bail_126:
    s_mov_b32 s71, 0
    s_waitcnt vmcnt(0)
    s_branch L_ret_125
L_slow_122:
L_spin_124:
    buffer_load_dword v2, v4, s[60:63], 0 offen sc1
    s_sub_u32 s71, s71, 1
    s_cbranch_scc1 L_bail_126
    s_waitcnt vmcnt(0)
    v_subrev_u32 v2, s70, v2
    v_cmp_le_u32 vcc, 16, v2
    s_nop 0
    s_cbranch_vccnz L_spin_124
L_ret_125:
    s_branch L_back_123
L_bail_131:
    s_mov_b32 s71, 0
    s_waitcnt vmcnt(0)
    s_branch L_ret_130
L_slow_127:
L_spin_129:
    buffer_load_dword v2, v4, s[60:63], 0 offen sc1
    s_sub_u32 s71, s71, 1
    s_cbranch_scc1 L_bail_131
    s_waitcnt vmcnt(0)
    v_subrev_u32 v2, s70, v2
    v_cmp_le_u32 vcc, 16, v2
    s_nop 0
    s_cbranch_vccnz L_spin_129
L_ret_130:
    s_branch L_back_128
L_bail_134:
    s_mov_b32 s71, 0
    s_waitcnt vmcnt(0)
    s_branch L_ret_133
L_bail_139:
    s_mov_b32 s71, 0
    s_waitcnt vmcnt(0)
    s_branch L_ret_138
L_slow_135:
L_spin_137:
    buffer_load_dword v2, v4, s[60:63], 0 offen sc1
    s_sub_u32 s71, s71, 1
    s_cbranch_scc1 L_bail_139
    s_waitcnt vmcnt(0)
    v_subrev_u32 v2, s70, v2
    v_cmp_le_u32 vcc, 16, v2
    s_nop 0
    s_cbranch_vccnz L_spin_137
L_ret_138:
    s_branch L_back_136
L_bail_144:
    s_mov_b32 s71, 0
    s_waitcnt vmcnt(0)
    s_branch L_ret_143
L_slow_140:
L_spin_142:
    buffer_load_dword v2, v4, s[60:63], 0 offen sc1
    s_sub_u32 s71, s71, 1
    s_cbranch_scc1 L_bail_144
    s_waitcnt vmcnt(0)
    v_subrev_u32 v2, s70, v2
    v_cmp_le_u32 vcc, 16, v2
    s_nop 0
    s_cbranch_vccnz L_spin_142
L_ret_143:
    s_branch L_back_141
L_bail_149:
    s_mov_b32 s71, 0
    s_waitcnt vmcnt(0)
    s_branch L_ret_148
L_slow_145:
L_spin_147:
    buffer_load_dword v2, v4, s[60:63], 0 offen sc1
    s_sub_u32 s71, s71, 1
    s_cbranch_scc1 L_bail_149
    s_waitcnt vmcnt(0)
    v_subrev_u32 v2, s70, v2
    v_cmp_le_u32 vcc, 16, v2
    s_nop 0
    s_cbranch_vccnz L_spin_147
L_ret_148:
    s_branch L_back_146
L_bail_152:
    s_mov_b32 s71, 0
    s_waitcnt vmcnt(0)
    s_branch L_ret_151
L_g1skip_120:
    s_add_u32 s70, s69, 11
    v_mov_b32 v2, s70
    s_waitcnt vmcnt(0) lgkmcnt(0)
    buffer_store_dword v2, v3, s[60:63], 0 offen sc1
    s_add_u32 s70, s69, 9
L_spin_150:
    buffer_load_dword v2, v4, s[60:63], 0 offen sc1
    s_sub_u32 s71, s71, 1
    s_cbranch_scc1 L_bail_152
    s_waitcnt vmcnt(0)
    v_subrev_u32 v2, s70, v2
    v_cmp_le_u32 vcc, 16, v2
    s_nop 0
    s_cbranch_vccnz L_spin_150
L_ret_151:
    v_lshrrev_b32 v20, 10, v5
    v_lshlrev_b32 v20, 3, v20
    s_mov_b32 s74, 2098176
    buffer_load_dwordx2 v[146:147], v20, s[60:63], s74 offen offset:0 sc1
    buffer_load_dwordx2 v[150:151], v20, s[60:63], s74 offen offset:256 sc1
    buffer_load_dwordx2 v[154:155], v20, s[60:63], s74 offen offset:512 sc1
    buffer_load_dwordx2 v[158:159], v20, s[60:63], s74 offen offset:768 sc1
    s_mov_b32 s74, 0
    buffer_load_dwordx2 v[144:145], v5, s[60:63], s74 offen sc1
    s_mov_b32 s74, 32768
    buffer_load_dwordx2 v[148:149], v5, s[60:63], s74 offen sc1
    s_mov_b32 s74, 65536
    buffer_load_dwordx2 v[152:153], v5, s[60:63], s74 offen sc1
    s_mov_b32 s74, 98304
    buffer_load_dwordx2 v[156:157], v5, s[60:63], s74 offen sc1
    s_or_b32 s74, s2, s66
    v_or_b32 v21, s74, v1
    v_cmp_eq_u32 s[84:85], 0, v21
    v_mov_b32 v20, s69
    s_nop 0
    v_cndmask_b32 v21, -1, v21, s[84:85]
    buffer_store_dword v20, v21, s[52:55], 0 offen sc1
    v_or_b32 v16, 10, v17
    v_or_b32 v16, 11, v17
    s_add_u32 s70, s69, 10
L_spin_132:
    buffer_load_dword v2, v4, s[60:63], 0 offen sc1
    s_sub_u32 s71, s71, 1
    s_cbranch_scc1 L_bail_134
    s_waitcnt vmcnt(0)
    v_subrev_u32 v2, s70, v2
    v_cmp_le_u32 vcc, 16, v2
    s_nop 0
    s_cbranch_vccnz L_spin_132
L_ret_133:
    buffer_load_dwordx4 v[100:103], v13, s[60:63], s28 offen sc1
    buffer_load_dwordx4 v[104:107], v13, s[60:63], s29 offen sc1
    buffer_load_dwordx4 v[108:111], v13, s[60:63], s30 offen sc1
    buffer_load_dwordx4 v[112:115], v13, s[60:63], s31 offen sc1
    buffer_load_dwordx4 v[116:119], v13, s[60:63], s32 offen sc1
    buffer_load_dwordx4 v[120:123], v13, s[60:63], s33 offen sc1
    buffer_load_dwordx4 v[124:127], v13, s[60:63], s34 offen sc1
    v_or_b32 v16, 12, v17
    buffer_load_dwordx4 v[128:131], v13, s[60:63], s35 offen sc1
    buffer_load_dwordx4 v[132:135], v13, s[60:63], s36 offen sc1
    buffer_load_dwordx4 v[136:139], v13, s[60:63], s37 offen sc1
    s_add_u32 s70, s69, 11
    buffer_load_dword v2, v4, s[60:63], 0 offen sc1
    s_waitcnt vmcnt(0) lgkmcnt(0)
    s_branch L_g2_121
    s_endpgm
.section .rodata,"a"
.p2align 6
.amdhsa_kernel interleave_layers__ssm_conv_h3__dense_activation_silu__prompt_kernel
  .amdhsa_next_free_vgpr 512
  .amdhsa_next_free_sgpr 102
  .amdhsa_accum_offset 256
  .amdhsa_group_segment_fixed_size 0
  .amdhsa_kernarg_size 96
  .amdhsa_user_sgpr_count 2
  .amdhsa_user_sgpr_kernarg_segment_ptr 1
  .amdhsa_system_sgpr_workgroup_id_x 1
  .amdhsa_float_denorm_mode_32 3
.end_amdhsa_kernel
```
